```python
import torch

def _softmax(x, axis=-1):
    return torch.softmax(x, dim=axis)

def _gelu(x):
    return torch.nn.functional.gelu(x, approximate='tanh')

def _silu(x):
    return torch.nn.functional.silu(x)

def _sigmoid(x):
    return torch.sigmoid(x)

def _layernorm(x, axis=-1, eps=1e-05):
    m = x.mean(dim=axis, keepdim=True)
    v = x.var(dim=axis, keepdim=True, unbiased=False)
    return (x - m) / torch.sqrt(v + eps)

def _scatter_add(tgt, idx, src, axis=0):
    return tgt.clone().index_add_(axis, idx, src)

def _segment_sum(src, seg, n):
    out = torch.zeros((n,) + src.shape[1:], dtype=src.dtype)
    return out.index_add_(0, seg, src)

def _pad(x, pw):
    flat = tuple((v for pair in reversed(pw) for v in pair))
    return torch.nn.functional.pad(x, flat)
kernel_name = 'sequential_preLN__grouped_kv_mqa__mixer_gmlp__prompt'

def setup_inputs():

    _w = lambda a: (lambda t: t.to(torch.bfloat16) if t.is_floating_point() else t)(torch.as_tensor(a))

    def _A_setup():
        B, S, D, H = (1, 2048, 512, 32)
        Dh = D // H
        return {'x': _w((lambda *s: torch.randn(*s, dtype=torch.bfloat16) * 0.05)(B, S, D)), 'wq': _w((lambda *s: torch.randn(*s, dtype=torch.bfloat16) * 0.05)(D, H * Dh)), 'wk': _w((lambda *s: torch.randn(*s, dtype=torch.bfloat16) * 0.05)(D, Dh)), 'wv': _w((lambda *s: torch.randn(*s, dtype=torch.bfloat16) * 0.05)(D, Dh)), 'wo': _w((lambda *s: torch.randn(*s, dtype=torch.bfloat16) * 0.05)(H * Dh, D))}
    _A_in = _A_setup()

    def _B_setup():
        B, S, D, F = (1, 2048, 512, 1376)
        Fh = F // 2
        return {'x': _w((lambda *s: torch.randn(*s, dtype=torch.bfloat16) * 0.05)(B, S, D)), 'w_in': _w((lambda *s: torch.randn(*s, dtype=torch.bfloat16) * 0.4)(D, 2 * Fh)), 'w_sp': _w(0.01 * (lambda *s: torch.randn(*s, dtype=torch.bfloat16) * 0.4)(S, S)), 'b_sp': _w(1.0 + 0.01 * (lambda *s: torch.randn(*s, dtype=torch.bfloat16) * 0.05)(S)), 'w_out': _w((lambda *s: torch.randn(*s, dtype=torch.bfloat16) * 0.05)(Fh, D))}
    _B_in = _B_setup()
    return {'A_x': _A_in['x'], 'A_wq': _A_in['wq'], 'A_wk': _A_in['wk'], 'A_wv': _A_in['wv'], 'A_wo': _A_in['wo'], 'B_x': _B_in['x'], 'B_w_in': _B_in['w_in'], 'B_w_sp': _B_in['w_sp'], 'B_b_sp': _B_in['b_sp'], 'B_w_out': _B_in['w_out']}

def reference(A_x, A_wq, A_wk, A_wv, A_wo, B_x, B_w_in, B_w_sp, B_b_sp, B_w_out):

    def _A_ref(x, wq, wk, wv, wo):
        B, S, D = x.shape
        H = 32
        Dh = D // H
        q = (lambda x, *d: x.permute(*d))((x @ wq).reshape(B, S, H, Dh), 0, 2, 1, 3)
        k = x @ wk
        v = x @ wv
        scores = torch.einsum('bhqd,bkd->bhqk', q, k) * Dh ** (-0.5)
        p = _softmax(scores, axis=-1)
        o = torch.einsum('bhqk,bkd->bhqd', p, v)
        return (lambda x, *d: x.permute(*d))(o, 0, 2, 1, 3).reshape(B, S, H * Dh) @ wo

    def _B_ref(x, w_in, w_sp, b_sp, w_out):
        B, S, D = x.shape
        F = w_in.shape[-1]
        Fh = F // 2
        z = _gelu(torch.einsum('bsd,df->bsf', x, w_in))
        z1 = z[..., :Fh].clone()
        z2 = _layernorm(z[..., Fh:], axis=-1)
        g = torch.einsum('ts,bsf->btf', w_sp, z2) + b_sp[None, :, None]
        return torch.einsum('bsf,fd->bsd', z1 * g, w_out)
    x = A_x
    h = x + _A_ref(_layernorm(x, axis=-1), A_wq, A_wk, A_wv, A_wo)
    h2 = h + _B_ref(_layernorm(h, axis=-1), B_w_in, B_w_sp, B_b_sp, B_w_out)
    return h2
```

```asm
; @launch grid=(256,1,1) block=(512,1,1) lds=163840
.amdgcn_target "amdgcn-amd-amdhsa--gfx950"
.text
.globl sequential_preLN__grouped_kv_mqa__mixer_gmlp__prompt_kernel
.p2align 8
.type sequential_preLN__grouped_kv_mqa__mixer_gmlp__prompt_kernel,@function
sequential_preLN__grouped_kv_mqa__mixer_gmlp__prompt_kernel:
  s_cmp_ge_u32 s2, 256
  s_cbranch_scc1 L_end
  s_lshr_b32 s7, s2, 3
  s_and_b32 s6, s7, 7
  s_lshr_b32 s33, s6, 2
  s_lshl_b32 s33, s33, 3
  s_add_u32 s33, s33, 16
  s_load_dwordx2 s[12:13], s[0:1], 0
  s_load_dwordx2 s[20:21], s[0:1], s33
  s_load_dwordx2 s[8:9], s[0:1], 96
  s_load_dwordx2 s[64:65], s[0:1], 88
  s_load_dwordx2 s[16:17], s[0:1], 8
  s_memrealtime s[78:79]
  s_mov_b32 s14, 2097152
  s_mov_b32 s15, 0x20000
  s_mov_b32 s22, 16384
  s_mov_b32 s23, 0x20000
  s_mov_b32 s18, 524288
  s_mov_b32 s19, 0x20000
  s_mov_b32 s10, 33554432
  s_mov_b32 s11, 0x20000
  s_mov_b32 s66, 256
  s_mov_b32 s67, 0x20000
  v_lshrrev_b32 v1, 6, v0
  v_and_b32 v2, 63, v0
  v_readfirstlane_b32 s4, v1
  v_mov_b32 v1, v2
  v_lshlrev_b32 v2, 4, v1
  s_and_b32 s3, s2, 7
  s_lshr_b32 s7, s7, 3
  s_lshl_b32 s3, s3, 2
  s_add_u32 s5, s3, s7
  s_and_b32 s55, s6, 3
  s_lshr_b32 s56, s6, 2
  v_lshrrev_b32 v3, 3, v1
  v_and_b32 v4, 7, v1
  v_xor_b32 v190, v3, v4
  v_lshlrev_b32 v190, 4, v190
  v_lshl_add_u32 v190, v3, 10, v190
  v_xor_b32 v191, 16, v190
  s_lshl_b32 s33, s5, 16
  s_lshl_b32 s49, s4, 7
  s_add_u32 s33, s33, s49
  s_lshl_b32 s86, s7, 1
  s_sub_u32 s34, s4, s86
  s_and_b32 s34, s34, 7
  s_lshl_b32 s34, s34, 13
  s_lshl_b32 s35, s55, 1
  s_lshl_b32 s37, s4, 11
  v_bfe_u32 v14, v3, 1, 1
  v_lshlrev_b32 v14, 2, v14
  v_xor_b32 v14, v14, v4
  v_lshlrev_b32 v14, 4, v14
  v_lshl_add_u32 v14, v3, 10, v14
  s_lshl_b32 s36, s6, 7
  v_add_u32 v14, s36, v14
  s_lshl_b32 s57, s4, 10
  s_lshl_b32 s87, s4, 13
  s_waitcnt lgkmcnt(0)
  s_add_u32 s36, s35, 0
  s_and_b32 s36, s36, 7
  s_lshl_b32 s38, s36, 10
  s_add_u32 m0, s38, s34
  s_lshl_b32 s36, s36, 13
  s_add_u32 s36, s36, s33
  buffer_load_dwordx4 v190, s[12:15], s36 offen lds
  s_add_u32 s36, s35, 1
  s_and_b32 s36, s36, 7
  s_lshl_b32 s38, s36, 10
  s_add_u32 m0, s38, s34
  s_lshl_b32 s36, s36, 13
  s_add_u32 s36, s36, s33
  buffer_load_dwordx4 v191, s[12:15], s36 offen lds
  s_add_u32 m0, s37, 131072
  s_nop 0
  buffer_load_dwordx4 v2, s[20:23], s37 offen offset:0 lds
  buffer_load_dwordx4 v2, s[20:23], s37 offen offset:1024 lds
  s_lshl_b32 s50, s5, 12
  s_lshl_b32 s49, s6, 7
  s_add_u32 s50, s50, s49
  s_add_u32 s50, s50, 131072
  s_lshl_b32 s51, s5, 12
  s_lshl_b32 s49, s4, 7
  s_add_u32 s51, s51, s49
  s_add_u32 s51, s51, 131072
  v_and_b32 v10, 15, v1
  v_mov_b32 v15, 0
  s_cmp_lg_u32 s4, 0
  s_cbranch_scc1 sequential_preLN__grouped_kv_mqa__mixer_gmlp__prompt_kernel_L1
  s_cmp_lg_u32 s2, 0
  s_cbranch_scc1 sequential_preLN__grouped_kv_mqa__mixer_gmlp__prompt_kernel_L2
  s_or_b32 s78, s78, 1
  v_mov_b32 v16, s78
  v_mov_b32 v17, s79
  s_mov_b64 exec, 1
  buffer_store_dwordx2 v[16:17], v15, s[64:67], 0 offen sc1
  s_mov_b64 exec, -1
sequential_preLN__grouped_kv_mqa__mixer_gmlp__prompt_kernel_L2:
  v_mov_b32 v16, 0
  v_mov_b32 v17, 0
  v_mov_b32 v18, 0
  v_mov_b32 v19, 0
  v_mov_b32 v20, 153632
  ds_write_b32 v20, v16
  v_lshlrev_b32 v20, 10, v1
  v_add_u32 v20, s50, v20
  s_lshl_b32 s39, s2, 2
  s_add_u32 s39, s39, 263168
  v_writelane_b32 v20, s39, 3
  s_lshl_b32 s39, s6, 12
  s_lshl_b32 s49, s5, 7
  s_add_u32 s39, s39, s49
  s_add_u32 s39, s39, 270336
  v_writelane_b32 v20, s39, 4
  s_lshl_b32 s39, s2, 2
  s_add_u32 s39, s39, 263168
  v_writelane_b32 v20, s39, 5
  s_lshl_b32 s39, s2, 2
  s_add_u32 s39, s39, 264192
  v_writelane_b32 v20, s39, 6
  s_mov_b64 exec, 127
  buffer_store_dword v16, v20, s[8:11], 0 offen sc1
  s_mov_b64 exec, -1
  v_lshrrev_b32 v20, 4, v1
  v_lshlrev_b32 v20, 10, v20
  v_lshl_add_u32 v20, v10, 4, v20
  s_lshr_b32 s40, s6, 1
  s_and_b32 s41, s6, 1
  s_lshl_b32 s47, s5, 12
  s_lshl_b32 s49, s40, 8
  s_add_u32 s47, s47, s49
  s_lshl_b32 s49, s41, 3
  s_add_u32 s47, s47, s49
  s_add_u32 s47, s47, 524288
  v_mov_b32 v18, -1
  v_mov_b32 v19, -1
  buffer_store_dwordx2 v[18:19], v20, s[8:11], s47 offen sc1
  s_sub_u32 s47, s47, 131072
  buffer_store_dwordx2 v[18:19], v20, s[8:11], s47 offen sc1
  s_waitcnt lgkmcnt(0)
sequential_preLN__grouped_kv_mqa__mixer_gmlp__prompt_kernel_L1:
  s_getpc_b64 s[90:91]
L_pc:
  s_sub_u32 s92, 7, s4
  s_lshl_b32 s92, s92, 5
  s_lshr_b32 s93, s2, 3
  s_add_u32 s92, s92, s93
  s_cmp_ge_u32 s92, 10
  s_cbranch_scc1 sequential_preLN__grouped_kv_mqa__mixer_gmlp__prompt_kernel_L3
  s_add_u32 s92, s92, 0
  s_lshl_b32 s92, s92, 10
  s_cmp_ge_u32 s92, L_codeend-L_pc-1024
  s_cbranch_scc1 sequential_preLN__grouped_kv_mqa__mixer_gmlp__prompt_kernel_L3
  v_add_u32 v203, s92, v2
  global_load_dwordx4 v[204:207], v203, s[90:91]
sequential_preLN__grouped_kv_mqa__mixer_gmlp__prompt_kernel_L3:
  s_barrier
  s_add_u32 s38, s86, 0
  s_and_b32 s38, s38, 7
  s_lshl_b32 s38, s38, 16
  s_add_u32 m0, s57, 65536
  s_add_u32 s38, s38, s87
  buffer_load_dwordx4 v14, s[16:19], s38 offen lds
  s_add_u32 s38, s86, 1
  s_and_b32 s38, s38, 7
  s_lshl_b32 s38, s38, 16
  s_add_u32 m0, s57, 73728
  s_add_u32 s38, s38, s87
  buffer_load_dwordx4 v14, s[16:19], s38 offen lds
  s_mov_b32 s28, 0x3f803f80
  s_and_b32 s29, s4, 1
  s_bfe_u32 s30, s4, 0x10001
  s_lshr_b32 s31, s4, 2
  s_lshr_b32 s32, s4, 1
  v_and_b32 v8, 31, v1
  v_lshlrev_b32 v7, 10, v8
  v_lshrrev_b32 v9, 5, v1
  v_lshl_add_u32 v7, v9, 4, v7
  s_lshl_b32 s52, s5, 16
  s_lshl_b32 s49, s30, 15
  s_add_u32 s52, s52, s49
  s_lshl_b32 s49, s6, 7
  s_add_u32 s52, s52, s49
  s_lshl_b32 s49, s29, 6
  s_add_u32 s52, s52, s49
  s_lshl_b32 s49, s31, 5
  s_add_u32 s52, s52, s49
  s_lshl_b32 s42, s2, 3
  s_add_u32 s42, s42, s4
  s_mov_b32 s74, 1073741824
  s_mov_b32 s75, 1073741824
  s_mov_b32 s53, 0
  s_mov_b32 s54, 1073741824
  v_lshrrev_b32 v16, 2, v1
  v_and_b32 v17, 3, v1
  v_lshlrev_b32 v17, 4, v17
  v_lshl_add_u32 v252, v16, 10, v17
  s_cmp_lt_u32 s2, 86
  s_cbranch_scc1 sequential_preLN__grouped_kv_mqa__mixer_gmlp__prompt_kernel_L4
  s_sub_u32 s44, s42, 688
  s_cmp_lt_u32 s44, 256
  s_cbranch_scc1 sequential_preLN__grouped_kv_mqa__mixer_gmlp__prompt_kernel_L5
  s_load_dwordx2 s[60:61], s[0:1], 72
  s_mov_b32 s62, 704512
  s_mov_b32 s63, 0x20000
  s_sub_u32 s44, s44, 256
  s_cmp_lt_u32 s44, 352
  s_cbranch_scc0 sequential_preLN__grouped_kv_mqa__mixer_gmlp__prompt_kernel_L7
  s_mul_i32 s45, s44, 2979
  s_lshr_b32 s45, s45, 16
  s_mul_i32 s46, s45, 22
  s_sub_u32 s46, s44, s46
  s_mul_i32 s54, s45, 45056
  s_lshl_b32 s49, s46, 11
  s_add_u32 s54, s54, s49
  s_add_u32 s54, s54, 13631488
  s_branch sequential_preLN__grouped_kv_mqa__mixer_gmlp__prompt_kernel_L6
sequential_preLN__grouped_kv_mqa__mixer_gmlp__prompt_kernel_L5:
  s_load_dwordx2 s[60:61], s[0:1], 32
  s_mov_b32 s62, 524288
  s_mov_b32 s63, 0x20000
  s_lshr_b32 s45, s44, 4
  s_and_b32 s46, s44, 15
  s_lshl_b32 s54, s44, 11
  s_add_u32 s54, s54, 11534336
sequential_preLN__grouped_kv_mqa__mixer_gmlp__prompt_kernel_L6:
  s_mov_b32 s53, 1
  s_lshl_b32 s74, s46, 15
  s_lshl_b32 s49, s45, 6
  s_add_u32 s74, s74, s49
  s_add_u32 s75, s74, 16384
  s_branch sequential_preLN__grouped_kv_mqa__mixer_gmlp__prompt_kernel_L7
sequential_preLN__grouped_kv_mqa__mixer_gmlp__prompt_kernel_L4:
  s_load_dwordx2 s[60:61], s[0:1], 48
  s_mov_b32 s62, 1409024
  s_mov_b32 s63, 0x20000
  s_mov_b32 s53, 2
  s_mov_b32 s47, 2752
  v_lshrrev_b32 v16, 1, v1
  v_mul_lo_u32 v252, v16, s47
  v_and_b32 v17, 1, v1
  v_lshl_add_u32 v252, v17, 4, v252
  s_mul_i32 s74, s4, 176128
  s_lshl_b32 s49, s2, 5
  s_add_u32 s74, s74, s49
  s_add_u32 s75, s74, 88064
  s_lshl_b32 s54, s2, 14
  s_lshl_b32 s49, s4, 11
  s_add_u32 s54, s54, s49
  s_add_u32 s54, s54, 12058624
sequential_preLN__grouped_kv_mqa__mixer_gmlp__prompt_kernel_L7:
  s_load_dwordx2 s[24:25], s[0:1], 56
  s_mov_b32 s26, 8388608
  s_mov_b32 s27, 0x20000
  v_lshrrev_b32 v24, 4, v1
  v_bfe_u32 v25, v1, 2, 2
  v_and_b32 v17, 1, v1
  v_lshlrev_b32 v17, 1, v17
  v_bfe_u32 v26, v1, 1, 1
  v_or_b32 v26, v26, v17
  v_and_b32 v16, 7, v1
  v_bfe_u32 v17, v1, 3, 2
  v_and_b32 v18, 1, v17
  v_xor_b32 v18, v18, v16
  v_xor_b32 v18, v18, v9
  v_lshlrev_b32 v18, 4, v18
  v_lshl_add_u32 v18, v16, 7, v18
  v_lshl_add_u32 v18, v17, 10, v18
  s_lshl_b32 s39, s31, 5
  s_lshl_b32 s49, s30, 12
  s_add_u32 s39, s39, s49
  v_xor_b32 v11, s39, v18
  v_xor_b32 v12, 64, v11
  v_lshrrev_b32 v17, 1, v24
  v_lshl_add_u32 v17, v17, 3, v25
  v_and_b32 v19, 1, v24
  v_lshlrev_b32 v20, 1, v19
  v_lshrrev_b32 v21, 1, v26
  v_add_u32 v20, v20, v21
  s_lshl_b32 s39, s29, 2
  v_add_u32 v20, s39, v20
  v_lshrrev_b32 v21, 1, v25
  v_lshlrev_b32 v21, 2, v21
  v_xor_b32 v20, v20, v21
  v_lshlrev_b32 v20, 4, v20
  v_lshl_add_u32 v20, v17, 7, v20
  v_and_b32 v21, 1, v26
  v_lshl_add_u32 v20, v21, 3, v20
  s_lshl_b32 s39, s31, 11
  s_add_u32 s39, s39, 65536
  v_add_u32 v13, s39, v20
  v_and_b32 v27, 0xfffffff3, v8
  v_and_b32 v20, 4, v8
  v_lshl_or_b32 v27, v20, 1, v27
  v_and_b32 v20, 8, v8
  v_lshrrev_b32 v20, 1, v20
  v_or_b32 v27, v27, v20
  s_lshl_b32 s36, s31, 15
  v_add_u32 v4, s36, v2
  v_lshlrev_b32 v3, 4, v10
  v_lshl_add_u32 v3, v9, 8, v3
  v_add_u32 v3, 0x18000, v3
  v_add_u32 v5, s36, v3
  v_and_b32 v6, 27, v1
  v_cmp_eq_u32 vcc, 16, v6
  v_mov_b32 v6, s28
  s_nop 0
  v_cndmask_b32 v6, 0, v6, vcc
  v_mov_b32 v240, v6
  v_mov_b32 v241, v6
  v_mov_b32 v242, v6
  v_mov_b32 v243, v6
  s_lshl_b32 s89, s31, 15
  s_lshl_b32 s49, s4, 10
  s_add_u32 s89, s89, s49
  s_and_b32 s89, s89, 0x8fff
  s_mov_b32 s44, 0x0000ffff
  s_mov_b32 s45, 0x0000ffff
  s_lshl_b32 s39, s30, 11
  s_add_u32 s39, s39, 147456
  v_lshlrev_b32 v176, 6, v8
  v_add_u32 v176, s39, v176
  s_and_b32 s39, s4, 3
  s_lshl_b32 s40, s39, 11
  s_lshl_b32 s49, s31, 14
  s_add_u32 s40, s40, s49
  s_add_u32 s40, s40, 139264
  v_add_u32 v177, s40, v2
  v_xor_b32 v178, 0x4000, v177
  s_lshl_b32 s40, s39, 10
  s_add_u32 s40, s40, 86016
  v_add_u32 v42, s40, v2
  s_lshl_b32 s40, s39, 2
  s_add_u32 s40, s40, 94208
  v_mov_b32 v43, s40
  s_lshl_b32 s39, s31, 8
  s_lshl_b32 s49, s29, 7
  s_add_u32 s39, s39, s49
  s_add_u32 s39, s39, 151552
  v_lshlrev_b32 v40, 2, v27
  v_add_u32 v40, s39, v40
  s_lshl_b32 s39, s29, 7
  s_lshl_b32 s49, s31, 6
  s_add_u32 s39, s39, s49
  s_add_u32 s39, s39, 151552
  v_lshlrev_b32 v41, 5, v9
  v_add_u32 v41, s39, v41
  v_lshlrev_b32 v180, 7, v1
  v_bfe_u32 v17, v1, 1, 3
  v_lshl_add_u32 v180, v17, 4, v180
  v_add_u32 v180, s34, v180
  v_xor_b32 v181, 16, v180
  v_xor_b32 v182, 32, v180
  v_xor_b32 v183, 48, v180
  v_xor_b32 v184, 64, v180
  v_xor_b32 v185, 80, v180
  v_xor_b32 v186, 96, v180
  v_xor_b32 v187, 112, v180
  v_lshlrev_b32 v188, 6, v1
  s_lshl_b32 s39, s4, 3
  s_add_u32 s39, s39, 147456
  v_add_u32 v188, s39, v188
  s_lshl_b32 s41, s4, 11
  s_add_u32 s41, s41, 66560
  s_cmp_eq_u32 s53, 2
  s_cbranch_scc1 sequential_preLN__grouped_kv_mqa__mixer_gmlp__prompt_kernel_L8
  v_lshrrev_b32 v200, 1, v24
  v_lshl_add_u32 v200, v200, 3, v25
  v_lshlrev_b32 v200, 6, v200
  v_and_b32 v201, 1, v24
  v_lshl_add_u32 v200, v201, 5, v200
  v_lshl_add_u32 v200, v26, 3, v200
  v_add_u32 v200, s41, v200
  v_add_u32 v201, 256, v200
  s_branch sequential_preLN__grouped_kv_mqa__mixer_gmlp__prompt_kernel_L9
sequential_preLN__grouped_kv_mqa__mixer_gmlp__prompt_kernel_L8:
  v_lshl_add_u32 v200, v24, 3, v25
  v_lshlrev_b32 v200, 5, v200
  v_and_b32 v201, 3, v1
  v_lshl_add_u32 v200, v201, 3, v200
  v_add_u32 v200, s41, v200
  v_add_u32 v201, 128, v200
sequential_preLN__grouped_kv_mqa__mixer_gmlp__prompt_kernel_L9:
  v_add_u32 v202, s41, v2
  v_and_b32 v17, 7, v1
  v_bfe_u32 v18, v1, 3, 1
  v_xor_b32 v19, v24, v17
  v_xor_b32 v19, v19, v18
  v_lshlrev_b32 v19, 4, v19
  v_lshl_add_u32 v19, v17, 7, v19
  v_lshl_add_u32 v19, v18, 10, v19
  s_mov_b32 s39, s34
  s_lshl_b32 s49, s55, 11
  s_add_u32 s39, s39, s49
  v_add_u32 v19, s39, v19
  v_xor_b32 v20, 64, v19
  v_lshl_add_u32 v21, v24, 3, v25
  v_lshlrev_b32 v21, 5, v21
  v_and_b32 v22, 3, v1
  v_lshl_add_u32 v21, v22, 3, v21
  s_add_u32 s39, s37, 131072
  v_add_u32 v21, s39, v21
  v_mov_b32 v36, s28
  v_mov_b32 v37, s28
  v_mov_b32 v38, s28
  v_mov_b32 v39, s28
  v_add_u32 v22, s39, v2
  v_lshlrev_b32 v23, 3, v10
  v_add_u32 v23, 152576, v23
  s_lshl_b32 s39, s4, 7
  v_add_u32 v18, s39, v23
  s_cmp_eq_u32 s4, 0
  s_cbranch_scc1 sequential_preLN__grouped_kv_mqa__mixer_gmlp__prompt_kernel_L10
  s_waitcnt vmcnt(2)
  s_branch sequential_preLN__grouped_kv_mqa__mixer_gmlp__prompt_kernel_L11
sequential_preLN__grouped_kv_mqa__mixer_gmlp__prompt_kernel_L10:
  s_waitcnt vmcnt(5)
  buffer_load_dwordx2 v[28:29], v15, s[64:67], 0 offen sc1
sequential_preLN__grouped_kv_mqa__mixer_gmlp__prompt_kernel_L11:
  ds_read_b128 v[80:83], v19
  ds_read_b64_tr_b16 v[112:113], v21
  ds_read_b64_tr_b16 v[114:115], v21 offset:128
  ds_read_b128 v[84:87], v20
  ds_read_b64_tr_b16 v[116:117], v21 offset:1024
  ds_read_b64_tr_b16 v[118:119], v21 offset:1152
  s_waitcnt lgkmcnt(3)
  v_mfma_f32_16x16x32_bf16 v[64:67], v[112:115], v[80:83], 0
  v_mfma_f32_16x16x32_bf16 v[68:71], v[112:115], v[36:39], 0
  v_mfma_f32_16x16x32_bf16 v[72:75], v[36:39], v[80:83], 0
  v_dot2_f32_bf16 v76, v80, v80, 0
  v_dot2_f32_bf16 v77, v81, v81, 0
  v_dot2_f32_bf16 v78, v82, v82, 0
  v_dot2_f32_bf16 v79, v83, v83, 0
  s_waitcnt lgkmcnt(0)
  v_mfma_f32_16x16x32_bf16 v[64:67], v[116:119], v[84:87], v[64:67]
  v_mfma_f32_16x16x32_bf16 v[68:71], v[116:119], v[36:39], v[68:71]
  v_mfma_f32_16x16x32_bf16 v[72:75], v[36:39], v[84:87], v[72:75]
  v_dot2_f32_bf16 v76, v84, v84, v76
  v_dot2_f32_bf16 v77, v85, v85, v77
  v_dot2_f32_bf16 v78, v86, v86, v78
  v_dot2_f32_bf16 v79, v87, v87, v79
  s_nop 2
  v_pk_add_f32 v[76:77], v[76:77], v[78:79]
  v_add_f32 v76, v76, v77
  v_mov_b32 v17, v76
  s_nop 1
  v_permlane16_swap_b32 v76, v17
  v_add_f32 v76, v76, v17
  v_mov_b32 v17, v76
  s_nop 1
  v_permlane32_swap_b32 v76, v17
  v_add_f32 v76, v76, v17
  ds_write_b128 v22, v[64:67]
  ds_write_b128 v22, v[68:71] offset:1024
  v_mov_b32 v73, v76
  ds_write_b64 v18, v[72:73]
  v_mov_b32 v17, 153632
  v_mov_b32 v16, 1
  s_mov_b64 exec, 1
  ds_add_u32 v17, v16
  s_mov_b64 exec, -1
  s_add_u32 s36, s35, 2
  s_and_b32 s36, s36, 7
  s_lshl_b32 s38, s36, 10
  s_add_u32 m0, s38, s34
  s_lshl_b32 s36, s36, 13
  s_add_u32 s36, s36, s33
  buffer_load_dwordx4 v190, s[12:15], s36 offen lds
  s_add_u32 s36, s35, 3
  s_and_b32 s36, s36, 7
  s_lshl_b32 s38, s36, 10
  s_add_u32 m0, s38, s34
  s_lshl_b32 s36, s36, 13
  s_add_u32 s36, s36, s33
  buffer_load_dwordx4 v191, s[12:15], s36 offen lds
  s_add_u32 s36, s35, 4
  s_and_b32 s36, s36, 7
  s_lshl_b32 s38, s36, 10
  s_add_u32 m0, s38, s34
  s_lshl_b32 s36, s36, 13
  s_add_u32 s36, s36, s33
  buffer_load_dwordx4 v190, s[12:15], s36 offen lds
  s_add_u32 s36, s35, 5
  s_and_b32 s36, s36, 7
  s_lshl_b32 s38, s36, 10
  s_add_u32 m0, s38, s34
  s_lshl_b32 s36, s36, 13
  s_add_u32 s36, s36, s33
  buffer_load_dwordx4 v191, s[12:15], s36 offen lds
  s_add_u32 s36, s35, 6
  s_and_b32 s36, s36, 7
  s_lshl_b32 s38, s36, 10
  s_add_u32 m0, s38, s34
  s_lshl_b32 s36, s36, 13
  s_add_u32 s36, s36, s33
  buffer_load_dwordx4 v190, s[12:15], s36 offen lds
  s_add_u32 s36, s35, 7
  s_and_b32 s36, s36, 7
  s_lshl_b32 s38, s36, 10
  s_add_u32 m0, s38, s34
  s_lshl_b32 s36, s36, 13
  s_add_u32 s36, s36, s33
  buffer_load_dwordx4 v191, s[12:15], s36 offen lds
  s_add_u32 s38, s86, 2
  s_and_b32 s38, s38, 7
  s_lshl_b32 s38, s38, 16
  s_add_u32 m0, s57, 81920
  s_add_u32 s38, s38, s87
  buffer_load_dwordx4 v14, s[16:19], s38 offen lds
  s_add_u32 s38, s86, 3
  s_and_b32 s38, s38, 7
  s_lshl_b32 s38, s38, 16
  s_add_u32 m0, s57, 90112
  s_add_u32 s38, s38, s87
  buffer_load_dwordx4 v14, s[16:19], s38 offen lds
  s_add_u32 s38, s86, 4
  s_and_b32 s38, s38, 7
  s_lshl_b32 s38, s38, 16
  s_add_u32 m0, s57, 98304
  s_add_u32 s38, s38, s87
  buffer_load_dwordx4 v14, s[16:19], s38 offen lds
  s_add_u32 s38, s86, 5
  s_and_b32 s38, s38, 7
  s_lshl_b32 s38, s38, 16
  s_add_u32 m0, s57, 106496
  s_add_u32 s38, s38, s87
  buffer_load_dwordx4 v14, s[16:19], s38 offen lds
  s_add_u32 s38, s86, 6
  s_and_b32 s38, s38, 7
  s_lshl_b32 s38, s38, 16
  s_add_u32 m0, s57, 114688
  s_add_u32 s38, s38, s87
  buffer_load_dwordx4 v14, s[16:19], s38 offen lds
  s_add_u32 s38, s86, 7
  s_and_b32 s38, s38, 7
  s_lshl_b32 s38, s38, 16
  s_add_u32 m0, s57, 122880
  s_add_u32 s38, s38, s87
  buffer_load_dwordx4 v14, s[16:19], s38 offen lds
  s_sub_u32 s92, 7, s4
  s_lshl_b32 s92, s92, 5
  s_lshr_b32 s93, s2, 3
  s_add_u32 s92, s92, s93
  s_cmp_ge_u32 s92, 54
  s_cbranch_scc1 sequential_preLN__grouped_kv_mqa__mixer_gmlp__prompt_kernel_L12
  s_add_u32 s92, s92, 10
  s_lshl_b32 s92, s92, 10
  s_cmp_ge_u32 s92, L_codeend-L_pc-1024
  s_cbranch_scc1 sequential_preLN__grouped_kv_mqa__mixer_gmlp__prompt_kernel_L12
  v_add_u32 v203, s92, v2
  global_load_dwordx4 v[204:207], v203, s[90:91]
sequential_preLN__grouped_kv_mqa__mixer_gmlp__prompt_kernel_L12:
  s_cmp_lg_u32 s4, 0
  s_cbranch_scc1 sequential_preLN__grouped_kv_mqa__mixer_gmlp__prompt_kernel_L13
  s_setprio 3
  s_mov_b32 s48, 1000000
sequential_preLN__grouped_kv_mqa__mixer_gmlp__prompt_kernel_cw16:
  ds_read_b32 v16, v17
  s_sub_u32 s48, s48, 1
  s_cmp_eq_u32 s48, 0
  s_cbranch_scc1 sequential_preLN__grouped_kv_mqa__mixer_gmlp__prompt_kernel_cx17
  s_waitcnt lgkmcnt(0)
  v_cmp_ne_u32 vcc, 8, v16
  s_cbranch_vccnz sequential_preLN__grouped_kv_mqa__mixer_gmlp__prompt_kernel_cw16
sequential_preLN__grouped_kv_mqa__mixer_gmlp__prompt_kernel_cx17:
  ds_read_b64 v[146:147], v23 offset:128
  ds_read_b64 v[148:149], v23 offset:256
  ds_read_b64 v[150:151], v23 offset:384
  ds_read_b64 v[152:153], v23 offset:512
  ds_read_b64 v[154:155], v23 offset:640
  ds_read_b64 v[156:157], v23 offset:768
  ds_read_b64 v[158:159], v23 offset:896
  ds_read_b128 v[116:119], v22 offset:3072
  ds_read_b128 v[120:123], v22 offset:5120
  ds_read_b128 v[124:127], v22 offset:7168
  ds_read_b128 v[128:131], v22 offset:9216
  ds_read_b128 v[132:135], v22 offset:11264
  ds_read_b128 v[136:139], v22 offset:13312
  ds_read_b128 v[140:143], v22 offset:15360
  v_and_b32 v33, 0xfffffff3, v1
  v_and_b32 v20, 4, v1
  v_lshl_or_b32 v33, v20, 1, v33
  v_and_b32 v20, 8, v1
  v_lshrrev_b32 v20, 1, v20
  v_or_b32 v33, v33, v20
  s_lshr_b32 s39, s55, 1
  s_lshl_b32 s40, s5, 11
  s_lshl_b32 s49, s39, 10
  s_add_u32 s40, s40, s49
  s_and_b32 s39, s55, 1
  v_and_b32 v20, 1, v24
  v_lshlrev_b32 v20, 3, v20
  v_and_b32 v33, 15, v33
  v_lshl_add_u32 v20, v33, 4, v20
  s_waitcnt lgkmcnt(7)
  ds_read_b128 v[84:87], v22 offset:2048
  ds_read_b128 v[88:91], v22 offset:4096
  ds_read_b128 v[92:95], v22 offset:6144
  ds_read_b128 v[96:99], v22 offset:8192
  ds_read_b128 v[100:103], v22 offset:10240
  ds_read_b128 v[104:107], v22 offset:12288
  ds_read_b128 v[108:111], v22 offset:14336
  v_pk_add_f32 v[146:147], v[146:147], v[148:149]
  v_pk_add_f32 v[150:151], v[150:151], v[152:153]
  v_pk_add_f32 v[154:155], v[154:155], v[156:157]
  v_pk_add_f32 v[146:147], v[146:147], v[150:151]
  v_pk_add_f32 v[154:155], v[154:155], v[158:159]
  v_pk_add_f32 v[146:147], v[146:147], v[154:155]
  v_pk_add_f32 v[72:73], v[72:73], v[146:147]
  v_mul_f32 v196, 0x3b000000, v72
  v_mul_f32 v21, 0x3b000000, v73
  v_fma_f32 v21, -v196, v196, v21
  v_max_f32 v21, 0, v21
  v_add_f32 v21, 0x3727c5ac, v21
  v_rsq_f32 v198, v21
  v_sub_f32 v197, 0, v196
  v_sub_f32 v196, 0, v196
  v_mov_b32 v199, v198
  s_waitcnt lgkmcnt(7)
  v_pk_add_f32 v[116:117], v[116:117], v[120:121]
  v_pk_add_f32 v[118:119], v[118:119], v[122:123]
  v_pk_add_f32 v[124:125], v[124:125], v[128:129]
  v_pk_add_f32 v[126:127], v[126:127], v[130:131]
  v_pk_add_f32 v[132:133], v[132:133], v[136:137]
  v_pk_add_f32 v[134:135], v[134:135], v[138:139]
  v_pk_add_f32 v[116:117], v[116:117], v[124:125]
  v_pk_add_f32 v[118:119], v[118:119], v[126:127]
  v_pk_add_f32 v[132:133], v[132:133], v[140:141]
  v_pk_add_f32 v[134:135], v[134:135], v[142:143]
  v_pk_add_f32 v[116:117], v[116:117], v[132:133]
  v_pk_add_f32 v[118:119], v[118:119], v[134:135]
  v_pk_add_f32 v[68:69], v[68:69], v[116:117]
  v_pk_add_f32 v[70:71], v[70:71], v[118:119]
  v_pk_fma_f32 v[64:65], v[196:197], v[68:69], v[64:65]
  v_pk_fma_f32 v[66:67], v[196:197], v[70:71], v[66:67]
  s_waitcnt lgkmcnt(0)
  v_pk_add_f32 v[84:85], v[84:85], v[88:89]
  v_pk_add_f32 v[86:87], v[86:87], v[90:91]
  v_pk_add_f32 v[92:93], v[92:93], v[96:97]
  v_pk_add_f32 v[94:95], v[94:95], v[98:99]
  v_pk_add_f32 v[100:101], v[100:101], v[104:105]
  v_pk_add_f32 v[102:103], v[102:103], v[106:107]
  v_pk_add_f32 v[84:85], v[84:85], v[92:93]
  v_pk_add_f32 v[86:87], v[86:87], v[94:95]
  v_pk_add_f32 v[100:101], v[100:101], v[108:109]
  v_pk_add_f32 v[102:103], v[102:103], v[110:111]
  v_pk_add_f32 v[84:85], v[84:85], v[100:101]
  v_pk_add_f32 v[86:87], v[86:87], v[102:103]
  v_pk_add_f32 v[64:65], v[64:65], v[84:85]
  v_pk_add_f32 v[66:67], v[66:67], v[86:87]
  v_pk_mul_f32 v[64:65], v[64:65], v[198:199]
  v_pk_mul_f32 v[66:67], v[66:67], v[198:199]
  v_cvt_pk_bf16_f32 v80, v64, v65
  v_cvt_pk_bf16_f32 v81, v66, v67
  v_mov_b32 v30, 0
  s_cmp_lg_u32 s56, 0
  s_cbranch_scc1 sequential_preLN__grouped_kv_mqa__mixer_gmlp__prompt_kernel_L14
  v_lshl_add_u32 v20, v9, 9, v20
  s_lshl_b32 s39, s39, 8
  s_add_u32 s40, s40, s39
  buffer_store_dwordx2 v[80:81], v20, s[8:11], s40 offen sc1
  v_dot2_f32_bf16 v30, v80, v80, v30
  v_dot2_f32_bf16 v30, v81, v81, v30
  s_nop 2
  v_mov_b32 v21, v30
  s_nop 1
  v_permlane16_swap_b32 v30, v21
  v_add_f32 v30, v30, v21
  v_mov_b32 v21, v30
  s_nop 1
  v_permlane32_swap_b32 v30, v21
  v_add_f32 v30, v30, v21
  s_nop 1
  v_max_f32_dpp v30, v30, v30 row_ror:1 row_mask:0xf bank_mask:0xf
  s_nop 1
  v_max_f32_dpp v30, v30, v30 row_ror:2 row_mask:0xf bank_mask:0xf
  s_nop 1
  v_max_f32_dpp v30, v30, v30 row_ror:4 row_mask:0xf bank_mask:0xf
  s_nop 1
  v_max_f32_dpp v30, v30, v30 row_ror:8 row_mask:0xf bank_mask:0xf
  s_branch sequential_preLN__grouped_kv_mqa__mixer_gmlp__prompt_kernel_L15
sequential_preLN__grouped_kv_mqa__mixer_gmlp__prompt_kernel_L14:
  v_lshlrev_b32 v17, 5, v10
  v_lshl_add_u32 v17, v24, 3, v17
  v_add_u32 v17, 131072, v17
  ds_write_b64 v17, v[80:81]
  v_lshlrev_b32 v17, 3, v1
  v_add_u32 v17, 131072, v17
  v_lshl_add_u32 v20, v9, 8, v20
  s_lshl_b32 s39, s39, 9
  s_add_u32 s40, s40, s39
  s_add_u32 s40, s40, 65536
  s_waitcnt lgkmcnt(0)
  ds_read_b64_tr_b16 v[82:83], v17
  s_waitcnt lgkmcnt(0)
  buffer_store_dwordx2 v[82:83], v20, s[8:11], s40 offen sc1
sequential_preLN__grouped_kv_mqa__mixer_gmlp__prompt_kernel_L15:
  s_waitcnt vmcnt(0)
  s_mov_b32 s48, 100000
sequential_preLN__grouped_kv_mqa__mixer_gmlp__prompt_kernel_np18:
  v_cmp_ne_u32 vcc, 0, v28
  s_cbranch_vccnz sequential_preLN__grouped_kv_mqa__mixer_gmlp__prompt_kernel_npx19
  s_sub_u32 s48, s48, 1
  s_cmp_eq_u32 s48, 0
  s_cbranch_scc1 sequential_preLN__grouped_kv_mqa__mixer_gmlp__prompt_kernel_npx19
  buffer_load_dwordx2 v[28:29], v15, s[64:67], 0 offen sc1
  s_waitcnt vmcnt(0)
  s_branch sequential_preLN__grouped_kv_mqa__mixer_gmlp__prompt_kernel_np18
sequential_preLN__grouped_kv_mqa__mixer_gmlp__prompt_kernel_npx19:
  s_lshl_b32 s41, s5, 7
  s_lshl_b32 s49, s6, 4
  s_add_u32 s41, s41, s49
  s_add_u32 s41, s41, 266240
  s_getreg_b32 s39, hwreg(HW_REG_XCC_ID, 0, 4)
  v_mov_b32 v31, s39
  s_mov_b64 exec, 1
  buffer_store_dwordx4 v[28:31], v15, s[8:11], s41 offen sc1
  s_mov_b64 exec, -1
  v_readfirstlane_b32 s78, v28
  v_readfirstlane_b32 s79, v29
  s_setprio 0
sequential_preLN__grouped_kv_mqa__mixer_gmlp__prompt_kernel_L13:
  s_waitcnt vmcnt(6)
  ds_read_b128 v[80:83], v180
  ds_read_b128 v[84:87], v181
  ds_read_b128 v[88:91], v182
  ds_read_b128 v[92:95], v183
  ds_read_b128 v[96:99], v184
  ds_read_b128 v[100:103], v185
  ds_read_b128 v[104:107], v186
  ds_read_b128 v[108:111], v187
  s_waitcnt lgkmcnt(7)
  v_dot2_f32_bf16 v64, v80, s28, 0
  v_dot2_f32_bf16 v65, v80, v80, 0
  v_dot2_f32_bf16 v66, v81, s28, 0
  v_dot2_f32_bf16 v67, v81, v81, 0
  v_dot2_f32_bf16 v68, v82, s28, 0
  v_dot2_f32_bf16 v69, v82, v82, 0
  v_dot2_f32_bf16 v70, v83, s28, 0
  v_dot2_f32_bf16 v71, v83, v83, 0
  s_waitcnt lgkmcnt(6)
  v_dot2_f32_bf16 v64, v84, s28, v64
  v_dot2_f32_bf16 v65, v84, v84, v65
  v_dot2_f32_bf16 v66, v85, s28, v66
  v_dot2_f32_bf16 v67, v85, v85, v67
  v_dot2_f32_bf16 v68, v86, s28, v68
  v_dot2_f32_bf16 v69, v86, v86, v69
  v_dot2_f32_bf16 v70, v87, s28, v70
  v_dot2_f32_bf16 v71, v87, v87, v71
  s_waitcnt lgkmcnt(5)
  v_dot2_f32_bf16 v64, v88, s28, v64
  v_dot2_f32_bf16 v65, v88, v88, v65
  v_dot2_f32_bf16 v66, v89, s28, v66
  v_dot2_f32_bf16 v67, v89, v89, v67
  v_dot2_f32_bf16 v68, v90, s28, v68
  v_dot2_f32_bf16 v69, v90, v90, v69
  v_dot2_f32_bf16 v70, v91, s28, v70
  v_dot2_f32_bf16 v71, v91, v91, v71
  s_waitcnt lgkmcnt(4)
  v_dot2_f32_bf16 v64, v92, s28, v64
  v_dot2_f32_bf16 v65, v92, v92, v65
  v_dot2_f32_bf16 v66, v93, s28, v66
  v_dot2_f32_bf16 v67, v93, v93, v67
  v_dot2_f32_bf16 v68, v94, s28, v68
  v_dot2_f32_bf16 v69, v94, v94, v69
  v_dot2_f32_bf16 v70, v95, s28, v70
  v_dot2_f32_bf16 v71, v95, v95, v71
  s_waitcnt lgkmcnt(3)
  v_dot2_f32_bf16 v64, v96, s28, v64
  v_dot2_f32_bf16 v65, v96, v96, v65
  v_dot2_f32_bf16 v66, v97, s28, v66
  v_dot2_f32_bf16 v67, v97, v97, v67
  v_dot2_f32_bf16 v68, v98, s28, v68
  v_dot2_f32_bf16 v69, v98, v98, v69
  v_dot2_f32_bf16 v70, v99, s28, v70
  v_dot2_f32_bf16 v71, v99, v99, v71
  s_waitcnt lgkmcnt(2)
  v_dot2_f32_bf16 v64, v100, s28, v64
  v_dot2_f32_bf16 v65, v100, v100, v65
  v_dot2_f32_bf16 v66, v101, s28, v66
  v_dot2_f32_bf16 v67, v101, v101, v67
  v_dot2_f32_bf16 v68, v102, s28, v68
  v_dot2_f32_bf16 v69, v102, v102, v69
  v_dot2_f32_bf16 v70, v103, s28, v70
  v_dot2_f32_bf16 v71, v103, v103, v71
  s_waitcnt lgkmcnt(1)
  v_dot2_f32_bf16 v64, v104, s28, v64
  v_dot2_f32_bf16 v65, v104, v104, v65
  v_dot2_f32_bf16 v66, v105, s28, v66
  v_dot2_f32_bf16 v67, v105, v105, v67
  v_dot2_f32_bf16 v68, v106, s28, v68
  v_dot2_f32_bf16 v69, v106, v106, v69
  v_dot2_f32_bf16 v70, v107, s28, v70
  v_dot2_f32_bf16 v71, v107, v107, v71
  s_waitcnt lgkmcnt(0)
  v_dot2_f32_bf16 v64, v108, s28, v64
  v_dot2_f32_bf16 v65, v108, v108, v65
  v_dot2_f32_bf16 v66, v109, s28, v66
  v_dot2_f32_bf16 v67, v109, v109, v67
  v_dot2_f32_bf16 v68, v110, s28, v68
  v_dot2_f32_bf16 v69, v110, v110, v69
  v_dot2_f32_bf16 v70, v111, s28, v70
  v_dot2_f32_bf16 v71, v111, v111, v71
  v_pk_add_f32 v[64:65], v[64:65], v[66:67]
  s_nop 1
  v_pk_add_f32 v[68:69], v[68:69], v[70:71]
  v_pk_add_f32 v[64:65], v[64:65], v[68:69]
  ds_write_b64 v188, v[64:65]
  s_waitcnt lgkmcnt(0)
  s_waitcnt vmcnt(0)
  s_barrier
  ds_read_b128 v[144:147], v176 offset:0
  ds_read_b128 v[148:151], v176 offset:16
  ds_read_b128 v[152:155], v176 offset:32
  ds_read_b128 v[156:159], v176 offset:48
  s_cmp_eq_u32 s4, 0
  s_cbranch_scc1 sequential_preLN__grouped_kv_mqa__mixer_gmlp__prompt_kernel_L20
  buffer_load_dwordx4 v[244:247], v252, s[60:63], s74 offen
  buffer_load_dwordx4 v[248:251], v252, s[60:63], s75 offen
sequential_preLN__grouped_kv_mqa__mixer_gmlp__prompt_kernel_L20:
  ds_read_b128 v[80:83], v11 offset:0
  ds_read_b64_tr_b16 v[112:113], v13 offset:0
  ds_read_b64_tr_b16 v[114:115], v13 offset:512
  ds_read_b128 v[84:87], v12 offset:0
  ds_read_b64_tr_b16 v[116:117], v13 offset:4096
  ds_read_b64_tr_b16 v[118:119], v13 offset:4608
  ds_read_b128 v[88:91], v11 offset:8192
  ds_read_b64_tr_b16 v[120:121], v13 offset:8192
  ds_read_b64_tr_b16 v[122:123], v13 offset:8704
  ds_read_b128 v[92:95], v12 offset:8192
  ds_read_b64_tr_b16 v[124:125], v13 offset:12288
  ds_read_b64_tr_b16 v[126:127], v13 offset:12800
  ds_read_b128 v[96:99], v11 offset:16384
  ds_read_b64_tr_b16 v[128:129], v13 offset:16384
  ds_read_b64_tr_b16 v[130:131], v13 offset:16896
  s_waitcnt lgkmcnt(12)
  ds_read_b128 v[100:103], v12 offset:16384
  ds_read_b64_tr_b16 v[132:133], v13 offset:20480
  ds_read_b64_tr_b16 v[134:135], v13 offset:20992
  v_mfma_f32_32x32x16_bf16 v[48:63], v[112:115], v[80:83], 0
  v_dot2_f32_bf16 v192, v112, s28, 0
  v_dot2_f32_bf16 v193, v113, s28, 0
  v_dot2_f32_bf16 v194, v114, s28, 0
  v_dot2_f32_bf16 v195, v115, s28, 0
  s_waitcnt lgkmcnt(12)
  ds_read_b128 v[104:107], v11 offset:24576
  ds_read_b64_tr_b16 v[136:137], v13 offset:24576
  ds_read_b64_tr_b16 v[138:139], v13 offset:25088
  v_mfma_f32_32x32x16_bf16 v[48:63], v[116:119], v[84:87], v[48:63]
  v_dot2_f32_bf16 v192, v116, s28, v192
  v_dot2_f32_bf16 v193, v117, s28, v193
  v_dot2_f32_bf16 v194, v118, s28, v194
  v_dot2_f32_bf16 v195, v119, s28, v195
  s_waitcnt lgkmcnt(12)
  ds_read_b128 v[108:111], v12 offset:24576
  ds_read_b64_tr_b16 v[140:141], v13 offset:28672
  ds_read_b64_tr_b16 v[142:143], v13 offset:29184
  v_pk_add_f32 v[144:145], v[144:145], v[146:147]
  v_mfma_f32_32x32x16_bf16 v[48:63], v[120:123], v[88:91], v[48:63]
  v_dot2_f32_bf16 v192, v120, s28, v192
  v_dot2_f32_bf16 v193, v121, s28, v193
  v_pk_add_f32 v[148:149], v[148:149], v[150:151]
  v_dot2_f32_bf16 v194, v122, s28, v194
  v_dot2_f32_bf16 v195, v123, s28, v195
  s_waitcnt lgkmcnt(12)
  v_pk_add_f32 v[152:153], v[152:153], v[154:155]
  ds_read_b128 v[80:83], v11 offset:32768
  ds_read_b64_tr_b16 v[112:113], v13 offset:32768
  ds_read_b64_tr_b16 v[114:115], v13 offset:33280
  v_pk_add_f32 v[156:157], v[156:157], v[158:159]
  v_mfma_f32_32x32x16_bf16 v[48:63], v[124:127], v[92:95], v[48:63]
  v_dot2_f32_bf16 v192, v124, s28, v192
  v_dot2_f32_bf16 v193, v125, s28, v193
  v_pk_add_f32 v[144:145], v[144:145], v[148:149]
  v_dot2_f32_bf16 v194, v126, s28, v194
  v_dot2_f32_bf16 v195, v127, s28, v195
  s_waitcnt lgkmcnt(12)
  v_pk_add_f32 v[152:153], v[152:153], v[156:157]
  ds_read_b128 v[84:87], v12 offset:32768
  ds_read_b64_tr_b16 v[116:117], v13 offset:36864
  ds_read_b64_tr_b16 v[118:119], v13 offset:37376
  v_mfma_f32_32x32x16_bf16 v[48:63], v[128:131], v[96:99], v[48:63]
  v_pk_add_f32 v[144:145], v[144:145], v[152:153]
  v_dot2_f32_bf16 v192, v128, s28, v192
  v_dot2_f32_bf16 v193, v129, s28, v193
  v_dot2_f32_bf16 v194, v130, s28, v194
  v_mul_f32 v196, 0x3b000000, v144
  v_dot2_f32_bf16 v195, v131, s28, v195
  s_waitcnt lgkmcnt(12)
  ds_read_b128 v[88:91], v11 offset:40960
  v_mul_f32 v20, 0x3b000000, v145
  ds_read_b64_tr_b16 v[120:121], v13 offset:40960
  ds_read_b64_tr_b16 v[122:123], v13 offset:41472
  v_mfma_f32_32x32x16_bf16 v[48:63], v[132:135], v[100:103], v[48:63]
  v_fma_f32 v20, -v196, v196, v20
  v_dot2_f32_bf16 v192, v132, s28, v192
  v_dot2_f32_bf16 v193, v133, s28, v193
  v_dot2_f32_bf16 v194, v134, s28, v194
  v_max_f32 v20, 0, v20
  v_dot2_f32_bf16 v195, v135, s28, v195
  s_waitcnt lgkmcnt(12)
  ds_read_b128 v[92:95], v12 offset:40960
  v_add_f32 v20, 0x3727c5ac, v20
  ds_read_b64_tr_b16 v[124:125], v13 offset:45056
  ds_read_b64_tr_b16 v[126:127], v13 offset:45568
  v_mfma_f32_32x32x16_bf16 v[48:63], v[136:139], v[104:107], v[48:63]
  v_dot2_f32_bf16 v192, v136, s28, v192
  v_rsq_f32 v198, v20
  v_dot2_f32_bf16 v193, v137, s28, v193
  v_dot2_f32_bf16 v194, v138, s28, v194
  v_dot2_f32_bf16 v195, v139, s28, v195
  v_mul_f32 v198, 0x3eb8aa3b, v198
  s_waitcnt lgkmcnt(12)
  ds_read_b128 v[96:99], v11 offset:49152
  ds_read_b64_tr_b16 v[128:129], v13 offset:49152
  v_sub_f32 v197, 0, v196
  ds_read_b64_tr_b16 v[130:131], v13 offset:49664
  v_mfma_f32_32x32x16_bf16 v[48:63], v[140:143], v[108:111], v[48:63]
  v_dot2_f32_bf16 v192, v140, s28, v192
  v_sub_f32 v196, 0, v196
  v_dot2_f32_bf16 v193, v141, s28, v193
  v_dot2_f32_bf16 v194, v142, s28, v194
  v_dot2_f32_bf16 v195, v143, s28, v195
  v_mov_b32 v199, v198
  s_waitcnt lgkmcnt(12)
  ds_read_b128 v[100:103], v12 offset:49152
  ds_read_b64_tr_b16 v[132:133], v13 offset:53248
  s_cmp_lg_u32 s4, 0
  s_cbranch_scc1 sequential_preLN__grouped_kv_mqa__mixer_gmlp__prompt_kernel_L21
  s_mov_b32 s39, 266240
  buffer_load_dwordx4 v[160:163], v2, s[8:11], s39 offen offset:0 sc1
  buffer_load_dwordx4 v[164:167], v2, s[8:11], s39 offen offset:1024 sc1
  buffer_load_dwordx4 v[168:171], v2, s[8:11], s39 offen offset:2048 sc1
  buffer_load_dwordx4 v[172:175], v2, s[8:11], s39 offen offset:3072 sc1
sequential_preLN__grouped_kv_mqa__mixer_gmlp__prompt_kernel_L21:
  ds_read_b64_tr_b16 v[134:135], v13 offset:53760
  v_mfma_f32_32x32x16_bf16 v[48:63], v[112:115], v[80:83], v[48:63]
  v_dot2_f32_bf16 v192, v112, s28, v192
  v_dot2_f32_bf16 v193, v113, s28, v193
  v_dot2_f32_bf16 v194, v114, s28, v194
  v_dot2_f32_bf16 v195, v115, s28, v195
  s_waitcnt lgkmcnt(12)
  ds_read_b128 v[104:107], v11 offset:57344
  ds_read_b64_tr_b16 v[136:137], v13 offset:57344
  ds_read_b64_tr_b16 v[138:139], v13 offset:57856
  v_mfma_f32_32x32x16_bf16 v[48:63], v[116:119], v[84:87], v[48:63]
  v_dot2_f32_bf16 v192, v116, s28, v192
  v_dot2_f32_bf16 v193, v117, s28, v193
  v_dot2_f32_bf16 v194, v118, s28, v194
  v_dot2_f32_bf16 v195, v119, s28, v195
  s_waitcnt lgkmcnt(12)
  ds_read_b128 v[108:111], v12 offset:57344
  ds_read_b64_tr_b16 v[140:141], v13 offset:61440
  ds_read_b64_tr_b16 v[142:143], v13 offset:61952
  v_mfma_f32_32x32x16_bf16 v[48:63], v[120:123], v[88:91], v[48:63]
  v_dot2_f32_bf16 v192, v120, s28, v192
  v_dot2_f32_bf16 v193, v121, s28, v193
  v_dot2_f32_bf16 v194, v122, s28, v194
  v_dot2_f32_bf16 v195, v123, s28, v195
  s_waitcnt lgkmcnt(12)
  v_mfma_f32_32x32x16_bf16 v[48:63], v[124:127], v[92:95], v[48:63]
  v_dot2_f32_bf16 v192, v124, s28, v192
  v_dot2_f32_bf16 v193, v125, s28, v193
  v_dot2_f32_bf16 v194, v126, s28, v194
  v_dot2_f32_bf16 v195, v127, s28, v195
  s_waitcnt lgkmcnt(9)
  v_mfma_f32_32x32x16_bf16 v[48:63], v[128:131], v[96:99], v[48:63]
  v_dot2_f32_bf16 v192, v128, s28, v192
  v_dot2_f32_bf16 v193, v129, s28, v193
  v_dot2_f32_bf16 v194, v130, s28, v194
  v_dot2_f32_bf16 v195, v131, s28, v195
  s_waitcnt lgkmcnt(6)
  v_mfma_f32_32x32x16_bf16 v[48:63], v[132:135], v[100:103], v[48:63]
  v_dot2_f32_bf16 v192, v132, s28, v192
  v_dot2_f32_bf16 v193, v133, s28, v193
  v_dot2_f32_bf16 v194, v134, s28, v194
  v_dot2_f32_bf16 v195, v135, s28, v195
  s_waitcnt lgkmcnt(3)
  v_mfma_f32_32x32x16_bf16 v[48:63], v[136:139], v[104:107], v[48:63]
  v_dot2_f32_bf16 v192, v136, s28, v192
  v_dot2_f32_bf16 v193, v137, s28, v193
  v_dot2_f32_bf16 v194, v138, s28, v194
  v_dot2_f32_bf16 v195, v139, s28, v195
  s_waitcnt lgkmcnt(0)
  v_mfma_f32_32x32x16_bf16 v[48:63], v[140:143], v[108:111], v[48:63]
  v_dot2_f32_bf16 v192, v140, s28, v192
  v_dot2_f32_bf16 v193, v141, s28, v193
  v_dot2_f32_bf16 v194, v142, s28, v194
  v_dot2_f32_bf16 v195, v143, s28, v195
  s_nop 2
  v_pk_add_f32 v[32:33], v[192:193], v[194:195]
  v_add_f32 v32, v32, v33
  v_mov_b32 v20, v32
  s_nop 1
  v_permlane32_swap_b32 v32, v20
  v_add_f32 v32, v32, v20
  ds_write_b32 v40, v32
  s_cmp_eq_u32 s31, 0
  s_cbranch_scc1 sequential_preLN__grouped_kv_mqa__mixer_gmlp__prompt_kernel_L22
  ds_write_b128 v177, v[48:51]
  ds_write_b128 v177, v[52:55] offset:1024
  v_mov_b32 v48, v56
  v_mov_b32 v49, v57
  v_mov_b32 v50, v58
  v_mov_b32 v51, v59
  v_mov_b32 v52, v60
  v_mov_b32 v53, v61
  v_mov_b32 v54, v62
  v_mov_b32 v55, v63
  s_branch sequential_preLN__grouped_kv_mqa__mixer_gmlp__prompt_kernel_L23
sequential_preLN__grouped_kv_mqa__mixer_gmlp__prompt_kernel_L22:
  ds_write_b128 v177, v[56:59]
  ds_write_b128 v177, v[60:63] offset:1024
sequential_preLN__grouped_kv_mqa__mixer_gmlp__prompt_kernel_L23:
  v_mov_b32 v21, 153600
  s_cmp_lg_u32 s4, 0
  s_cbranch_scc1 sequential_preLN__grouped_kv_mqa__mixer_gmlp__prompt_kernel_L24
  s_waitcnt vmcnt(0)
  v_xor_b32 v160, s78, v160
  v_xor_b32 v161, s79, v161
  v_xor_b32 v164, s78, v164
  v_xor_b32 v165, s79, v165
  v_xor_b32 v168, s78, v168
  v_xor_b32 v169, s79, v169
  v_xor_b32 v172, s78, v172
  v_xor_b32 v173, s79, v173
  v_or3_b32 v160, v160, v161, v164
  v_or3_b32 v161, v165, v168, v169
  v_or3_b32 v160, v160, v172, v173
  v_or_b32 v160, v160, v161
  v_cmp_ne_u32 vcc, 0, v160
  buffer_load_dwordx4 v[244:247], v252, s[60:63], s74 offen
  buffer_load_dwordx4 v[248:251], v252, s[60:63], s75 offen
  s_cbranch_vccz sequential_preLN__grouped_kv_mqa__mixer_gmlp__prompt_kernel_L25
  v_mov_b32 v163, 0
  ds_write_b64 v21, v[162:163]
  s_branch sequential_preLN__grouped_kv_mqa__mixer_gmlp__prompt_kernel_L24
sequential_preLN__grouped_kv_mqa__mixer_gmlp__prompt_kernel_L25:
  v_max_f32 v162, v162, v166
  v_max3_f32 v162, v162, v170, v174
  s_nop 1
  v_max_f32_dpp v162, v162, v162 row_ror:1 row_mask:0xf bank_mask:0xf
  s_nop 1
  v_max_f32_dpp v162, v162, v162 row_ror:2 row_mask:0xf bank_mask:0xf
  s_nop 1
  v_max_f32_dpp v162, v162, v162 row_ror:4 row_mask:0xf bank_mask:0xf
  s_nop 1
  v_max_f32_dpp v162, v162, v162 row_ror:8 row_mask:0xf bank_mask:0xf
  v_mov_b32 v160, v162
  s_nop 1
  v_permlane16_swap_b32 v162, v160
  v_max_f32 v162, v162, v160
  v_mov_b32 v160, v162
  s_nop 1
  v_permlane32_swap_b32 v162, v160
  v_max_f32 v162, v162, v160
  v_mov_b32 v163, 1
  v_mov_b32 v160, 153600
  ds_write_b64 v160, v[162:163]
sequential_preLN__grouped_kv_mqa__mixer_gmlp__prompt_kernel_L24:
  s_waitcnt lgkmcnt(0)
  s_barrier
  ds_read_b64 v[30:31], v21
  ds_read_b128 v[112:115], v41 offset:0
  ds_read_b128 v[116:119], v41 offset:16
  ds_read_b128 v[120:123], v41 offset:256
  ds_read_b128 v[124:127], v41 offset:272
  ds_read_b128 v[80:83], v178 offset:0
  ds_read_b128 v[84:87], v178 offset:1024
  s_waitcnt lgkmcnt(6)
  v_readfirstlane_b32 s88, v31
  s_nop 0
  s_cmp_eq_u32 s88, 0
  s_cbranch_scc1 sequential_preLN__grouped_kv_mqa__mixer_gmlp__prompt_kernel_L26
  s_add_u32 s36, s89, 0
  s_add_u32 m0, s89, 0
  s_nop 0
  buffer_load_dwordx4 v2, s[8:11], s36 offen sc1 lds
  s_add_u32 s36, s89, 65536
  s_add_u32 m0, s89, 98304
  s_nop 0
  buffer_load_dwordx4 v2, s[8:11], s36 offen sc1 lds
  s_add_u32 s36, s89, 4096
  s_add_u32 m0, s89, 4096
  s_nop 0
  buffer_load_dwordx4 v2, s[8:11], s36 offen sc1 lds
  s_add_u32 s36, s89, 69632
  s_add_u32 m0, s89, 102400
  s_nop 0
  buffer_load_dwordx4 v2, s[8:11], s36 offen sc1 lds
sequential_preLN__grouped_kv_mqa__mixer_gmlp__prompt_kernel_L26:
  s_waitcnt lgkmcnt(2)
  v_pk_add_f32 v[112:113], v[112:113], v[120:121]
  v_pk_add_f32 v[114:115], v[114:115], v[122:123]
  v_pk_add_f32 v[116:117], v[116:117], v[124:125]
  v_pk_add_f32 v[118:119], v[118:119], v[126:127]
  v_pk_fma_f32 v[48:49], v[196:197], v[112:113], v[48:49]
  v_pk_fma_f32 v[50:51], v[196:197], v[114:115], v[50:51]
  v_pk_fma_f32 v[52:53], v[196:197], v[116:117], v[52:53]
  v_pk_fma_f32 v[54:55], v[196:197], v[118:119], v[54:55]
  s_waitcnt lgkmcnt(0)
  v_pk_add_f32 v[48:49], v[48:49], v[80:81]
  v_pk_add_f32 v[50:51], v[50:51], v[82:83]
  v_pk_add_f32 v[52:53], v[52:53], v[84:85]
  v_pk_add_f32 v[54:55], v[54:55], v[86:87]
  v_pk_mul_f32 v[48:49], v[48:49], v[198:199]
  v_pk_mul_f32 v[50:51], v[50:51], v[198:199]
  v_pk_mul_f32 v[52:53], v[52:53], v[198:199]
  v_pk_mul_f32 v[54:55], v[54:55], v[198:199]
  v_mov_b32 v11, v200
  v_mov_b32 v12, v201
  v_mov_b32 v13, v202
  v_mov_b32 v14, v30
  v_cvt_pk_bf16_f32 v16, v48, v49
  v_cvt_pk_bf16_f32 v17, v50, v51
  v_cvt_pk_bf16_f32 v18, v52, v53
  v_cvt_pk_bf16_f32 v19, v54, v55
  s_lshl_b32 s39, s31, 12
  v_add_u32 v40, s39, v42
  ds_write_b128 v40, v[16:19]
  v_mov_b32 v28, v6
  v_mov_b32 v29, v6
  v_mov_b32 v30, v6
  v_mov_b32 v31, v6
  v_mov_b32 v32, v6
  v_mov_b32 v33, v6
  v_mov_b32 v34, v6
  v_mov_b32 v35, v6
  v_dot2_f32_bf16 v192, v16, v16, 0
  v_dot2_f32_bf16 v193, v17, v17, 0
  v_dot2_f32_bf16 v194, v18, v18, 0
  v_dot2_f32_bf16 v195, v19, v19, 0
  s_nop 2
  v_pk_add_f32 v[192:193], v[192:193], v[194:195]
  v_add_f32 v6, v192, v193
  v_mov_b32 v38, v6
  s_nop 1
  v_permlane32_swap_b32 v6, v38
  v_add_f32 v6, v6, v38
  s_nop 1
  v_max_f32_dpp v6, v6, v6 row_ror:1 row_mask:0xf bank_mask:0xf
  s_nop 1
  v_max_f32_dpp v6, v6, v6 row_ror:2 row_mask:0xf bank_mask:0xf
  s_nop 1
  v_max_f32_dpp v6, v6, v6 row_ror:4 row_mask:0xf bank_mask:0xf
  s_nop 1
  v_max_f32_dpp v6, v6, v6 row_ror:8 row_mask:0xf bank_mask:0xf
  v_mov_b32 v38, v6
  s_nop 1
  v_permlane16_swap_b32 v6, v38
  v_max_f32 v6, v6, v38
  s_lshl_b32 s39, s31, 4
  v_add_u32 v40, s39, v43
  ds_write_b32 v40, v6
  s_cmp_lg_u32 s88, 0
  s_cbranch_scc1 sequential_preLN__grouped_kv_mqa__mixer_gmlp__prompt_kernel_L27
  s_cmp_lg_u32 s4, 0
  s_cbranch_scc1 sequential_preLN__grouped_kv_mqa__mixer_gmlp__prompt_kernel_L30
  s_mov_b32 s48, 100000
sequential_preLN__grouped_kv_mqa__mixer_gmlp__prompt_kernel_p028:
  s_mov_b32 s39, 266240
  buffer_load_dwordx4 v[160:163], v2, s[8:11], s39 offen offset:0 sc1
  buffer_load_dwordx4 v[164:167], v2, s[8:11], s39 offen offset:1024 sc1
  buffer_load_dwordx4 v[168:171], v2, s[8:11], s39 offen offset:2048 sc1
  buffer_load_dwordx4 v[172:175], v2, s[8:11], s39 offen offset:3072 sc1
  s_waitcnt vmcnt(0)
  v_xor_b32 v160, s78, v160
  v_xor_b32 v161, s79, v161
  v_xor_b32 v164, s78, v164
  v_xor_b32 v165, s79, v165
  v_xor_b32 v168, s78, v168
  v_xor_b32 v169, s79, v169
  v_xor_b32 v172, s78, v172
  v_xor_b32 v173, s79, v173
  v_or3_b32 v160, v160, v161, v164
  v_or3_b32 v161, v165, v168, v169
  v_or3_b32 v160, v160, v172, v173
  v_or_b32 v160, v160, v161
  v_cmp_ne_u32 vcc, 0, v160
  s_cbranch_vccz sequential_preLN__grouped_kv_mqa__mixer_gmlp__prompt_kernel_p0x29
  s_sub_u32 s48, s48, 1
  s_sleep 4
  s_cmp_lg_u32 s48, 0
  s_cbranch_scc1 sequential_preLN__grouped_kv_mqa__mixer_gmlp__prompt_kernel_p028
sequential_preLN__grouped_kv_mqa__mixer_gmlp__prompt_kernel_p0x29:
  v_max_f32 v162, v162, v166
  v_max3_f32 v162, v162, v170, v174
  s_nop 1
  v_max_f32_dpp v162, v162, v162 row_ror:1 row_mask:0xf bank_mask:0xf
  s_nop 1
  v_max_f32_dpp v162, v162, v162 row_ror:2 row_mask:0xf bank_mask:0xf
  s_nop 1
  v_max_f32_dpp v162, v162, v162 row_ror:4 row_mask:0xf bank_mask:0xf
  s_nop 1
  v_max_f32_dpp v162, v162, v162 row_ror:8 row_mask:0xf bank_mask:0xf
  v_mov_b32 v160, v162
  s_nop 1
  v_permlane16_swap_b32 v162, v160
  v_max_f32 v162, v162, v160
  v_mov_b32 v160, v162
  s_nop 1
  v_permlane32_swap_b32 v162, v160
  v_max_f32 v162, v162, v160
  v_mov_b32 v163, 1
  v_mov_b32 v160, 153600
  ds_write_b64 v160, v[162:163]
  s_waitcnt lgkmcnt(0)
sequential_preLN__grouped_kv_mqa__mixer_gmlp__prompt_kernel_L30:
  s_barrier
  s_add_u32 s36, s89, 0
  s_add_u32 m0, s89, 0
  s_nop 0
  buffer_load_dwordx4 v2, s[8:11], s36 offen sc1 lds
  s_add_u32 s36, s89, 65536
  s_add_u32 m0, s89, 98304
  s_nop 0
  buffer_load_dwordx4 v2, s[8:11], s36 offen sc1 lds
  s_add_u32 s36, s89, 4096
  s_add_u32 m0, s89, 4096
  s_nop 0
  buffer_load_dwordx4 v2, s[8:11], s36 offen sc1 lds
  s_add_u32 s36, s89, 69632
  s_add_u32 m0, s89, 102400
  s_nop 0
  buffer_load_dwordx4 v2, s[8:11], s36 offen sc1 lds
  v_mov_b32 v14, 153600
  ds_read_b32 v14, v14
  s_waitcnt lgkmcnt(0)
sequential_preLN__grouped_kv_mqa__mixer_gmlp__prompt_kernel_L27:
  buffer_load_dwordx4 v[44:47], v7, s[12:15], s52 offen
  s_lshl_b32 s39, s5, 7
  s_add_u32 s39, s39, 266252
  v_and_b32 v38, 7, v1
  v_lshlrev_b32 v38, 4, v38
  buffer_load_dword v254, v38, s[8:11], s39 offen sc1
  s_waitcnt lgkmcnt(0)
  s_waitcnt vmcnt(2)
  s_barrier
  ds_read2_b32 v[38:39], v43 offset0:0 offset1:4
  ds_read_b128 v[16:19], v42
  ds_read_b128 v[24:27], v4
  ds_read_b128 v[20:23], v42 offset:4096
  s_mov_b64 exec, s[44:45]
  ds_read_b128 v[28:31], v5
  s_mov_b64 exec, -1
  v_mov_b32 v6, 0x457a0000
  s_waitcnt lgkmcnt(4)
  v_max_f32 v38, v38, v39
  v_mul_f32 v38, v38, v14
  v_cmp_nle_f32 vcc, v38, v6
  s_cbranch_vccnz sequential_preLN__grouped_kv_mqa__mixer_gmlp__prompt_kernel_slow31
  s_waitcnt lgkmcnt(2)
  v_mfma_f32_32x32x16_bf16 v[48:63], v[24:27], v[16:19], 0
  s_waitcnt lgkmcnt(0)
  s_and_b32 s90, s4, 3
  s_xor_b32 s90, s90, s31
  s_and_b32 s91, s90, 1
  s_mov_b32 s39, 0x110b0600
  s_mov_b32 s40, 0x26211c16
  s_cmp_lt_u32 s6, 4
  s_cselect_b32 s39, s39, s40
  s_and_b32 s40, s6, 3
  s_lshl_b32 s40, s40, 3
  s_lshr_b32 s39, s39, s40
  s_and_b32 s95, s39, 0xff
  s_lshr_b32 s96, 21, s6
  s_and_b32 s96, s96, 1
  s_and_b32 s97, s30, s96
  s_mul_i32 s39, s90, 3
  s_add_u32 s39, s39, 1
  s_lshr_b32 s93, s39, 1
  s_sub_u32 s39, s93, s96
  s_cmp_eq_u32 s39, 5
  s_cselect_b32 s92, 1073741824, 0
  s_lshr_b32 s40, s90, 1
  s_mul_i32 s40, s40, 3
  s_add_u32 s94, s40, 1
  s_setprio 3
  v_mfma_f32_32x32x16_bf16 v[64:79], v[24:27], v[20:23], 0
  v_exp_f32 v48, v48
  v_exp_f32 v49, v49
  v_exp_f32 v50, v50
  v_exp_f32 v51, v51
  ds_read_b128 v[24:27], v4 offset:1024
  s_mov_b64 exec, s[44:45]
  ds_read_b128 v[32:35], v5 offset:512
  ds_read_b128 v[240:243], v5 offset:1024
  s_mov_b64 exec, -1
  v_cvt_pk_bf16_f32 v36, v48, v49
  v_exp_f32 v52, v52
  v_exp_f32 v53, v53
  v_cvt_pk_bf16_f32 v37, v50, v51
  v_exp_f32 v54, v54
  v_exp_f32 v55, v55
  v_cvt_pk_bf16_f32 v38, v52, v53
  s_add_u32 s36, s89, 8192
  s_add_u32 m0, s89, 8192
  s_nop 0
  buffer_load_dwordx4 v2, s[8:11], s36 offen sc1 lds
  v_exp_f32 v56, v56
  v_exp_f32 v57, v57
  v_cvt_pk_bf16_f32 v39, v54, v55
  v_exp_f32 v58, v58
  v_exp_f32 v59, v59
  v_mfma_f32_32x32x16_bf16 v[80:95], v[28:31], v[36:39], 0
  v_cvt_pk_bf16_f32 v40, v56, v57
  v_exp_f32 v60, v60
  v_exp_f32 v61, v61
  v_cvt_pk_bf16_f32 v41, v58, v59
  ds_write_b128 v13, v[244:247] offset:0
  ds_write_b128 v13, v[248:251] offset:1024
  v_exp_f32 v62, v62
  v_exp_f32 v63, v63
  v_cvt_pk_bf16_f32 v42, v60, v61
  v_cvt_pk_bf16_f32 v43, v62, v63
  s_waitcnt lgkmcnt(0)
  v_mfma_f32_32x32x16_bf16 v[48:63], v[24:27], v[16:19], 0
  v_exp_f32 v64, v64
  v_exp_f32 v65, v65
  v_exp_f32 v66, v66
  v_exp_f32 v67, v67
  v_mfma_f32_32x32x16_bf16 v[80:95], v[32:35], v[40:43], v[80:95]
  v_cvt_pk_bf16_f32 v36, v64, v65
  v_exp_f32 v68, v68
  v_exp_f32 v69, v69
  v_cvt_pk_bf16_f32 v37, v66, v67
  v_exp_f32 v70, v70
  v_exp_f32 v71, v71
  v_cvt_pk_bf16_f32 v38, v68, v69
  ds_read_b64_tr_b16 v[128:129], v11 offset:0
  ds_read_b64_tr_b16 v[130:131], v12 offset:0
  ds_read_b64_tr_b16 v[132:133], v11 offset:1024
  ds_read_b64_tr_b16 v[134:135], v12 offset:1024
  v_exp_f32 v72, v72
  v_exp_f32 v73, v73
  v_cvt_pk_bf16_f32 v39, v70, v71
  v_exp_f32 v74, v74
  v_exp_f32 v75, v75
  v_mfma_f32_32x32x16_bf16 v[96:111], v[28:31], v[36:39], 0
  v_cvt_pk_bf16_f32 v40, v72, v73
  v_exp_f32 v76, v76
  v_exp_f32 v77, v77
  v_cvt_pk_bf16_f32 v41, v74, v75
  s_add_u32 s36, s89, 73728
  s_add_u32 m0, s89, 106496
  s_nop 0
  buffer_load_dwordx4 v2, s[8:11], s36 offen sc1 lds
  v_exp_f32 v78, v78
  v_exp_f32 v79, v79
  v_cvt_pk_bf16_f32 v42, v76, v77
  v_cvt_pk_bf16_f32 v43, v78, v79
  s_setprio 2
  v_mfma_f32_32x32x16_bf16 v[64:79], v[24:27], v[20:23], 0
  v_exp_f32 v48, v48
  v_exp_f32 v49, v49
  v_exp_f32 v50, v50
  v_exp_f32 v51, v51
  v_mfma_f32_32x32x16_bf16 v[96:111], v[32:35], v[40:43], v[96:111]
  ds_read_b128 v[24:27], v4 offset:2048
  s_mov_b64 exec, s[44:45]
  ds_read_b128 v[32:35], v5 offset:1536
  ds_read_b128 v[28:31], v5 offset:2048
  s_mov_b64 exec, -1
  v_cvt_pk_bf16_f32 v36, v48, v49
  v_exp_f32 v52, v52
  v_exp_f32 v53, v53
  v_cvt_pk_bf16_f32 v37, v50, v51
  v_exp_f32 v54, v54
  v_exp_f32 v55, v55
  v_cvt_pk_bf16_f32 v38, v52, v53
  s_add_u32 s36, s89, 12288
  s_add_u32 m0, s89, 12288
  s_nop 0
  buffer_load_dwordx4 v2, s[8:11], s36 offen sc1 lds
  v_exp_f32 v56, v56
  v_exp_f32 v57, v57
  v_cvt_pk_bf16_f32 v39, v54, v55
  v_exp_f32 v58, v58
  v_exp_f32 v59, v59
  v_mfma_f32_32x32x16_bf16 v[80:95], v[240:243], v[36:39], v[80:95]
  v_cvt_pk_bf16_f32 v40, v56, v57
  v_exp_f32 v60, v60
  v_exp_f32 v61, v61
  v_cvt_pk_bf16_f32 v41, v58, v59
  s_add_u32 s36, s89, 77824
  s_add_u32 m0, s89, 110592
  s_nop 0
  buffer_load_dwordx4 v2, s[8:11], s36 offen sc1 lds
  v_exp_f32 v62, v62
  v_exp_f32 v63, v63
  v_cvt_pk_bf16_f32 v42, v60, v61
  v_cvt_pk_bf16_f32 v43, v62, v63
  s_waitcnt lgkmcnt(0)
  v_mfma_f32_32x32x16_bf16 v[48:63], v[24:27], v[16:19], 0
  v_exp_f32 v64, v64
  v_exp_f32 v65, v65
  v_exp_f32 v66, v66
  v_exp_f32 v67, v67
  v_mfma_f32_32x32x16_bf16 v[80:95], v[32:35], v[40:43], v[80:95]
  v_cvt_pk_bf16_f32 v36, v64, v65
  v_exp_f32 v68, v68
  v_exp_f32 v69, v69
  v_cvt_pk_bf16_f32 v37, v66, v67
  v_exp_f32 v70, v70
  v_exp_f32 v71, v71
  v_cvt_pk_bf16_f32 v38, v68, v69
  buffer_store_dwordx4 v[128:131], v2, s[8:11], s54 offen offset:0 sc1
  buffer_store_dwordx4 v[132:135], v2, s[8:11], s54 offen offset:1024 sc1
  s_cmp_lg_u32 s53, 2
  s_cbranch_scc1 sequential_preLN__grouped_kv_mqa__mixer_gmlp__prompt_kernel_L33
  v_dot2_f32_bf16 v140, v128, s28, 0
  v_dot2_f32_bf16 v141, v129, s28, 0
  v_dot2_f32_bf16 v142, v130, s28, 0
  v_dot2_f32_bf16 v143, v131, s28, 0
  v_dot2_f32_bf16 v140, v132, s28, v140
  v_dot2_f32_bf16 v141, v133, s28, v141
  v_dot2_f32_bf16 v142, v134, s28, v142
  v_dot2_f32_bf16 v143, v135, s28, v143
  v_lshlrev_b32 v137, 5, v10
  s_lshl_b32 s39, s4, 2
  s_add_u32 s39, s39, 82944
  v_add_u32 v137, s39, v137
  v_pk_add_f32 v[140:141], v[140:141], v[142:143]
  v_add_f32 v138, v140, v141
  v_mov_b32 v139, v138
  s_nop 1
  v_permlane32_swap_b32 v138, v139
  v_add_f32 v138, v138, v139
  v_mov_b32 v139, v138
  s_nop 1
  v_permlane16_swap_b32 v138, v139
  v_add_f32 v138, v138, v139
  ds_write_b32 v137, v138
sequential_preLN__grouped_kv_mqa__mixer_gmlp__prompt_kernel_L33:
  v_exp_f32 v72, v72
  v_exp_f32 v73, v73
  v_cvt_pk_bf16_f32 v39, v70, v71
  v_exp_f32 v74, v74
  v_exp_f32 v75, v75
  v_mfma_f32_32x32x16_bf16 v[96:111], v[240:243], v[36:39], v[96:111]
  v_cvt_pk_bf16_f32 v40, v72, v73
  v_exp_f32 v76, v76
  v_exp_f32 v77, v77
  v_cvt_pk_bf16_f32 v41, v74, v75
  s_add_u32 s36, s89, 16384
  s_add_u32 m0, s89, 16384
  s_nop 0
  buffer_load_dwordx4 v2, s[8:11], s36 offen sc1 lds
  v_exp_f32 v78, v78
  v_exp_f32 v79, v79
  v_cvt_pk_bf16_f32 v42, v76, v77
  v_cvt_pk_bf16_f32 v43, v78, v79
  s_setprio 1
  v_mfma_f32_32x32x16_bf16 v[64:79], v[24:27], v[20:23], 0
  v_exp_f32 v48, v48
  v_exp_f32 v49, v49
  v_exp_f32 v50, v50
  v_exp_f32 v51, v51
  v_mfma_f32_32x32x16_bf16 v[96:111], v[32:35], v[40:43], v[96:111]
  ds_read_b128 v[24:27], v4 offset:3072
  s_mov_b64 exec, s[44:45]
  ds_read_b128 v[32:35], v5 offset:2560
  ds_read_b128 v[240:243], v5 offset:3072
  s_mov_b64 exec, -1
  v_cvt_pk_bf16_f32 v36, v48, v49
  v_exp_f32 v52, v52
  v_exp_f32 v53, v53
  v_cvt_pk_bf16_f32 v37, v50, v51
  v_exp_f32 v54, v54
  v_exp_f32 v55, v55
  v_cvt_pk_bf16_f32 v38, v52, v53
  s_add_u32 s36, s89, 81920
  s_add_u32 m0, s89, 114688
  s_nop 0
  buffer_load_dwordx4 v2, s[8:11], s36 offen sc1 lds
  v_exp_f32 v56, v56
  v_exp_f32 v57, v57
  v_cvt_pk_bf16_f32 v39, v54, v55
  v_exp_f32 v58, v58
  v_exp_f32 v59, v59
  v_mfma_f32_32x32x16_bf16 v[80:95], v[28:31], v[36:39], v[80:95]
  v_cvt_pk_bf16_f32 v40, v56, v57
  v_exp_f32 v60, v60
  v_exp_f32 v61, v61
  v_cvt_pk_bf16_f32 v41, v58, v59
  s_add_u32 s36, s89, 20480
  s_add_u32 m0, s89, 20480
  s_nop 0
  buffer_load_dwordx4 v2, s[8:11], s36 offen sc1 lds
  v_exp_f32 v62, v62
  v_exp_f32 v63, v63
  v_cvt_pk_bf16_f32 v42, v60, v61
  v_cvt_pk_bf16_f32 v43, v62, v63
  s_waitcnt lgkmcnt(0)
  v_mfma_f32_32x32x16_bf16 v[48:63], v[24:27], v[16:19], 0
  v_exp_f32 v64, v64
  v_exp_f32 v65, v65
  v_exp_f32 v66, v66
  v_exp_f32 v67, v67
  v_mfma_f32_32x32x16_bf16 v[80:95], v[32:35], v[40:43], v[80:95]
  v_cvt_pk_bf16_f32 v36, v64, v65
  v_exp_f32 v68, v68
  v_exp_f32 v69, v69
  v_cvt_pk_bf16_f32 v37, v66, v67
  v_exp_f32 v70, v70
  v_exp_f32 v71, v71
  v_cvt_pk_bf16_f32 v38, v68, v69
  s_waitcnt vmcnt(9)
  v_readfirstlane_b32 s39, v254
  s_nop 1
  v_cmp_ne_u32 vcc, s39, v254
  s_nop 0
  s_cmp_eq_u64 vcc, 0
  s_cselect_b32 s68, 1, 0
  v_exp_f32 v72, v72
  v_exp_f32 v73, v73
  v_cvt_pk_bf16_f32 v39, v70, v71
  v_exp_f32 v74, v74
  v_exp_f32 v75, v75
  v_mfma_f32_32x32x16_bf16 v[96:111], v[28:31], v[36:39], v[96:111]
  v_cvt_pk_bf16_f32 v40, v72, v73
  v_exp_f32 v76, v76
  v_exp_f32 v77, v77
  v_cvt_pk_bf16_f32 v41, v74, v75
  s_add_u32 s36, s89, 86016
  s_add_u32 m0, s89, 118784
  s_nop 0
  buffer_load_dwordx4 v2, s[8:11], s36 offen sc1 lds
  v_exp_f32 v78, v78
  v_exp_f32 v79, v79
  v_cvt_pk_bf16_f32 v42, v76, v77
  v_cvt_pk_bf16_f32 v43, v78, v79
  s_setprio 0
  v_mfma_f32_32x32x16_bf16 v[64:79], v[24:27], v[20:23], 0
  v_exp_f32 v48, v48
  v_exp_f32 v49, v49
  v_exp_f32 v50, v50
  v_exp_f32 v51, v51
  v_mfma_f32_32x32x16_bf16 v[96:111], v[32:35], v[40:43], v[96:111]
  ds_read_b128 v[24:27], v4 offset:4096
  s_mov_b64 exec, s[44:45]
  ds_read_b128 v[32:35], v5 offset:3584
  ds_read_b128 v[28:31], v5 offset:4096
  s_mov_b64 exec, -1
  v_cvt_pk_bf16_f32 v36, v48, v49
  v_exp_f32 v52, v52
  v_exp_f32 v53, v53
  v_cvt_pk_bf16_f32 v37, v50, v51
  v_exp_f32 v54, v54
  v_exp_f32 v55, v55
  v_cvt_pk_bf16_f32 v38, v52, v53
  s_add_u32 s36, s89, 24576
  s_add_u32 m0, s89, 24576
  s_nop 0
  buffer_load_dwordx4 v2, s[8:11], s36 offen sc1 lds
  v_exp_f32 v56, v56
  v_exp_f32 v57, v57
  v_cvt_pk_bf16_f32 v39, v54, v55
  v_exp_f32 v58, v58
  v_exp_f32 v59, v59
  v_mfma_f32_32x32x16_bf16 v[80:95], v[240:243], v[36:39], v[80:95]
  v_cvt_pk_bf16_f32 v40, v56, v57
  v_exp_f32 v60, v60
  v_exp_f32 v61, v61
  v_cvt_pk_bf16_f32 v41, v58, v59
  s_add_u32 s36, s89, 90112
  s_add_u32 m0, s89, 122880
  s_nop 0
  buffer_load_dwordx4 v2, s[8:11], s36 offen sc1 lds
  v_exp_f32 v62, v62
  v_exp_f32 v63, v63
  v_cvt_pk_bf16_f32 v42, v60, v61
  v_cvt_pk_bf16_f32 v43, v62, v63
  s_waitcnt lgkmcnt(0)
  v_mfma_f32_32x32x16_bf16 v[48:63], v[24:27], v[16:19], 0
  v_exp_f32 v64, v64
  v_exp_f32 v65, v65
  v_exp_f32 v66, v66
  v_exp_f32 v67, v67
  v_mfma_f32_32x32x16_bf16 v[80:95], v[32:35], v[40:43], v[80:95]
  v_cvt_pk_bf16_f32 v36, v64, v65
  v_exp_f32 v68, v68
  v_exp_f32 v69, v69
  v_cvt_pk_bf16_f32 v37, v66, v67
  v_exp_f32 v70, v70
  v_exp_f32 v71, v71
  v_cvt_pk_bf16_f32 v38, v68, v69
  s_add_u32 s36, s89, 28672
  s_add_u32 m0, s89, 28672
  s_nop 0
  buffer_load_dwordx4 v2, s[8:11], s36 offen sc1 lds
  v_exp_f32 v72, v72
  v_exp_f32 v73, v73
  v_cvt_pk_bf16_f32 v39, v70, v71
  v_exp_f32 v74, v74
  v_exp_f32 v75, v75
  v_mfma_f32_32x32x16_bf16 v[96:111], v[240:243], v[36:39], v[96:111]
  v_cvt_pk_bf16_f32 v40, v72, v73
  v_exp_f32 v76, v76
  v_exp_f32 v77, v77
  v_cvt_pk_bf16_f32 v41, v74, v75
  s_add_u32 s36, s89, 94208
  s_add_u32 m0, s89, 126976
  s_nop 0
  buffer_load_dwordx4 v2, s[8:11], s36 offen sc1 lds
  v_exp_f32 v78, v78
  v_exp_f32 v79, v79
  v_cvt_pk_bf16_f32 v42, v76, v77
  v_cvt_pk_bf16_f32 v43, v78, v79
  s_barrier
  s_setprio 3
  v_mfma_f32_32x32x16_bf16 v[64:79], v[24:27], v[20:23], 0
  v_exp_f32 v48, v48
  v_exp_f32 v49, v49
  v_exp_f32 v50, v50
  v_exp_f32 v51, v51
  v_mfma_f32_32x32x16_bf16 v[96:111], v[32:35], v[40:43], v[96:111]
  ds_read_b128 v[24:27], v4 offset:5120
  s_mov_b64 exec, s[44:45]
  ds_read_b128 v[32:35], v5 offset:4608
  ds_read_b128 v[240:243], v5 offset:5120
  s_mov_b64 exec, -1
  v_cvt_pk_bf16_f32 v36, v48, v49
  v_exp_f32 v52, v52
  v_exp_f32 v53, v53
  v_cvt_pk_bf16_f32 v37, v50, v51
  v_exp_f32 v54, v54
  v_exp_f32 v55, v55
  v_cvt_pk_bf16_f32 v38, v52, v53
  s_cmp_lg_u32 s53, 2
  s_cbranch_scc1 sequential_preLN__grouped_kv_mqa__mixer_gmlp__prompt_kernel_L34
  s_cmp_lg_u32 s4, 7
  s_cbranch_scc1 sequential_preLN__grouped_kv_mqa__mixer_gmlp__prompt_kernel_L34
  v_lshlrev_b32 v137, 5, v10
  v_add_u32 v137, 82944, v137
  ds_read_b128 v[140:143], v137
  ds_read_b128 v[144:147], v137 offset:16
  v_lshlrev_b32 v137, 2, v10
  s_lshl_b32 s39, s2, 6
  s_add_u32 s39, s39, 655360
  s_waitcnt lgkmcnt(0)
  v_pk_add_f32 v[140:141], v[140:141], v[142:143]
  v_pk_add_f32 v[144:145], v[144:145], v[146:147]
  v_pk_add_f32 v[140:141], v[140:141], v[144:145]
  v_add_f32 v140, v140, v141
  buffer_store_dword v140, v137, s[8:11], s39 offen sc1
sequential_preLN__grouped_kv_mqa__mixer_gmlp__prompt_kernel_L34:
  v_exp_f32 v56, v56
  v_exp_f32 v57, v57
  v_cvt_pk_bf16_f32 v39, v54, v55
  v_exp_f32 v58, v58
  v_exp_f32 v59, v59
  v_mfma_f32_32x32x16_bf16 v[80:95], v[28:31], v[36:39], v[80:95]
  v_cvt_pk_bf16_f32 v40, v56, v57
  v_exp_f32 v60, v60
  v_exp_f32 v61, v61
  v_cvt_pk_bf16_f32 v41, v58, v59
  v_mov_b32 v248, -1
  v_mov_b32 v249, -1
  v_mov_b32 v250, -1
  v_mov_b32 v251, -1
  s_lshl_b32 s46, s5, 16
  s_lshl_b32 s49, s30, 15
  s_add_u32 s46, s46, s49
  s_lshl_b32 s49, s6, 12
  s_add_u32 s46, s46, s49
  s_lshl_b32 s49, s29, 11
  s_add_u32 s46, s46, s49
  s_lshl_b32 s49, s31, 10
  s_add_u32 s46, s46, s49
  s_add_u32 s46, s46, 1048576
  s_cmp_eq_u32 s68, 0
  s_cbranch_scc1 sequential_preLN__grouped_kv_mqa__mixer_gmlp__prompt_kernel_L35
  buffer_store_dwordx4 v[248:251], v2, s[8:11], s46 offen
  s_branch sequential_preLN__grouped_kv_mqa__mixer_gmlp__prompt_kernel_L36
sequential_preLN__grouped_kv_mqa__mixer_gmlp__prompt_kernel_L35:
  buffer_store_dwordx4 v[248:251], v2, s[8:11], s46 offen sc1
sequential_preLN__grouped_kv_mqa__mixer_gmlp__prompt_kernel_L36:
  v_exp_f32 v62, v62
  v_exp_f32 v63, v63
  v_cvt_pk_bf16_f32 v42, v60, v61
  v_cvt_pk_bf16_f32 v43, v62, v63
  s_waitcnt lgkmcnt(0)
  v_mfma_f32_32x32x16_bf16 v[48:63], v[24:27], v[16:19], 0
  v_exp_f32 v64, v64
  v_exp_f32 v65, v65
  v_exp_f32 v66, v66
  v_exp_f32 v67, v67
  v_mfma_f32_32x32x16_bf16 v[80:95], v[32:35], v[40:43], v[80:95]
  v_cvt_pk_bf16_f32 v36, v64, v65
  v_exp_f32 v68, v68
  v_exp_f32 v69, v69
  v_cvt_pk_bf16_f32 v37, v66, v67
  v_exp_f32 v70, v70
  v_exp_f32 v71, v71
  v_cvt_pk_bf16_f32 v38, v68, v69
  s_lshl_b32 s46, s5, 16
  s_lshl_b32 s49, s32, 14
  s_add_u32 s46, s46, s49
  s_lshl_b32 s49, s6, 11
  s_add_u32 s46, s46, s49
  s_lshl_b32 s49, s29, 10
  s_add_u32 s46, s46, s49
  s_add_u32 s46, s46, 3145728
  s_cmp_eq_u32 s68, 0
  s_cbranch_scc1 sequential_preLN__grouped_kv_mqa__mixer_gmlp__prompt_kernel_L37
  buffer_store_dwordx4 v[248:251], v2, s[8:11], s46 offen
  s_branch sequential_preLN__grouped_kv_mqa__mixer_gmlp__prompt_kernel_L38
sequential_preLN__grouped_kv_mqa__mixer_gmlp__prompt_kernel_L37:
  buffer_store_dwordx4 v[248:251], v2, s[8:11], s46 offen sc1
sequential_preLN__grouped_kv_mqa__mixer_gmlp__prompt_kernel_L38:
  v_exp_f32 v72, v72
  v_exp_f32 v73, v73
  v_cvt_pk_bf16_f32 v39, v70, v71
  v_exp_f32 v74, v74
  v_exp_f32 v75, v75
  v_mfma_f32_32x32x16_bf16 v[96:111], v[28:31], v[36:39], v[96:111]
  v_cvt_pk_bf16_f32 v40, v72, v73
  v_exp_f32 v76, v76
  v_exp_f32 v77, v77
  v_cvt_pk_bf16_f32 v41, v74, v75
  s_mul_i32 s46, s5, 90112
  s_mul_i32 s49, s29, 45056
  s_add_u32 s46, s46, s49
  s_lshl_b32 s49, s95, 10
  s_add_u32 s46, s46, s49
  s_lshl_b32 s49, s32, 10
  s_add_u32 s46, s46, s49
  s_add_u32 s46, s46, 8388608
  s_cmp_eq_u32 s68, 0
  s_cbranch_scc1 sequential_preLN__grouped_kv_mqa__mixer_gmlp__prompt_kernel_L39
  buffer_store_dwordx4 v[248:251], v2, s[8:11], s46 offen
  s_branch sequential_preLN__grouped_kv_mqa__mixer_gmlp__prompt_kernel_L40
sequential_preLN__grouped_kv_mqa__mixer_gmlp__prompt_kernel_L39:
  buffer_store_dwordx4 v[248:251], v2, s[8:11], s46 offen sc1
sequential_preLN__grouped_kv_mqa__mixer_gmlp__prompt_kernel_L40:
  v_exp_f32 v78, v78
  v_exp_f32 v79, v79
  v_cvt_pk_bf16_f32 v42, v76, v77
  v_cvt_pk_bf16_f32 v43, v78, v79
  s_setprio 2
  v_mfma_f32_32x32x16_bf16 v[64:79], v[24:27], v[20:23], 0
  v_exp_f32 v48, v48
  v_exp_f32 v49, v49
  v_exp_f32 v50, v50
  v_exp_f32 v51, v51
  v_mfma_f32_32x32x16_bf16 v[96:111], v[32:35], v[40:43], v[96:111]
  ds_read_b128 v[24:27], v4 offset:6144
  s_mov_b64 exec, s[44:45]
  ds_read_b128 v[32:35], v5 offset:5632
  ds_read_b128 v[28:31], v5 offset:6144
  s_mov_b64 exec, -1
  v_cvt_pk_bf16_f32 v36, v48, v49
  v_exp_f32 v52, v52
  v_exp_f32 v53, v53
  v_cvt_pk_bf16_f32 v37, v50, v51
  v_exp_f32 v54, v54
  v_exp_f32 v55, v55
  v_cvt_pk_bf16_f32 v38, v52, v53
  s_mul_i32 s46, s5, 90112
  s_mul_i32 s49, s29, 45056
  s_add_u32 s46, s46, s49
  s_lshl_b32 s49, s95, 10
  s_add_u32 s46, s46, s49
  s_lshl_b32 s49, s97, 10
  s_add_u32 s46, s46, s49
  s_add_u32 s46, s46, 8392704
  s_cmp_eq_u32 s68, 0
  s_cbranch_scc1 sequential_preLN__grouped_kv_mqa__mixer_gmlp__prompt_kernel_L41
  buffer_store_dwordx4 v[248:251], v2, s[8:11], s46 offen
  s_branch sequential_preLN__grouped_kv_mqa__mixer_gmlp__prompt_kernel_L42
sequential_preLN__grouped_kv_mqa__mixer_gmlp__prompt_kernel_L41:
  buffer_store_dwordx4 v[248:251], v2, s[8:11], s46 offen sc1
sequential_preLN__grouped_kv_mqa__mixer_gmlp__prompt_kernel_L42:
  v_exp_f32 v56, v56
  v_exp_f32 v57, v57
  v_cvt_pk_bf16_f32 v39, v54, v55
  v_exp_f32 v58, v58
  v_exp_f32 v59, v59
  v_mfma_f32_32x32x16_bf16 v[80:95], v[240:243], v[36:39], v[80:95]
  v_cvt_pk_bf16_f32 v40, v56, v57
  v_exp_f32 v60, v60
  v_exp_f32 v61, v61
  v_cvt_pk_bf16_f32 v41, v58, v59
  v_exp_f32 v62, v62
  v_exp_f32 v63, v63
  v_cvt_pk_bf16_f32 v42, v60, v61
  v_cvt_pk_bf16_f32 v43, v62, v63
  s_waitcnt lgkmcnt(0)
  v_mfma_f32_32x32x16_bf16 v[48:63], v[24:27], v[16:19], 0
  v_exp_f32 v64, v64
  v_exp_f32 v65, v65
  v_exp_f32 v66, v66
  v_exp_f32 v67, v67
  v_mfma_f32_32x32x16_bf16 v[80:95], v[32:35], v[40:43], v[80:95]
  v_cvt_pk_bf16_f32 v36, v64, v65
  v_exp_f32 v68, v68
  v_exp_f32 v69, v69
  v_cvt_pk_bf16_f32 v37, v66, v67
  v_exp_f32 v70, v70
  v_exp_f32 v71, v71
  v_cvt_pk_bf16_f32 v38, v68, v69
  v_exp_f32 v72, v72
  v_exp_f32 v73, v73
  v_cvt_pk_bf16_f32 v39, v70, v71
  v_exp_f32 v74, v74
  v_exp_f32 v75, v75
  v_mfma_f32_32x32x16_bf16 v[96:111], v[240:243], v[36:39], v[96:111]
  v_cvt_pk_bf16_f32 v40, v72, v73
  v_exp_f32 v76, v76
  v_exp_f32 v77, v77
  v_cvt_pk_bf16_f32 v41, v74, v75
  v_exp_f32 v78, v78
  v_exp_f32 v79, v79
  v_cvt_pk_bf16_f32 v42, v76, v77
  v_cvt_pk_bf16_f32 v43, v78, v79
  s_waitcnt vmcnt(0)
  s_barrier
  s_cmp_lg_u32 s4, 0
  s_cbranch_scc1 sequential_preLN__grouped_kv_mqa__mixer_gmlp__prompt_kernel_L43
  s_lshl_b32 s39, s2, 2
  s_add_u32 s39, s39, 263168
  v_mov_b32 v14, 1
  s_mov_b64 exec, 1
  buffer_store_dword v14, v15, s[8:11], s39 offen sc1
  s_mov_b64 exec, -1
sequential_preLN__grouped_kv_mqa__mixer_gmlp__prompt_kernel_L43:
  s_setprio 3
  v_mfma_f32_32x32x16_bf16 v[64:79], v[24:27], v[20:23], 0
  v_exp_f32 v48, v48
  v_exp_f32 v49, v49
  v_exp_f32 v50, v50
  v_exp_f32 v51, v51
  v_mfma_f32_32x32x16_bf16 v[96:111], v[32:35], v[40:43], v[96:111]
  ds_read_b128 v[24:27], v4 offset:7168
  s_mov_b64 exec, s[44:45]
  ds_read_b128 v[32:35], v5 offset:6656
  ds_read_b128 v[240:243], v5 offset:7168
  s_mov_b64 exec, -1
  v_cvt_pk_bf16_f32 v36, v48, v49
  v_exp_f32 v52, v52
  v_exp_f32 v53, v53
  v_cvt_pk_bf16_f32 v37, v50, v51
  v_exp_f32 v54, v54
  v_exp_f32 v55, v55
  v_cvt_pk_bf16_f32 v38, v52, v53
  v_exp_f32 v56, v56
  v_exp_f32 v57, v57
  v_cvt_pk_bf16_f32 v39, v54, v55
  v_exp_f32 v58, v58
  v_exp_f32 v59, v59
  v_mfma_f32_32x32x16_bf16 v[80:95], v[28:31], v[36:39], v[80:95]
  v_cvt_pk_bf16_f32 v40, v56, v57
  v_exp_f32 v60, v60
  v_exp_f32 v61, v61
  v_cvt_pk_bf16_f32 v41, v58, v59
  v_exp_f32 v62, v62
  v_exp_f32 v63, v63
  v_cvt_pk_bf16_f32 v42, v60, v61
  v_cvt_pk_bf16_f32 v43, v62, v63
  s_waitcnt lgkmcnt(0)
  v_mfma_f32_32x32x16_bf16 v[48:63], v[24:27], v[16:19], 0
  v_exp_f32 v64, v64
  v_exp_f32 v65, v65
  v_exp_f32 v66, v66
  v_exp_f32 v67, v67
  v_mfma_f32_32x32x16_bf16 v[80:95], v[32:35], v[40:43], v[80:95]
  v_cvt_pk_bf16_f32 v36, v64, v65
  v_exp_f32 v68, v68
  v_exp_f32 v69, v69
  v_cvt_pk_bf16_f32 v37, v66, v67
  v_exp_f32 v70, v70
  v_exp_f32 v71, v71
  v_cvt_pk_bf16_f32 v38, v68, v69
  v_exp_f32 v72, v72
  v_exp_f32 v73, v73
  v_cvt_pk_bf16_f32 v39, v70, v71
  v_exp_f32 v74, v74
  v_exp_f32 v75, v75
  v_mfma_f32_32x32x16_bf16 v[96:111], v[28:31], v[36:39], v[96:111]
  v_cvt_pk_bf16_f32 v40, v72, v73
  v_exp_f32 v76, v76
  v_exp_f32 v77, v77
  v_cvt_pk_bf16_f32 v41, v74, v75
  v_exp_f32 v78, v78
  v_exp_f32 v79, v79
  v_cvt_pk_bf16_f32 v42, v76, v77
  v_cvt_pk_bf16_f32 v43, v78, v79
  s_setprio 2
  v_mfma_f32_32x32x16_bf16 v[64:79], v[24:27], v[20:23], 0
  v_exp_f32 v48, v48
  v_exp_f32 v49, v49
  v_exp_f32 v50, v50
  v_exp_f32 v51, v51
  v_mfma_f32_32x32x16_bf16 v[96:111], v[32:35], v[40:43], v[96:111]
  ds_read_b128 v[24:27], v4 offset:8192
  s_mov_b64 exec, s[44:45]
  ds_read_b128 v[32:35], v5 offset:7680
  ds_read_b128 v[28:31], v5 offset:8192
  s_mov_b64 exec, -1
  v_cvt_pk_bf16_f32 v36, v48, v49
  v_exp_f32 v52, v52
  v_exp_f32 v53, v53
  v_cvt_pk_bf16_f32 v37, v50, v51
  v_exp_f32 v54, v54
  v_exp_f32 v55, v55
  v_cvt_pk_bf16_f32 v38, v52, v53
  v_exp_f32 v56, v56
  v_exp_f32 v57, v57
  v_cvt_pk_bf16_f32 v39, v54, v55
  v_exp_f32 v58, v58
  v_exp_f32 v59, v59
  v_mfma_f32_32x32x16_bf16 v[80:95], v[240:243], v[36:39], v[80:95]
  v_cvt_pk_bf16_f32 v40, v56, v57
  v_exp_f32 v60, v60
  v_exp_f32 v61, v61
  v_cvt_pk_bf16_f32 v41, v58, v59
  v_exp_f32 v62, v62
  v_exp_f32 v63, v63
  v_cvt_pk_bf16_f32 v42, v60, v61
  v_cvt_pk_bf16_f32 v43, v62, v63
  s_waitcnt lgkmcnt(0)
  v_mfma_f32_32x32x16_bf16 v[48:63], v[24:27], v[16:19], 0
  v_exp_f32 v64, v64
  v_exp_f32 v65, v65
  v_exp_f32 v66, v66
  v_exp_f32 v67, v67
  v_mfma_f32_32x32x16_bf16 v[80:95], v[32:35], v[40:43], v[80:95]
  v_cvt_pk_bf16_f32 v36, v64, v65
  v_exp_f32 v68, v68
  v_exp_f32 v69, v69
  v_cvt_pk_bf16_f32 v37, v66, v67
  v_exp_f32 v70, v70
  v_exp_f32 v71, v71
  v_cvt_pk_bf16_f32 v38, v68, v69
  v_exp_f32 v72, v72
  v_exp_f32 v73, v73
  v_cvt_pk_bf16_f32 v39, v70, v71
  v_exp_f32 v74, v74
  v_exp_f32 v75, v75
  v_mfma_f32_32x32x16_bf16 v[96:111], v[240:243], v[36:39], v[96:111]
  v_cvt_pk_bf16_f32 v40, v72, v73
  v_exp_f32 v76, v76
  v_exp_f32 v77, v77
  v_cvt_pk_bf16_f32 v41, v74, v75
  v_exp_f32 v78, v78
  v_exp_f32 v79, v79
  v_cvt_pk_bf16_f32 v42, v76, v77
  v_cvt_pk_bf16_f32 v43, v78, v79
  s_setprio 1
  v_mfma_f32_32x32x16_bf16 v[64:79], v[24:27], v[20:23], 0
  v_exp_f32 v48, v48
  v_exp_f32 v49, v49
  v_exp_f32 v50, v50
  v_exp_f32 v51, v51
  v_mfma_f32_32x32x16_bf16 v[96:111], v[32:35], v[40:43], v[96:111]
  ds_read_b128 v[24:27], v4 offset:9216
  s_mov_b64 exec, s[44:45]
  ds_read_b128 v[32:35], v5 offset:8704
  ds_read_b128 v[240:243], v5 offset:9216
  s_mov_b64 exec, -1
  v_cvt_pk_bf16_f32 v36, v48, v49
  v_exp_f32 v52, v52
  v_exp_f32 v53, v53
  v_cvt_pk_bf16_f32 v37, v50, v51
  v_exp_f32 v54, v54
  v_exp_f32 v55, v55
  v_cvt_pk_bf16_f32 v38, v52, v53
  v_exp_f32 v56, v56
  v_exp_f32 v57, v57
  v_cvt_pk_bf16_f32 v39, v54, v55
  v_exp_f32 v58, v58
  v_exp_f32 v59, v59
  v_mfma_f32_32x32x16_bf16 v[80:95], v[28:31], v[36:39], v[80:95]
  v_cvt_pk_bf16_f32 v40, v56, v57
  v_exp_f32 v60, v60
  v_exp_f32 v61, v61
  v_cvt_pk_bf16_f32 v41, v58, v59
  v_exp_f32 v62, v62
  v_exp_f32 v63, v63
  v_cvt_pk_bf16_f32 v42, v60, v61
  v_cvt_pk_bf16_f32 v43, v62, v63
  s_waitcnt lgkmcnt(0)
  v_mfma_f32_32x32x16_bf16 v[48:63], v[24:27], v[16:19], 0
  v_exp_f32 v64, v64
  v_exp_f32 v65, v65
  v_exp_f32 v66, v66
  v_exp_f32 v67, v67
  v_mfma_f32_32x32x16_bf16 v[80:95], v[32:35], v[40:43], v[80:95]
  v_cvt_pk_bf16_f32 v36, v64, v65
  v_exp_f32 v68, v68
  v_exp_f32 v69, v69
  v_cvt_pk_bf16_f32 v37, v66, v67
  v_exp_f32 v70, v70
  v_exp_f32 v71, v71
  v_cvt_pk_bf16_f32 v38, v68, v69
  v_exp_f32 v72, v72
  v_exp_f32 v73, v73
  v_cvt_pk_bf16_f32 v39, v70, v71
  v_exp_f32 v74, v74
  v_exp_f32 v75, v75
  v_mfma_f32_32x32x16_bf16 v[96:111], v[28:31], v[36:39], v[96:111]
  v_cvt_pk_bf16_f32 v40, v72, v73
  v_exp_f32 v76, v76
  v_exp_f32 v77, v77
  v_cvt_pk_bf16_f32 v41, v74, v75
  v_exp_f32 v78, v78
  v_exp_f32 v79, v79
  v_cvt_pk_bf16_f32 v42, v76, v77
  v_cvt_pk_bf16_f32 v43, v78, v79
  s_setprio 0
  v_mfma_f32_32x32x16_bf16 v[64:79], v[24:27], v[20:23], 0
  v_exp_f32 v48, v48
  v_exp_f32 v49, v49
  v_exp_f32 v50, v50
  v_exp_f32 v51, v51
  v_mfma_f32_32x32x16_bf16 v[96:111], v[32:35], v[40:43], v[96:111]
  ds_read_b128 v[24:27], v4 offset:10240
  s_mov_b64 exec, s[44:45]
  ds_read_b128 v[32:35], v5 offset:9728
  ds_read_b128 v[28:31], v5 offset:10240
  s_mov_b64 exec, -1
  v_cvt_pk_bf16_f32 v36, v48, v49
  v_exp_f32 v52, v52
  v_exp_f32 v53, v53
  v_cvt_pk_bf16_f32 v37, v50, v51
  v_exp_f32 v54, v54
  v_exp_f32 v55, v55
  v_cvt_pk_bf16_f32 v38, v52, v53
  v_exp_f32 v56, v56
  v_exp_f32 v57, v57
  v_cvt_pk_bf16_f32 v39, v54, v55
  v_exp_f32 v58, v58
  v_exp_f32 v59, v59
  v_mfma_f32_32x32x16_bf16 v[80:95], v[240:243], v[36:39], v[80:95]
  v_cvt_pk_bf16_f32 v40, v56, v57
  v_exp_f32 v60, v60
  v_exp_f32 v61, v61
  v_cvt_pk_bf16_f32 v41, v58, v59
  v_exp_f32 v62, v62
  v_exp_f32 v63, v63
  v_cvt_pk_bf16_f32 v42, v60, v61
  v_cvt_pk_bf16_f32 v43, v62, v63
  s_waitcnt lgkmcnt(0)
  v_mfma_f32_32x32x16_bf16 v[48:63], v[24:27], v[16:19], 0
  v_exp_f32 v64, v64
  v_exp_f32 v65, v65
  v_exp_f32 v66, v66
  v_exp_f32 v67, v67
  v_mfma_f32_32x32x16_bf16 v[80:95], v[32:35], v[40:43], v[80:95]
  v_cvt_pk_bf16_f32 v36, v64, v65
  v_exp_f32 v68, v68
  v_exp_f32 v69, v69
  v_cvt_pk_bf16_f32 v37, v66, v67
  v_exp_f32 v70, v70
  v_exp_f32 v71, v71
  v_cvt_pk_bf16_f32 v38, v68, v69
  v_exp_f32 v72, v72
  v_exp_f32 v73, v73
  v_cvt_pk_bf16_f32 v39, v70, v71
  v_exp_f32 v74, v74
  v_exp_f32 v75, v75
  v_mfma_f32_32x32x16_bf16 v[96:111], v[240:243], v[36:39], v[96:111]
  v_cvt_pk_bf16_f32 v40, v72, v73
  v_exp_f32 v76, v76
  v_exp_f32 v77, v77
  v_cvt_pk_bf16_f32 v41, v74, v75
  v_exp_f32 v78, v78
  v_exp_f32 v79, v79
  v_cvt_pk_bf16_f32 v42, v76, v77
  v_cvt_pk_bf16_f32 v43, v78, v79
  s_barrier
  s_setprio 3
  v_mfma_f32_32x32x16_bf16 v[64:79], v[24:27], v[20:23], 0
  v_exp_f32 v48, v48
  v_exp_f32 v49, v49
  v_exp_f32 v50, v50
  v_exp_f32 v51, v51
  v_mfma_f32_32x32x16_bf16 v[96:111], v[32:35], v[40:43], v[96:111]
  ds_read_b128 v[24:27], v4 offset:11264
  s_mov_b64 exec, s[44:45]
  ds_read_b128 v[32:35], v5 offset:10752
  ds_read_b128 v[240:243], v5 offset:11264
  s_mov_b64 exec, -1
  v_cvt_pk_bf16_f32 v36, v48, v49
  v_exp_f32 v52, v52
  v_exp_f32 v53, v53
  v_cvt_pk_bf16_f32 v37, v50, v51
  v_exp_f32 v54, v54
  v_exp_f32 v55, v55
  v_cvt_pk_bf16_f32 v38, v52, v53
  v_exp_f32 v56, v56
  v_exp_f32 v57, v57
  v_cvt_pk_bf16_f32 v39, v54, v55
  v_exp_f32 v58, v58
  v_exp_f32 v59, v59
  v_mfma_f32_32x32x16_bf16 v[80:95], v[28:31], v[36:39], v[80:95]
  v_cvt_pk_bf16_f32 v40, v56, v57
  v_exp_f32 v60, v60
  v_exp_f32 v61, v61
  v_cvt_pk_bf16_f32 v41, v58, v59
  s_cmp_lg_u32 s4, 0
  s_cbranch_scc1 sequential_preLN__grouped_kv_mqa__mixer_gmlp__prompt_kernel_L44
  s_mov_b32 s39, 263168
  buffer_load_dwordx4 v[244:247], v2, s[8:11], s39 offen sc1
sequential_preLN__grouped_kv_mqa__mixer_gmlp__prompt_kernel_L44:
  v_exp_f32 v62, v62
  v_exp_f32 v63, v63
  v_cvt_pk_bf16_f32 v42, v60, v61
  v_cvt_pk_bf16_f32 v43, v62, v63
  s_waitcnt lgkmcnt(0)
  v_mfma_f32_32x32x16_bf16 v[48:63], v[24:27], v[16:19], 0
  v_exp_f32 v64, v64
  v_exp_f32 v65, v65
  v_exp_f32 v66, v66
  v_exp_f32 v67, v67
  v_mfma_f32_32x32x16_bf16 v[80:95], v[32:35], v[40:43], v[80:95]
  v_cvt_pk_bf16_f32 v36, v64, v65
  v_exp_f32 v68, v68
  v_exp_f32 v69, v69
  v_cvt_pk_bf16_f32 v37, v66, v67
  v_exp_f32 v70, v70
  v_exp_f32 v71, v71
  v_cvt_pk_bf16_f32 v38, v68, v69
  v_exp_f32 v72, v72
  v_exp_f32 v73, v73
  v_cvt_pk_bf16_f32 v39, v70, v71
  v_exp_f32 v74, v74
  v_exp_f32 v75, v75
  v_mfma_f32_32x32x16_bf16 v[96:111], v[28:31], v[36:39], v[96:111]
  v_cvt_pk_bf16_f32 v40, v72, v73
  v_exp_f32 v76, v76
  v_exp_f32 v77, v77
  v_cvt_pk_bf16_f32 v41, v74, v75
  v_exp_f32 v78, v78
  v_exp_f32 v79, v79
  v_cvt_pk_bf16_f32 v42, v76, v77
  v_cvt_pk_bf16_f32 v43, v78, v79
  s_setprio 2
  v_mfma_f32_32x32x16_bf16 v[64:79], v[24:27], v[20:23], 0
  v_exp_f32 v48, v48
  v_exp_f32 v49, v49
  v_exp_f32 v50, v50
  v_exp_f32 v51, v51
  v_mfma_f32_32x32x16_bf16 v[96:111], v[32:35], v[40:43], v[96:111]
  ds_read_b128 v[24:27], v4 offset:12288
  s_mov_b64 exec, s[44:45]
  ds_read_b128 v[32:35], v5 offset:11776
  ds_read_b128 v[28:31], v5 offset:12288
  s_mov_b64 exec, -1
  v_cvt_pk_bf16_f32 v36, v48, v49
  v_exp_f32 v52, v52
  v_exp_f32 v53, v53
  v_cvt_pk_bf16_f32 v37, v50, v51
  v_exp_f32 v54, v54
  v_exp_f32 v55, v55
  v_cvt_pk_bf16_f32 v38, v52, v53
  v_exp_f32 v56, v56
  v_exp_f32 v57, v57
  v_cvt_pk_bf16_f32 v39, v54, v55
  v_exp_f32 v58, v58
  v_exp_f32 v59, v59
  v_mfma_f32_32x32x16_bf16 v[80:95], v[240:243], v[36:39], v[80:95]
  v_cvt_pk_bf16_f32 v40, v56, v57
  v_exp_f32 v60, v60
  v_exp_f32 v61, v61
  v_cvt_pk_bf16_f32 v41, v58, v59
  v_exp_f32 v62, v62
  v_exp_f32 v63, v63
  v_cvt_pk_bf16_f32 v42, v60, v61
  v_cvt_pk_bf16_f32 v43, v62, v63
  s_waitcnt lgkmcnt(0)
  v_mfma_f32_32x32x16_bf16 v[48:63], v[24:27], v[16:19], 0
  v_exp_f32 v64, v64
  v_exp_f32 v65, v65
  v_exp_f32 v66, v66
  v_exp_f32 v67, v67
  v_mfma_f32_32x32x16_bf16 v[80:95], v[32:35], v[40:43], v[80:95]
  v_cvt_pk_bf16_f32 v36, v64, v65
  v_exp_f32 v68, v68
  v_exp_f32 v69, v69
  v_cvt_pk_bf16_f32 v37, v66, v67
  v_exp_f32 v70, v70
  v_exp_f32 v71, v71
  v_cvt_pk_bf16_f32 v38, v68, v69
  v_exp_f32 v72, v72
  v_exp_f32 v73, v73
  v_cvt_pk_bf16_f32 v39, v70, v71
  v_exp_f32 v74, v74
  v_exp_f32 v75, v75
  v_mfma_f32_32x32x16_bf16 v[96:111], v[240:243], v[36:39], v[96:111]
  v_cvt_pk_bf16_f32 v40, v72, v73
  v_exp_f32 v76, v76
  v_exp_f32 v77, v77
  v_cvt_pk_bf16_f32 v41, v74, v75
  v_exp_f32 v78, v78
  v_exp_f32 v79, v79
  v_cvt_pk_bf16_f32 v42, v76, v77
  v_cvt_pk_bf16_f32 v43, v78, v79
  s_cmp_lg_u32 s4, 0
  s_cbranch_scc1 sequential_preLN__grouped_kv_mqa__mixer_gmlp__prompt_kernel_wpx46
  s_mov_b32 s48, 100000
sequential_preLN__grouped_kv_mqa__mixer_gmlp__prompt_kernel_wp45:
  s_waitcnt vmcnt(0)
  v_min_u32 v14, v244, v245
  v_min3_u32 v14, v14, v246, v247
  v_cmp_eq_u32 vcc, 0, v14
  s_cbranch_vccz sequential_preLN__grouped_kv_mqa__mixer_gmlp__prompt_kernel_wpx46
  s_sub_u32 s48, s48, 1
  s_cmp_eq_u32 s48, 0
  s_cbranch_scc1 sequential_preLN__grouped_kv_mqa__mixer_gmlp__prompt_kernel_wpx46
  s_sleep 16
  s_mov_b32 s39, 263168
  buffer_load_dwordx4 v[244:247], v2, s[8:11], s39 offen sc1
  s_branch sequential_preLN__grouped_kv_mqa__mixer_gmlp__prompt_kernel_wp45
sequential_preLN__grouped_kv_mqa__mixer_gmlp__prompt_kernel_wpx46:
  s_barrier
  s_setprio 3
  v_mfma_f32_32x32x16_bf16 v[64:79], v[24:27], v[20:23], 0
  v_exp_f32 v48, v48
  v_exp_f32 v49, v49
  v_exp_f32 v50, v50
  v_exp_f32 v51, v51
  v_mfma_f32_32x32x16_bf16 v[96:111], v[32:35], v[40:43], v[96:111]
  ds_read_b128 v[24:27], v4 offset:13312
  s_mov_b64 exec, s[44:45]
  ds_read_b128 v[32:35], v5 offset:12800
  ds_read_b128 v[240:243], v5 offset:13312
  s_mov_b64 exec, -1
  v_cvt_pk_bf16_f32 v36, v48, v49
  v_exp_f32 v52, v52
  v_exp_f32 v53, v53
  v_cvt_pk_bf16_f32 v37, v50, v51
  v_exp_f32 v54, v54
  v_exp_f32 v55, v55
  v_cvt_pk_bf16_f32 v38, v52, v53
  s_lshl_b32 s39, s5, 18
  s_lshl_b32 s49, s6, 15
  s_add_u32 s39, s39, s49
  s_lshl_b32 s49, s4, 12
  s_add_u32 s39, s39, s49
  buffer_load_dwordx4 v[248:251], v2, s[24:27], s39 offen offset:0
  v_exp_f32 v56, v56
  v_exp_f32 v57, v57
  v_cvt_pk_bf16_f32 v39, v54, v55
  v_exp_f32 v58, v58
  v_exp_f32 v59, v59
  v_mfma_f32_32x32x16_bf16 v[80:95], v[28:31], v[36:39], v[80:95]
  v_cvt_pk_bf16_f32 v40, v56, v57
  v_exp_f32 v60, v60
  v_exp_f32 v61, v61
  v_cvt_pk_bf16_f32 v41, v58, v59
  s_lshl_b32 s46, s6, 16
  s_lshl_b32 s49, s29, 15
  s_add_u32 s46, s46, s49
  s_lshl_b32 s49, s31, 10
  s_add_u32 s46, s46, s49
  s_add_u32 s46, s46, 11534336
  buffer_load_dwordx4 v[112:115], v2, s[8:11], s46 offen offset:0 sc1
  v_exp_f32 v62, v62
  v_exp_f32 v63, v63
  v_cvt_pk_bf16_f32 v42, v60, v61
  v_cvt_pk_bf16_f32 v43, v62, v63
  s_waitcnt lgkmcnt(0)
  v_mfma_f32_32x32x16_bf16 v[48:63], v[24:27], v[16:19], 0
  v_exp_f32 v64, v64
  v_exp_f32 v65, v65
  v_exp_f32 v66, v66
  v_exp_f32 v67, v67
  v_mfma_f32_32x32x16_bf16 v[80:95], v[32:35], v[40:43], v[80:95]
  v_cvt_pk_bf16_f32 v36, v64, v65
  v_exp_f32 v68, v68
  v_exp_f32 v69, v69
  v_cvt_pk_bf16_f32 v37, v66, v67
  v_exp_f32 v70, v70
  v_exp_f32 v71, v71
  v_cvt_pk_bf16_f32 v38, v68, v69
  v_exp_f32 v72, v72
  v_exp_f32 v73, v73
  v_cvt_pk_bf16_f32 v39, v70, v71
  v_exp_f32 v74, v74
  v_exp_f32 v75, v75
  v_mfma_f32_32x32x16_bf16 v[96:111], v[28:31], v[36:39], v[96:111]
  v_cvt_pk_bf16_f32 v40, v72, v73
  v_exp_f32 v76, v76
  v_exp_f32 v77, v77
  v_cvt_pk_bf16_f32 v41, v74, v75
  buffer_load_dwordx4 v[116:119], v2, s[8:11], s46 offen offset:2048 sc1
  v_exp_f32 v78, v78
  v_exp_f32 v79, v79
  v_cvt_pk_bf16_f32 v42, v76, v77
  v_cvt_pk_bf16_f32 v43, v78, v79
  s_setprio 2
  v_mfma_f32_32x32x16_bf16 v[64:79], v[24:27], v[20:23], 0
  v_exp_f32 v48, v48
  v_exp_f32 v49, v49
  v_exp_f32 v50, v50
  v_exp_f32 v51, v51
  v_mfma_f32_32x32x16_bf16 v[96:111], v[32:35], v[40:43], v[96:111]
  ds_read_b128 v[24:27], v4 offset:14336
  s_mov_b64 exec, s[44:45]
  ds_read_b128 v[32:35], v5 offset:13824
  ds_read_b128 v[28:31], v5 offset:14336
  s_mov_b64 exec, -1
  v_cvt_pk_bf16_f32 v36, v48, v49
  v_exp_f32 v52, v52
  v_exp_f32 v53, v53
  v_cvt_pk_bf16_f32 v37, v50, v51
  v_exp_f32 v54, v54
  v_exp_f32 v55, v55
  v_cvt_pk_bf16_f32 v38, v52, v53
  v_exp_f32 v56, v56
  v_exp_f32 v57, v57
  v_cvt_pk_bf16_f32 v39, v54, v55
  v_exp_f32 v58, v58
  v_exp_f32 v59, v59
  v_mfma_f32_32x32x16_bf16 v[80:95], v[240:243], v[36:39], v[80:95]
  v_cvt_pk_bf16_f32 v40, v56, v57
  v_exp_f32 v60, v60
  v_exp_f32 v61, v61
  v_cvt_pk_bf16_f32 v41, v58, v59
  s_add_u32 s46, s46, 4096
  buffer_load_dwordx4 v[120:123], v2, s[8:11], s46 offen offset:0 sc1
  v_exp_f32 v62, v62
  v_exp_f32 v63, v63
  v_cvt_pk_bf16_f32 v42, v60, v61
  v_cvt_pk_bf16_f32 v43, v62, v63
  s_waitcnt lgkmcnt(0)
  v_mfma_f32_32x32x16_bf16 v[48:63], v[24:27], v[16:19], 0
  v_exp_f32 v64, v64
  v_exp_f32 v65, v65
  v_exp_f32 v66, v66
  v_exp_f32 v67, v67
  v_mfma_f32_32x32x16_bf16 v[80:95], v[32:35], v[40:43], v[80:95]
  v_cvt_pk_bf16_f32 v36, v64, v65
  v_exp_f32 v68, v68
  v_exp_f32 v69, v69
  v_cvt_pk_bf16_f32 v37, v66, v67
  v_exp_f32 v70, v70
  v_exp_f32 v71, v71
  v_cvt_pk_bf16_f32 v38, v68, v69
  v_exp_f32 v72, v72
  v_exp_f32 v73, v73
  v_cvt_pk_bf16_f32 v39, v70, v71
  v_exp_f32 v74, v74
  v_exp_f32 v75, v75
  v_mfma_f32_32x32x16_bf16 v[96:111], v[240:243], v[36:39], v[96:111]
  v_cvt_pk_bf16_f32 v40, v72, v73
  v_exp_f32 v76, v76
  v_exp_f32 v77, v77
  v_cvt_pk_bf16_f32 v41, v74, v75
  buffer_load_dwordx4 v[124:127], v2, s[8:11], s46 offen offset:2048 sc1
  v_exp_f32 v78, v78
  v_exp_f32 v79, v79
  v_cvt_pk_bf16_f32 v42, v76, v77
  v_cvt_pk_bf16_f32 v43, v78, v79
  s_setprio 1
  v_mfma_f32_32x32x16_bf16 v[64:79], v[24:27], v[20:23], 0
  v_exp_f32 v48, v48
  v_exp_f32 v49, v49
  v_exp_f32 v50, v50
  v_exp_f32 v51, v51
  v_mfma_f32_32x32x16_bf16 v[96:111], v[32:35], v[40:43], v[96:111]
  ds_read_b128 v[24:27], v4 offset:15360
  s_mov_b64 exec, s[44:45]
  ds_read_b128 v[32:35], v5 offset:14848
  ds_read_b128 v[240:243], v5 offset:15360
  s_mov_b64 exec, -1
  v_cvt_pk_bf16_f32 v36, v48, v49
  v_exp_f32 v52, v52
  v_exp_f32 v53, v53
  v_cvt_pk_bf16_f32 v37, v50, v51
  v_exp_f32 v54, v54
  v_exp_f32 v55, v55
  v_cvt_pk_bf16_f32 v38, v52, v53
  v_exp_f32 v56, v56
  v_exp_f32 v57, v57
  v_cvt_pk_bf16_f32 v39, v54, v55
  v_exp_f32 v58, v58
  v_exp_f32 v59, v59
  v_mfma_f32_32x32x16_bf16 v[80:95], v[28:31], v[36:39], v[80:95]
  v_cvt_pk_bf16_f32 v40, v56, v57
  v_exp_f32 v60, v60
  v_exp_f32 v61, v61
  v_cvt_pk_bf16_f32 v41, v58, v59
  s_add_u32 s46, s46, 4096
  buffer_load_dwordx4 v[128:131], v2, s[8:11], s46 offen offset:0 sc1
  v_exp_f32 v62, v62
  v_exp_f32 v63, v63
  v_cvt_pk_bf16_f32 v42, v60, v61
  v_cvt_pk_bf16_f32 v43, v62, v63
  s_waitcnt lgkmcnt(0)
  v_mfma_f32_32x32x16_bf16 v[48:63], v[24:27], v[16:19], 0
  v_exp_f32 v64, v64
  v_exp_f32 v65, v65
  v_exp_f32 v66, v66
  v_exp_f32 v67, v67
  v_mfma_f32_32x32x16_bf16 v[80:95], v[32:35], v[40:43], v[80:95]
  v_cvt_pk_bf16_f32 v36, v64, v65
  v_exp_f32 v68, v68
  v_exp_f32 v69, v69
  v_cvt_pk_bf16_f32 v37, v66, v67
  v_exp_f32 v70, v70
  v_exp_f32 v71, v71
  v_cvt_pk_bf16_f32 v38, v68, v69
  v_exp_f32 v72, v72
  v_exp_f32 v73, v73
  v_cvt_pk_bf16_f32 v39, v70, v71
  v_exp_f32 v74, v74
  v_exp_f32 v75, v75
  v_mfma_f32_32x32x16_bf16 v[96:111], v[28:31], v[36:39], v[96:111]
  v_cvt_pk_bf16_f32 v40, v72, v73
  v_exp_f32 v76, v76
  v_exp_f32 v77, v77
  v_cvt_pk_bf16_f32 v41, v74, v75
  buffer_load_dwordx4 v[132:135], v2, s[8:11], s46 offen offset:2048 sc1
  v_exp_f32 v78, v78
  v_exp_f32 v79, v79
  v_cvt_pk_bf16_f32 v42, v76, v77
  v_cvt_pk_bf16_f32 v43, v78, v79
  s_setprio 0
  v_mfma_f32_32x32x16_bf16 v[64:79], v[24:27], v[20:23], 0
  v_exp_f32 v48, v48
  v_exp_f32 v49, v49
  v_exp_f32 v50, v50
  v_exp_f32 v51, v51
  v_mfma_f32_32x32x16_bf16 v[96:111], v[32:35], v[40:43], v[96:111]
  ds_read_b128 v[24:27], v4 offset:16384
  s_mov_b64 exec, s[44:45]
  ds_read_b128 v[32:35], v5 offset:15872
  ds_read_b128 v[28:31], v5 offset:16384
  s_mov_b64 exec, -1
  v_cvt_pk_bf16_f32 v36, v48, v49
  v_exp_f32 v52, v52
  v_exp_f32 v53, v53
  v_cvt_pk_bf16_f32 v37, v50, v51
  v_exp_f32 v54, v54
  v_exp_f32 v55, v55
  v_cvt_pk_bf16_f32 v38, v52, v53
  v_exp_f32 v56, v56
  v_exp_f32 v57, v57
  v_cvt_pk_bf16_f32 v39, v54, v55
  v_exp_f32 v58, v58
  v_exp_f32 v59, v59
  v_mfma_f32_32x32x16_bf16 v[80:95], v[240:243], v[36:39], v[80:95]
  v_cvt_pk_bf16_f32 v40, v56, v57
  v_exp_f32 v60, v60
  v_exp_f32 v61, v61
  v_cvt_pk_bf16_f32 v41, v58, v59
  s_add_u32 s46, s46, 4096
  buffer_load_dwordx4 v[136:139], v2, s[8:11], s46 offen offset:0 sc1
  v_exp_f32 v62, v62
  v_exp_f32 v63, v63
  v_cvt_pk_bf16_f32 v42, v60, v61
  v_cvt_pk_bf16_f32 v43, v62, v63
  s_waitcnt lgkmcnt(0)
  v_mfma_f32_32x32x16_bf16 v[48:63], v[24:27], v[16:19], 0
  v_exp_f32 v64, v64
  v_exp_f32 v65, v65
  v_exp_f32 v66, v66
  v_exp_f32 v67, v67
  v_mfma_f32_32x32x16_bf16 v[80:95], v[32:35], v[40:43], v[80:95]
  v_cvt_pk_bf16_f32 v36, v64, v65
  v_exp_f32 v68, v68
  v_exp_f32 v69, v69
  v_cvt_pk_bf16_f32 v37, v66, v67
  v_exp_f32 v70, v70
  v_exp_f32 v71, v71
  v_cvt_pk_bf16_f32 v38, v68, v69
  v_exp_f32 v72, v72
  v_exp_f32 v73, v73
  v_cvt_pk_bf16_f32 v39, v70, v71
  v_exp_f32 v74, v74
  v_exp_f32 v75, v75
  v_mfma_f32_32x32x16_bf16 v[96:111], v[240:243], v[36:39], v[96:111]
  v_cvt_pk_bf16_f32 v40, v72, v73
  v_exp_f32 v76, v76
  v_exp_f32 v77, v77
  v_cvt_pk_bf16_f32 v41, v74, v75
  buffer_load_dwordx4 v[140:143], v2, s[8:11], s46 offen offset:2048 sc1
  v_exp_f32 v78, v78
  v_exp_f32 v79, v79
  v_cvt_pk_bf16_f32 v42, v76, v77
  v_cvt_pk_bf16_f32 v43, v78, v79
  s_barrier
  s_setprio 3
  v_mfma_f32_32x32x16_bf16 v[64:79], v[24:27], v[20:23], 0
  v_exp_f32 v48, v48
  v_exp_f32 v49, v49
  v_exp_f32 v50, v50
  v_exp_f32 v51, v51
  v_mfma_f32_32x32x16_bf16 v[96:111], v[32:35], v[40:43], v[96:111]
  ds_read_b128 v[24:27], v4 offset:17408
  s_mov_b64 exec, s[44:45]
  ds_read_b128 v[32:35], v5 offset:16896
  ds_read_b128 v[240:243], v5 offset:17408
  s_mov_b64 exec, -1
  v_cvt_pk_bf16_f32 v36, v48, v49
  v_exp_f32 v52, v52
  v_exp_f32 v53, v53
  v_cvt_pk_bf16_f32 v37, v50, v51
  v_exp_f32 v54, v54
  v_exp_f32 v55, v55
  v_cvt_pk_bf16_f32 v38, v52, v53
  v_exp_f32 v56, v56
  v_exp_f32 v57, v57
  v_cvt_pk_bf16_f32 v39, v54, v55
  v_exp_f32 v58, v58
  v_exp_f32 v59, v59
  v_mfma_f32_32x32x16_bf16 v[80:95], v[28:31], v[36:39], v[80:95]
  v_cvt_pk_bf16_f32 v40, v56, v57
  v_exp_f32 v60, v60
  v_exp_f32 v61, v61
  v_cvt_pk_bf16_f32 v41, v58, v59
  s_lshl_b32 s39, s5, 18
  s_lshl_b32 s49, s6, 15
  s_add_u32 s39, s39, s49
  s_lshl_b32 s49, s4, 12
  s_add_u32 s39, s39, s49
  buffer_load_dwordx4 v[248:251], v2, s[24:27], s39 offen offset:1024
  v_exp_f32 v62, v62
  v_exp_f32 v63, v63
  v_cvt_pk_bf16_f32 v42, v60, v61
  v_cvt_pk_bf16_f32 v43, v62, v63
  s_waitcnt lgkmcnt(0)
  v_mfma_f32_32x32x16_bf16 v[48:63], v[24:27], v[16:19], 0
  v_exp_f32 v64, v64
  v_exp_f32 v65, v65
  v_exp_f32 v66, v66
  v_exp_f32 v67, v67
  v_mfma_f32_32x32x16_bf16 v[80:95], v[32:35], v[40:43], v[80:95]
  v_cvt_pk_bf16_f32 v36, v64, v65
  v_exp_f32 v68, v68
  v_exp_f32 v69, v69
  v_cvt_pk_bf16_f32 v37, v66, v67
  v_exp_f32 v70, v70
  v_exp_f32 v71, v71
  v_cvt_pk_bf16_f32 v38, v68, v69
  v_exp_f32 v72, v72
  v_exp_f32 v73, v73
  v_cvt_pk_bf16_f32 v39, v70, v71
  v_exp_f32 v74, v74
  v_exp_f32 v75, v75
  v_mfma_f32_32x32x16_bf16 v[96:111], v[28:31], v[36:39], v[96:111]
  v_cvt_pk_bf16_f32 v40, v72, v73
  v_exp_f32 v76, v76
  v_exp_f32 v77, v77
  v_cvt_pk_bf16_f32 v41, v74, v75
  s_add_u32 s46, s46, 4096
  buffer_load_dwordx4 v[144:147], v2, s[8:11], s46 offen offset:0 sc1
  v_exp_f32 v78, v78
  v_exp_f32 v79, v79
  v_cvt_pk_bf16_f32 v42, v76, v77
  v_cvt_pk_bf16_f32 v43, v78, v79
  s_setprio 2
  v_mfma_f32_32x32x16_bf16 v[64:79], v[24:27], v[20:23], 0
  v_exp_f32 v48, v48
  v_exp_f32 v49, v49
  v_exp_f32 v50, v50
  v_exp_f32 v51, v51
  v_mfma_f32_32x32x16_bf16 v[96:111], v[32:35], v[40:43], v[96:111]
  ds_read_b128 v[24:27], v4 offset:18432
  s_mov_b64 exec, s[44:45]
  ds_read_b128 v[32:35], v5 offset:17920
  ds_read_b128 v[28:31], v5 offset:18432
  s_mov_b64 exec, -1
  v_cvt_pk_bf16_f32 v36, v48, v49
  v_exp_f32 v52, v52
  v_exp_f32 v53, v53
  v_cvt_pk_bf16_f32 v37, v50, v51
  v_exp_f32 v54, v54
  v_exp_f32 v55, v55
  v_cvt_pk_bf16_f32 v38, v52, v53
  v_exp_f32 v56, v56
  v_exp_f32 v57, v57
  v_cvt_pk_bf16_f32 v39, v54, v55
  v_exp_f32 v58, v58
  v_exp_f32 v59, v59
  v_mfma_f32_32x32x16_bf16 v[80:95], v[240:243], v[36:39], v[80:95]
  v_cvt_pk_bf16_f32 v40, v56, v57
  v_exp_f32 v60, v60
  v_exp_f32 v61, v61
  v_cvt_pk_bf16_f32 v41, v58, v59
  buffer_load_dwordx4 v[148:151], v2, s[8:11], s46 offen offset:2048 sc1
  v_exp_f32 v62, v62
  v_exp_f32 v63, v63
  v_cvt_pk_bf16_f32 v42, v60, v61
  v_cvt_pk_bf16_f32 v43, v62, v63
  s_waitcnt lgkmcnt(0)
  v_mfma_f32_32x32x16_bf16 v[48:63], v[24:27], v[16:19], 0
  v_exp_f32 v64, v64
  v_exp_f32 v65, v65
  v_exp_f32 v66, v66
  v_exp_f32 v67, v67
  v_mfma_f32_32x32x16_bf16 v[80:95], v[32:35], v[40:43], v[80:95]
  v_cvt_pk_bf16_f32 v36, v64, v65
  v_exp_f32 v68, v68
  v_exp_f32 v69, v69
  v_cvt_pk_bf16_f32 v37, v66, v67
  v_exp_f32 v70, v70
  v_exp_f32 v71, v71
  v_cvt_pk_bf16_f32 v38, v68, v69
  v_exp_f32 v72, v72
  v_exp_f32 v73, v73
  v_cvt_pk_bf16_f32 v39, v70, v71
  v_exp_f32 v74, v74
  v_exp_f32 v75, v75
  v_mfma_f32_32x32x16_bf16 v[96:111], v[240:243], v[36:39], v[96:111]
  v_cvt_pk_bf16_f32 v40, v72, v73
  v_exp_f32 v76, v76
  v_exp_f32 v77, v77
  v_cvt_pk_bf16_f32 v41, v74, v75
  s_add_u32 s46, s46, 4096
  buffer_load_dwordx4 v[152:155], v2, s[8:11], s46 offen offset:0 sc1
  v_exp_f32 v78, v78
  v_exp_f32 v79, v79
  v_cvt_pk_bf16_f32 v42, v76, v77
  v_cvt_pk_bf16_f32 v43, v78, v79
  s_setprio 1
  v_mfma_f32_32x32x16_bf16 v[64:79], v[24:27], v[20:23], 0
  v_exp_f32 v48, v48
  v_exp_f32 v49, v49
  v_exp_f32 v50, v50
  v_exp_f32 v51, v51
  v_mfma_f32_32x32x16_bf16 v[96:111], v[32:35], v[40:43], v[96:111]
  ds_read_b128 v[24:27], v4 offset:19456
  s_mov_b64 exec, s[44:45]
  ds_read_b128 v[32:35], v5 offset:18944
  ds_read_b128 v[240:243], v5 offset:19456
  s_mov_b64 exec, -1
  v_cvt_pk_bf16_f32 v36, v48, v49
  v_exp_f32 v52, v52
  v_exp_f32 v53, v53
  v_cvt_pk_bf16_f32 v37, v50, v51
  v_exp_f32 v54, v54
  v_exp_f32 v55, v55
  v_cvt_pk_bf16_f32 v38, v52, v53
  v_exp_f32 v56, v56
  v_exp_f32 v57, v57
  v_cvt_pk_bf16_f32 v39, v54, v55
  v_exp_f32 v58, v58
  v_exp_f32 v59, v59
  v_mfma_f32_32x32x16_bf16 v[80:95], v[28:31], v[36:39], v[80:95]
  v_cvt_pk_bf16_f32 v40, v56, v57
  v_exp_f32 v60, v60
  v_exp_f32 v61, v61
  v_cvt_pk_bf16_f32 v41, v58, v59
  buffer_load_dwordx4 v[156:159], v2, s[8:11], s46 offen offset:2048 sc1
  v_exp_f32 v62, v62
  v_exp_f32 v63, v63
  v_cvt_pk_bf16_f32 v42, v60, v61
  v_cvt_pk_bf16_f32 v43, v62, v63
  s_waitcnt lgkmcnt(0)
  v_mfma_f32_32x32x16_bf16 v[48:63], v[24:27], v[16:19], 0
  v_exp_f32 v64, v64
  v_exp_f32 v65, v65
  v_exp_f32 v66, v66
  v_exp_f32 v67, v67
  v_mfma_f32_32x32x16_bf16 v[80:95], v[32:35], v[40:43], v[80:95]
  v_cvt_pk_bf16_f32 v36, v64, v65
  v_exp_f32 v68, v68
  v_exp_f32 v69, v69
  v_cvt_pk_bf16_f32 v37, v66, v67
  v_exp_f32 v70, v70
  v_exp_f32 v71, v71
  v_cvt_pk_bf16_f32 v38, v68, v69
  v_exp_f32 v72, v72
  v_exp_f32 v73, v73
  v_cvt_pk_bf16_f32 v39, v70, v71
  v_exp_f32 v74, v74
  v_exp_f32 v75, v75
  v_mfma_f32_32x32x16_bf16 v[96:111], v[28:31], v[36:39], v[96:111]
  v_cvt_pk_bf16_f32 v40, v72, v73
  v_exp_f32 v76, v76
  v_exp_f32 v77, v77
  v_cvt_pk_bf16_f32 v41, v74, v75
  s_add_u32 s46, s46, 4096
  buffer_load_dwordx4 v[160:163], v2, s[8:11], s46 offen offset:0 sc1
  v_exp_f32 v78, v78
  v_exp_f32 v79, v79
  v_cvt_pk_bf16_f32 v42, v76, v77
  v_cvt_pk_bf16_f32 v43, v78, v79
  s_setprio 0
  v_mfma_f32_32x32x16_bf16 v[64:79], v[24:27], v[20:23], 0
  v_exp_f32 v48, v48
  v_exp_f32 v49, v49
  v_exp_f32 v50, v50
  v_exp_f32 v51, v51
  v_mfma_f32_32x32x16_bf16 v[96:111], v[32:35], v[40:43], v[96:111]
  ds_read_b128 v[24:27], v4 offset:20480
  s_mov_b64 exec, s[44:45]
  ds_read_b128 v[32:35], v5 offset:19968
  ds_read_b128 v[28:31], v5 offset:20480
  s_mov_b64 exec, -1
  v_cvt_pk_bf16_f32 v36, v48, v49
  v_exp_f32 v52, v52
  v_exp_f32 v53, v53
  v_cvt_pk_bf16_f32 v37, v50, v51
  v_exp_f32 v54, v54
  v_exp_f32 v55, v55
  v_cvt_pk_bf16_f32 v38, v52, v53
  v_exp_f32 v56, v56
  v_exp_f32 v57, v57
  v_cvt_pk_bf16_f32 v39, v54, v55
  v_exp_f32 v58, v58
  v_exp_f32 v59, v59
  v_mfma_f32_32x32x16_bf16 v[80:95], v[240:243], v[36:39], v[80:95]
  v_cvt_pk_bf16_f32 v40, v56, v57
  v_exp_f32 v60, v60
  v_exp_f32 v61, v61
  v_cvt_pk_bf16_f32 v41, v58, v59
  buffer_load_dwordx4 v[164:167], v2, s[8:11], s46 offen offset:2048 sc1
  v_exp_f32 v62, v62
  v_exp_f32 v63, v63
  v_cvt_pk_bf16_f32 v42, v60, v61
  v_cvt_pk_bf16_f32 v43, v62, v63
  s_waitcnt lgkmcnt(0)
  v_mfma_f32_32x32x16_bf16 v[48:63], v[24:27], v[16:19], 0
  v_exp_f32 v64, v64
  v_exp_f32 v65, v65
  v_exp_f32 v66, v66
  v_exp_f32 v67, v67
  v_mfma_f32_32x32x16_bf16 v[80:95], v[32:35], v[40:43], v[80:95]
  v_cvt_pk_bf16_f32 v36, v64, v65
  v_exp_f32 v68, v68
  v_exp_f32 v69, v69
  v_cvt_pk_bf16_f32 v37, v66, v67
  v_exp_f32 v70, v70
  v_exp_f32 v71, v71
  v_cvt_pk_bf16_f32 v38, v68, v69
  v_exp_f32 v72, v72
  v_exp_f32 v73, v73
  v_cvt_pk_bf16_f32 v39, v70, v71
  v_exp_f32 v74, v74
  v_exp_f32 v75, v75
  v_mfma_f32_32x32x16_bf16 v[96:111], v[240:243], v[36:39], v[96:111]
  v_cvt_pk_bf16_f32 v40, v72, v73
  v_exp_f32 v76, v76
  v_exp_f32 v77, v77
  v_cvt_pk_bf16_f32 v41, v74, v75
  s_add_u32 s46, s46, 4096
  buffer_load_dwordx4 v[168:171], v2, s[8:11], s46 offen offset:0 sc1
  v_exp_f32 v78, v78
  v_exp_f32 v79, v79
  v_cvt_pk_bf16_f32 v42, v76, v77
  v_cvt_pk_bf16_f32 v43, v78, v79
  s_barrier
  s_setprio 3
  v_mfma_f32_32x32x16_bf16 v[64:79], v[24:27], v[20:23], 0
  v_exp_f32 v48, v48
  v_exp_f32 v49, v49
  v_exp_f32 v50, v50
  v_exp_f32 v51, v51
  v_mfma_f32_32x32x16_bf16 v[96:111], v[32:35], v[40:43], v[96:111]
  ds_read_b128 v[24:27], v4 offset:21504
  s_mov_b64 exec, s[44:45]
  ds_read_b128 v[32:35], v5 offset:20992
  ds_read_b128 v[240:243], v5 offset:21504
  s_mov_b64 exec, -1
  v_cvt_pk_bf16_f32 v36, v48, v49
  v_exp_f32 v52, v52
  v_exp_f32 v53, v53
  v_cvt_pk_bf16_f32 v37, v50, v51
  v_exp_f32 v54, v54
  v_exp_f32 v55, v55
  v_cvt_pk_bf16_f32 v38, v52, v53
  v_exp_f32 v56, v56
  v_exp_f32 v57, v57
  v_cvt_pk_bf16_f32 v39, v54, v55
  v_exp_f32 v58, v58
  v_exp_f32 v59, v59
  v_mfma_f32_32x32x16_bf16 v[80:95], v[28:31], v[36:39], v[80:95]
  v_cvt_pk_bf16_f32 v40, v56, v57
  v_exp_f32 v60, v60
  v_exp_f32 v61, v61
  v_cvt_pk_bf16_f32 v41, v58, v59
  buffer_load_dwordx4 v[172:175], v2, s[8:11], s46 offen offset:2048 sc1
  v_exp_f32 v62, v62
  v_exp_f32 v63, v63
  v_cvt_pk_bf16_f32 v42, v60, v61
  v_cvt_pk_bf16_f32 v43, v62, v63
  s_waitcnt lgkmcnt(0)
  v_mfma_f32_32x32x16_bf16 v[48:63], v[24:27], v[16:19], 0
  v_exp_f32 v64, v64
  v_exp_f32 v65, v65
  v_exp_f32 v66, v66
  v_exp_f32 v67, v67
  v_mfma_f32_32x32x16_bf16 v[80:95], v[32:35], v[40:43], v[80:95]
  v_cvt_pk_bf16_f32 v36, v64, v65
  v_exp_f32 v68, v68
  v_exp_f32 v69, v69
  v_cvt_pk_bf16_f32 v37, v66, v67
  v_exp_f32 v70, v70
  v_exp_f32 v71, v71
  v_cvt_pk_bf16_f32 v38, v68, v69
  v_exp_f32 v72, v72
  v_exp_f32 v73, v73
  v_cvt_pk_bf16_f32 v39, v70, v71
  v_exp_f32 v74, v74
  v_exp_f32 v75, v75
  v_mfma_f32_32x32x16_bf16 v[96:111], v[28:31], v[36:39], v[96:111]
  v_cvt_pk_bf16_f32 v40, v72, v73
  v_exp_f32 v76, v76
  v_exp_f32 v77, v77
  v_cvt_pk_bf16_f32 v41, v74, v75
  s_lshl_b32 s39, s5, 18
  s_lshl_b32 s49, s6, 15
  s_add_u32 s39, s39, s49
  s_lshl_b32 s49, s4, 12
  s_add_u32 s39, s39, s49
  buffer_load_dwordx4 v[248:251], v2, s[24:27], s39 offen offset:2048
  v_exp_f32 v78, v78
  v_exp_f32 v79, v79
  v_cvt_pk_bf16_f32 v42, v76, v77
  v_cvt_pk_bf16_f32 v43, v78, v79
  s_setprio 2
  v_mfma_f32_32x32x16_bf16 v[64:79], v[24:27], v[20:23], 0
  v_exp_f32 v48, v48
  v_exp_f32 v49, v49
  v_exp_f32 v50, v50
  v_exp_f32 v51, v51
  v_mfma_f32_32x32x16_bf16 v[96:111], v[32:35], v[40:43], v[96:111]
  ds_read_b128 v[24:27], v4 offset:22528
  s_mov_b64 exec, s[44:45]
  ds_read_b128 v[32:35], v5 offset:22016
  ds_read_b128 v[28:31], v5 offset:22528
  s_mov_b64 exec, -1
  v_cvt_pk_bf16_f32 v36, v48, v49
  v_exp_f32 v52, v52
  v_exp_f32 v53, v53
  v_cvt_pk_bf16_f32 v37, v50, v51
  v_exp_f32 v54, v54
  v_exp_f32 v55, v55
  v_cvt_pk_bf16_f32 v38, v52, v53
  v_exp_f32 v56, v56
  v_exp_f32 v57, v57
  v_cvt_pk_bf16_f32 v39, v54, v55
  v_exp_f32 v58, v58
  v_exp_f32 v59, v59
  v_mfma_f32_32x32x16_bf16 v[80:95], v[240:243], v[36:39], v[80:95]
  v_cvt_pk_bf16_f32 v40, v56, v57
  v_exp_f32 v60, v60
  v_exp_f32 v61, v61
  v_cvt_pk_bf16_f32 v41, v58, v59
  s_mov_b32 s46, s93
  s_add_u32 s46, s46, s95
  s_add_u32 s46, s46, 43
  s_lshl_b32 s46, s46, 14
  s_lshl_b32 s47, s31, 10
  s_add_u32 s46, s46, s47
  s_add_u32 s46, s46, 12058624
  s_add_u32 s46, s46, s92
  buffer_load_dwordx4 v[176:179], v2, s[8:11], s46 offen offset:0 sc1
  v_exp_f32 v62, v62
  v_exp_f32 v63, v63
  v_cvt_pk_bf16_f32 v42, v60, v61
  v_cvt_pk_bf16_f32 v43, v62, v63
  s_waitcnt lgkmcnt(0)
  v_mfma_f32_32x32x16_bf16 v[48:63], v[24:27], v[16:19], 0
  v_exp_f32 v64, v64
  v_exp_f32 v65, v65
  v_exp_f32 v66, v66
  v_exp_f32 v67, v67
  v_mfma_f32_32x32x16_bf16 v[80:95], v[32:35], v[40:43], v[80:95]
  v_cvt_pk_bf16_f32 v36, v64, v65
  v_exp_f32 v68, v68
  v_exp_f32 v69, v69
  v_cvt_pk_bf16_f32 v37, v66, v67
  v_exp_f32 v70, v70
  v_exp_f32 v71, v71
  v_cvt_pk_bf16_f32 v38, v68, v69
  buffer_load_dwordx4 v[180:183], v2, s[8:11], s46 offen offset:2048 sc1
  v_exp_f32 v72, v72
  v_exp_f32 v73, v73
  v_cvt_pk_bf16_f32 v39, v70, v71
  v_exp_f32 v74, v74
  v_exp_f32 v75, v75
  v_mfma_f32_32x32x16_bf16 v[96:111], v[240:243], v[36:39], v[96:111]
  v_cvt_pk_bf16_f32 v40, v72, v73
  v_exp_f32 v76, v76
  v_exp_f32 v77, v77
  v_cvt_pk_bf16_f32 v41, v74, v75
  v_exp_f32 v78, v78
  v_exp_f32 v79, v79
  v_cvt_pk_bf16_f32 v42, v76, v77
  v_cvt_pk_bf16_f32 v43, v78, v79
  s_setprio 1
  v_mfma_f32_32x32x16_bf16 v[64:79], v[24:27], v[20:23], 0
  v_exp_f32 v48, v48
  v_exp_f32 v49, v49
  v_exp_f32 v50, v50
  v_exp_f32 v51, v51
  v_mfma_f32_32x32x16_bf16 v[96:111], v[32:35], v[40:43], v[96:111]
  ds_read_b128 v[24:27], v4 offset:23552
  s_mov_b64 exec, s[44:45]
  ds_read_b128 v[32:35], v5 offset:23040
  ds_read_b128 v[240:243], v5 offset:23552
  s_mov_b64 exec, -1
  v_cvt_pk_bf16_f32 v36, v48, v49
  v_exp_f32 v52, v52
  v_exp_f32 v53, v53
  v_cvt_pk_bf16_f32 v37, v50, v51
  v_exp_f32 v54, v54
  v_exp_f32 v55, v55
  v_cvt_pk_bf16_f32 v38, v52, v53
  s_add_u32 s46, s46, 4096
  buffer_load_dwordx4 v[184:187], v2, s[8:11], s46 offen offset:0 sc1
  v_exp_f32 v56, v56
  v_exp_f32 v57, v57
  v_cvt_pk_bf16_f32 v39, v54, v55
  v_exp_f32 v58, v58
  v_exp_f32 v59, v59
  v_mfma_f32_32x32x16_bf16 v[80:95], v[28:31], v[36:39], v[80:95]
  v_cvt_pk_bf16_f32 v40, v56, v57
  v_exp_f32 v60, v60
  v_exp_f32 v61, v61
  v_cvt_pk_bf16_f32 v41, v58, v59
  v_exp_f32 v62, v62
  v_exp_f32 v63, v63
  v_cvt_pk_bf16_f32 v42, v60, v61
  v_cvt_pk_bf16_f32 v43, v62, v63
  s_waitcnt lgkmcnt(0)
  v_mfma_f32_32x32x16_bf16 v[48:63], v[24:27], v[16:19], 0
  v_exp_f32 v64, v64
  v_exp_f32 v65, v65
  v_exp_f32 v66, v66
  v_exp_f32 v67, v67
  v_mfma_f32_32x32x16_bf16 v[80:95], v[32:35], v[40:43], v[80:95]
  v_cvt_pk_bf16_f32 v36, v64, v65
  v_exp_f32 v68, v68
  v_exp_f32 v69, v69
  v_cvt_pk_bf16_f32 v37, v66, v67
  v_exp_f32 v70, v70
  v_exp_f32 v71, v71
  v_cvt_pk_bf16_f32 v38, v68, v69
  buffer_load_dwordx4 v[188:191], v2, s[8:11], s46 offen offset:2048 sc1
  v_exp_f32 v72, v72
  v_exp_f32 v73, v73
  v_cvt_pk_bf16_f32 v39, v70, v71
  v_exp_f32 v74, v74
  v_exp_f32 v75, v75
  v_mfma_f32_32x32x16_bf16 v[96:111], v[28:31], v[36:39], v[96:111]
  v_cvt_pk_bf16_f32 v40, v72, v73
  v_exp_f32 v76, v76
  v_exp_f32 v77, v77
  v_cvt_pk_bf16_f32 v41, v74, v75
  v_exp_f32 v78, v78
  v_exp_f32 v79, v79
  v_cvt_pk_bf16_f32 v42, v76, v77
  v_cvt_pk_bf16_f32 v43, v78, v79
  s_setprio 0
  v_mfma_f32_32x32x16_bf16 v[64:79], v[24:27], v[20:23], 0
  v_exp_f32 v48, v48
  v_exp_f32 v49, v49
  v_exp_f32 v50, v50
  v_exp_f32 v51, v51
  v_mfma_f32_32x32x16_bf16 v[96:111], v[32:35], v[40:43], v[96:111]
  ds_read_b128 v[24:27], v4 offset:24576
  s_mov_b64 exec, s[44:45]
  ds_read_b128 v[32:35], v5 offset:24064
  ds_read_b128 v[28:31], v5 offset:24576
  s_mov_b64 exec, -1
  v_cvt_pk_bf16_f32 v36, v48, v49
  v_exp_f32 v52, v52
  v_exp_f32 v53, v53
  v_cvt_pk_bf16_f32 v37, v50, v51
  v_exp_f32 v54, v54
  v_exp_f32 v55, v55
  v_cvt_pk_bf16_f32 v38, v52, v53
  s_add_u32 s46, s46, 4096
  buffer_load_dwordx4 v[192:195], v2, s[8:11], s46 offen offset:0 sc1
  v_exp_f32 v56, v56
  v_exp_f32 v57, v57
  v_cvt_pk_bf16_f32 v39, v54, v55
  v_exp_f32 v58, v58
  v_exp_f32 v59, v59
  v_mfma_f32_32x32x16_bf16 v[80:95], v[240:243], v[36:39], v[80:95]
  v_cvt_pk_bf16_f32 v40, v56, v57
  v_exp_f32 v60, v60
  v_exp_f32 v61, v61
  v_cvt_pk_bf16_f32 v41, v58, v59
  v_exp_f32 v62, v62
  v_exp_f32 v63, v63
  v_cvt_pk_bf16_f32 v42, v60, v61
  v_cvt_pk_bf16_f32 v43, v62, v63
  s_waitcnt lgkmcnt(0)
  v_mfma_f32_32x32x16_bf16 v[48:63], v[24:27], v[16:19], 0
  v_exp_f32 v64, v64
  v_exp_f32 v65, v65
  v_exp_f32 v66, v66
  v_exp_f32 v67, v67
  v_mfma_f32_32x32x16_bf16 v[80:95], v[32:35], v[40:43], v[80:95]
  v_cvt_pk_bf16_f32 v36, v64, v65
  v_exp_f32 v68, v68
  v_exp_f32 v69, v69
  v_cvt_pk_bf16_f32 v37, v66, v67
  v_exp_f32 v70, v70
  v_exp_f32 v71, v71
  v_cvt_pk_bf16_f32 v38, v68, v69
  buffer_load_dwordx4 v[196:199], v2, s[8:11], s46 offen offset:2048 sc1
  v_exp_f32 v72, v72
  v_exp_f32 v73, v73
  v_cvt_pk_bf16_f32 v39, v70, v71
  v_exp_f32 v74, v74
  v_exp_f32 v75, v75
  v_mfma_f32_32x32x16_bf16 v[96:111], v[240:243], v[36:39], v[96:111]
  v_cvt_pk_bf16_f32 v40, v72, v73
  v_exp_f32 v76, v76
  v_exp_f32 v77, v77
  v_cvt_pk_bf16_f32 v41, v74, v75
  v_exp_f32 v78, v78
  v_exp_f32 v79, v79
  v_cvt_pk_bf16_f32 v42, v76, v77
  v_cvt_pk_bf16_f32 v43, v78, v79
  s_barrier
  s_setprio 3
  v_mfma_f32_32x32x16_bf16 v[64:79], v[24:27], v[20:23], 0
  v_exp_f32 v48, v48
  v_exp_f32 v49, v49
  v_exp_f32 v50, v50
  v_exp_f32 v51, v51
  v_mfma_f32_32x32x16_bf16 v[96:111], v[32:35], v[40:43], v[96:111]
  ds_read_b128 v[24:27], v4 offset:25600
  s_mov_b64 exec, s[44:45]
  ds_read_b128 v[32:35], v5 offset:25088
  ds_read_b128 v[240:243], v5 offset:25600
  s_mov_b64 exec, -1
  v_cvt_pk_bf16_f32 v36, v48, v49
  v_exp_f32 v52, v52
  v_exp_f32 v53, v53
  v_cvt_pk_bf16_f32 v37, v50, v51
  v_exp_f32 v54, v54
  v_exp_f32 v55, v55
  v_cvt_pk_bf16_f32 v38, v52, v53
  s_add_u32 s46, s46, 4096
  buffer_load_dwordx4 v[200:203], v2, s[8:11], s46 offen offset:0 sc1
  v_exp_f32 v56, v56
  v_exp_f32 v57, v57
  v_cvt_pk_bf16_f32 v39, v54, v55
  v_exp_f32 v58, v58
  v_exp_f32 v59, v59
  v_mfma_f32_32x32x16_bf16 v[80:95], v[28:31], v[36:39], v[80:95]
  v_cvt_pk_bf16_f32 v40, v56, v57
  v_exp_f32 v60, v60
  v_exp_f32 v61, v61
  v_cvt_pk_bf16_f32 v41, v58, v59
  v_exp_f32 v62, v62
  v_exp_f32 v63, v63
  v_cvt_pk_bf16_f32 v42, v60, v61
  v_cvt_pk_bf16_f32 v43, v62, v63
  s_waitcnt lgkmcnt(0)
  v_mfma_f32_32x32x16_bf16 v[48:63], v[24:27], v[16:19], 0
  v_exp_f32 v64, v64
  v_exp_f32 v65, v65
  v_exp_f32 v66, v66
  v_exp_f32 v67, v67
  v_mfma_f32_32x32x16_bf16 v[80:95], v[32:35], v[40:43], v[80:95]
  v_cvt_pk_bf16_f32 v36, v64, v65
  v_exp_f32 v68, v68
  v_exp_f32 v69, v69
  v_cvt_pk_bf16_f32 v37, v66, v67
  v_exp_f32 v70, v70
  v_exp_f32 v71, v71
  v_cvt_pk_bf16_f32 v38, v68, v69
  buffer_load_dwordx4 v[204:207], v2, s[8:11], s46 offen offset:2048 sc1
  v_exp_f32 v72, v72
  v_exp_f32 v73, v73
  v_cvt_pk_bf16_f32 v39, v70, v71
  v_exp_f32 v74, v74
  v_exp_f32 v75, v75
  v_mfma_f32_32x32x16_bf16 v[96:111], v[28:31], v[36:39], v[96:111]
  v_cvt_pk_bf16_f32 v40, v72, v73
  v_exp_f32 v76, v76
  v_exp_f32 v77, v77
  v_cvt_pk_bf16_f32 v41, v74, v75
  v_exp_f32 v78, v78
  v_exp_f32 v79, v79
  v_cvt_pk_bf16_f32 v42, v76, v77
  v_cvt_pk_bf16_f32 v43, v78, v79
  s_setprio 2
  v_mfma_f32_32x32x16_bf16 v[64:79], v[24:27], v[20:23], 0
  v_exp_f32 v48, v48
  v_exp_f32 v49, v49
  v_exp_f32 v50, v50
  v_exp_f32 v51, v51
  v_mfma_f32_32x32x16_bf16 v[96:111], v[32:35], v[40:43], v[96:111]
  ds_read_b128 v[24:27], v4 offset:26624
  s_mov_b64 exec, s[44:45]
  ds_read_b128 v[32:35], v5 offset:26112
  ds_read_b128 v[28:31], v5 offset:26624
  s_mov_b64 exec, -1
  v_cvt_pk_bf16_f32 v36, v48, v49
  v_exp_f32 v52, v52
  v_exp_f32 v53, v53
  v_cvt_pk_bf16_f32 v37, v50, v51
  v_exp_f32 v54, v54
  v_exp_f32 v55, v55
  v_cvt_pk_bf16_f32 v38, v52, v53
  s_lshl_b32 s39, s5, 18
  s_lshl_b32 s49, s6, 15
  s_add_u32 s39, s39, s49
  s_lshl_b32 s49, s4, 12
  s_add_u32 s39, s39, s49
  buffer_load_dwordx4 v[248:251], v2, s[24:27], s39 offen offset:3072
  v_exp_f32 v56, v56
  v_exp_f32 v57, v57
  v_cvt_pk_bf16_f32 v39, v54, v55
  v_exp_f32 v58, v58
  v_exp_f32 v59, v59
  v_mfma_f32_32x32x16_bf16 v[80:95], v[240:243], v[36:39], v[80:95]
  v_cvt_pk_bf16_f32 v40, v56, v57
  v_exp_f32 v60, v60
  v_exp_f32 v61, v61
  v_cvt_pk_bf16_f32 v41, v58, v59
  v_exp_f32 v62, v62
  v_exp_f32 v63, v63
  v_cvt_pk_bf16_f32 v42, v60, v61
  v_cvt_pk_bf16_f32 v43, v62, v63
  s_waitcnt lgkmcnt(0)
  v_mfma_f32_32x32x16_bf16 v[48:63], v[24:27], v[16:19], 0
  v_exp_f32 v64, v64
  v_exp_f32 v65, v65
  v_exp_f32 v66, v66
  v_exp_f32 v67, v67
  v_mfma_f32_32x32x16_bf16 v[80:95], v[32:35], v[40:43], v[80:95]
  v_cvt_pk_bf16_f32 v36, v64, v65
  v_exp_f32 v68, v68
  v_exp_f32 v69, v69
  v_cvt_pk_bf16_f32 v37, v66, v67
  v_exp_f32 v70, v70
  v_exp_f32 v71, v71
  v_cvt_pk_bf16_f32 v38, v68, v69
  s_xor_b32 s46, s91, 1
  s_mul_i32 s46, s46, 43
  s_add_u32 s46, s46, s94
  s_add_u32 s46, s46, s95
  s_lshl_b32 s46, s46, 14
  s_lshl_b32 s47, s31, 10
  s_add_u32 s46, s46, s47
  s_add_u32 s46, s46, 12058624
  buffer_load_dwordx4 v[208:211], v2, s[8:11], s46 offen offset:0 sc1
  v_exp_f32 v72, v72
  v_exp_f32 v73, v73
  v_cvt_pk_bf16_f32 v39, v70, v71
  v_exp_f32 v74, v74
  v_exp_f32 v75, v75
  v_mfma_f32_32x32x16_bf16 v[96:111], v[240:243], v[36:39], v[96:111]
  v_cvt_pk_bf16_f32 v40, v72, v73
  v_exp_f32 v76, v76
  v_exp_f32 v77, v77
  v_cvt_pk_bf16_f32 v41, v74, v75
  v_exp_f32 v78, v78
  v_exp_f32 v79, v79
  v_cvt_pk_bf16_f32 v42, v76, v77
  v_cvt_pk_bf16_f32 v43, v78, v79
  s_setprio 1
  v_mfma_f32_32x32x16_bf16 v[64:79], v[24:27], v[20:23], 0
  v_exp_f32 v48, v48
  v_exp_f32 v49, v49
  v_exp_f32 v50, v50
  v_exp_f32 v51, v51
  v_mfma_f32_32x32x16_bf16 v[96:111], v[32:35], v[40:43], v[96:111]
  ds_read_b128 v[24:27], v4 offset:27648
  s_mov_b64 exec, s[44:45]
  ds_read_b128 v[32:35], v5 offset:27136
  ds_read_b128 v[240:243], v5 offset:27648
  s_mov_b64 exec, -1
  v_cvt_pk_bf16_f32 v36, v48, v49
  v_exp_f32 v52, v52
  v_exp_f32 v53, v53
  v_cvt_pk_bf16_f32 v37, v50, v51
  v_exp_f32 v54, v54
  v_exp_f32 v55, v55
  v_cvt_pk_bf16_f32 v38, v52, v53
  buffer_load_dwordx4 v[212:215], v2, s[8:11], s46 offen offset:2048 sc1
  v_exp_f32 v56, v56
  v_exp_f32 v57, v57
  v_cvt_pk_bf16_f32 v39, v54, v55
  v_exp_f32 v58, v58
  v_exp_f32 v59, v59
  v_mfma_f32_32x32x16_bf16 v[80:95], v[28:31], v[36:39], v[80:95]
  v_cvt_pk_bf16_f32 v40, v56, v57
  v_exp_f32 v60, v60
  v_exp_f32 v61, v61
  v_cvt_pk_bf16_f32 v41, v58, v59
  v_exp_f32 v62, v62
  v_exp_f32 v63, v63
  v_cvt_pk_bf16_f32 v42, v60, v61
  v_cvt_pk_bf16_f32 v43, v62, v63
  s_waitcnt lgkmcnt(0)
  v_mfma_f32_32x32x16_bf16 v[48:63], v[24:27], v[16:19], 0
  v_exp_f32 v64, v64
  v_exp_f32 v65, v65
  v_exp_f32 v66, v66
  v_exp_f32 v67, v67
  v_mfma_f32_32x32x16_bf16 v[80:95], v[32:35], v[40:43], v[80:95]
  v_cvt_pk_bf16_f32 v36, v64, v65
  v_exp_f32 v68, v68
  v_exp_f32 v69, v69
  v_cvt_pk_bf16_f32 v37, v66, v67
  v_exp_f32 v70, v70
  v_exp_f32 v71, v71
  v_cvt_pk_bf16_f32 v38, v68, v69
  s_add_u32 s46, s46, 4096
  buffer_load_dwordx4 v[216:219], v2, s[8:11], s46 offen offset:0 sc1
  v_exp_f32 v72, v72
  v_exp_f32 v73, v73
  v_cvt_pk_bf16_f32 v39, v70, v71
  v_exp_f32 v74, v74
  v_exp_f32 v75, v75
  v_mfma_f32_32x32x16_bf16 v[96:111], v[28:31], v[36:39], v[96:111]
  v_cvt_pk_bf16_f32 v40, v72, v73
  v_exp_f32 v76, v76
  v_exp_f32 v77, v77
  v_cvt_pk_bf16_f32 v41, v74, v75
  v_exp_f32 v78, v78
  v_exp_f32 v79, v79
  v_cvt_pk_bf16_f32 v42, v76, v77
  v_cvt_pk_bf16_f32 v43, v78, v79
  s_setprio 0
  v_mfma_f32_32x32x16_bf16 v[64:79], v[24:27], v[20:23], 0
  v_exp_f32 v48, v48
  v_exp_f32 v49, v49
  v_exp_f32 v50, v50
  v_exp_f32 v51, v51
  v_mfma_f32_32x32x16_bf16 v[96:111], v[32:35], v[40:43], v[96:111]
  ds_read_b128 v[24:27], v4 offset:28672
  s_mov_b64 exec, s[44:45]
  ds_read_b128 v[32:35], v5 offset:28160
  ds_read_b128 v[28:31], v5 offset:28672
  s_mov_b64 exec, -1
  v_cvt_pk_bf16_f32 v36, v48, v49
  v_exp_f32 v52, v52
  v_exp_f32 v53, v53
  v_cvt_pk_bf16_f32 v37, v50, v51
  v_exp_f32 v54, v54
  v_exp_f32 v55, v55
  v_cvt_pk_bf16_f32 v38, v52, v53
  buffer_load_dwordx4 v[220:223], v2, s[8:11], s46 offen offset:2048 sc1
  v_exp_f32 v56, v56
  v_exp_f32 v57, v57
  v_cvt_pk_bf16_f32 v39, v54, v55
  v_exp_f32 v58, v58
  v_exp_f32 v59, v59
  v_mfma_f32_32x32x16_bf16 v[80:95], v[240:243], v[36:39], v[80:95]
  v_cvt_pk_bf16_f32 v40, v56, v57
  v_exp_f32 v60, v60
  v_exp_f32 v61, v61
  v_cvt_pk_bf16_f32 v41, v58, v59
  v_exp_f32 v62, v62
  v_exp_f32 v63, v63
  v_cvt_pk_bf16_f32 v42, v60, v61
  v_cvt_pk_bf16_f32 v43, v62, v63
  s_waitcnt lgkmcnt(0)
  v_mfma_f32_32x32x16_bf16 v[48:63], v[24:27], v[16:19], 0
  v_exp_f32 v64, v64
  v_exp_f32 v65, v65
  v_exp_f32 v66, v66
  v_exp_f32 v67, v67
  v_mfma_f32_32x32x16_bf16 v[80:95], v[32:35], v[40:43], v[80:95]
  v_cvt_pk_bf16_f32 v36, v64, v65
  v_exp_f32 v68, v68
  v_exp_f32 v69, v69
  v_cvt_pk_bf16_f32 v37, v66, v67
  v_exp_f32 v70, v70
  v_exp_f32 v71, v71
  v_cvt_pk_bf16_f32 v38, v68, v69
  s_add_u32 s46, s46, 4096
  buffer_load_dwordx4 v[224:227], v2, s[8:11], s46 offen offset:0 sc1
  v_exp_f32 v72, v72
  v_exp_f32 v73, v73
  v_cvt_pk_bf16_f32 v39, v70, v71
  v_exp_f32 v74, v74
  v_exp_f32 v75, v75
  v_mfma_f32_32x32x16_bf16 v[96:111], v[240:243], v[36:39], v[96:111]
  v_cvt_pk_bf16_f32 v40, v72, v73
  v_exp_f32 v76, v76
  v_exp_f32 v77, v77
  v_cvt_pk_bf16_f32 v41, v74, v75
  v_exp_f32 v78, v78
  v_exp_f32 v79, v79
  v_cvt_pk_bf16_f32 v42, v76, v77
  v_cvt_pk_bf16_f32 v43, v78, v79
  s_barrier
  s_setprio 3
  v_mfma_f32_32x32x16_bf16 v[64:79], v[24:27], v[20:23], 0
  v_exp_f32 v48, v48
  v_exp_f32 v49, v49
  v_exp_f32 v50, v50
  v_exp_f32 v51, v51
  v_mfma_f32_32x32x16_bf16 v[96:111], v[32:35], v[40:43], v[96:111]
  ds_read_b128 v[24:27], v4 offset:29696
  s_mov_b64 exec, s[44:45]
  ds_read_b128 v[32:35], v5 offset:29184
  ds_read_b128 v[240:243], v5 offset:29696
  s_mov_b64 exec, -1
  v_cvt_pk_bf16_f32 v36, v48, v49
  v_exp_f32 v52, v52
  v_exp_f32 v53, v53
  v_cvt_pk_bf16_f32 v37, v50, v51
  v_exp_f32 v54, v54
  v_exp_f32 v55, v55
  v_cvt_pk_bf16_f32 v38, v52, v53
  buffer_load_dwordx4 v[228:231], v2, s[8:11], s46 offen offset:2048 sc1
  v_exp_f32 v56, v56
  v_exp_f32 v57, v57
  v_cvt_pk_bf16_f32 v39, v54, v55
  v_exp_f32 v58, v58
  v_exp_f32 v59, v59
  v_mfma_f32_32x32x16_bf16 v[80:95], v[28:31], v[36:39], v[80:95]
  v_cvt_pk_bf16_f32 v40, v56, v57
  v_exp_f32 v60, v60
  v_exp_f32 v61, v61
  v_cvt_pk_bf16_f32 v41, v58, v59
  v_exp_f32 v62, v62
  v_exp_f32 v63, v63
  v_cvt_pk_bf16_f32 v42, v60, v61
  v_cvt_pk_bf16_f32 v43, v62, v63
  s_waitcnt lgkmcnt(0)
  v_mfma_f32_32x32x16_bf16 v[48:63], v[24:27], v[16:19], 0
  v_exp_f32 v64, v64
  v_exp_f32 v65, v65
  v_exp_f32 v66, v66
  v_exp_f32 v67, v67
  v_mfma_f32_32x32x16_bf16 v[80:95], v[32:35], v[40:43], v[80:95]
  v_cvt_pk_bf16_f32 v36, v64, v65
  v_exp_f32 v68, v68
  v_exp_f32 v69, v69
  v_cvt_pk_bf16_f32 v37, v66, v67
  v_exp_f32 v70, v70
  v_exp_f32 v71, v71
  v_cvt_pk_bf16_f32 v38, v68, v69
  s_add_u32 s46, s46, 4096
  buffer_load_dwordx4 v[232:235], v2, s[8:11], s46 offen offset:0 sc1
  v_exp_f32 v72, v72
  v_exp_f32 v73, v73
  v_cvt_pk_bf16_f32 v39, v70, v71
  v_exp_f32 v74, v74
  v_exp_f32 v75, v75
  v_mfma_f32_32x32x16_bf16 v[96:111], v[28:31], v[36:39], v[96:111]
  v_cvt_pk_bf16_f32 v40, v72, v73
  v_exp_f32 v76, v76
  v_exp_f32 v77, v77
  v_cvt_pk_bf16_f32 v41, v74, v75
  v_exp_f32 v78, v78
  v_exp_f32 v79, v79
  v_cvt_pk_bf16_f32 v42, v76, v77
  v_cvt_pk_bf16_f32 v43, v78, v79
  s_setprio 2
  v_mfma_f32_32x32x16_bf16 v[64:79], v[24:27], v[20:23], 0
  v_exp_f32 v48, v48
  v_exp_f32 v49, v49
  v_exp_f32 v50, v50
  v_exp_f32 v51, v51
  v_mfma_f32_32x32x16_bf16 v[96:111], v[32:35], v[40:43], v[96:111]
  ds_read_b128 v[24:27], v4 offset:30720
  s_mov_b64 exec, s[44:45]
  ds_read_b128 v[32:35], v5 offset:30208
  ds_read_b128 v[28:31], v5 offset:30720
  s_mov_b64 exec, -1
  v_cvt_pk_bf16_f32 v36, v48, v49
  v_exp_f32 v52, v52
  v_exp_f32 v53, v53
  v_cvt_pk_bf16_f32 v37, v50, v51
  v_exp_f32 v54, v54
  v_exp_f32 v55, v55
  v_cvt_pk_bf16_f32 v38, v52, v53
  buffer_load_dwordx4 v[236:239], v2, s[8:11], s46 offen offset:2048 sc1
  v_exp_f32 v56, v56
  v_exp_f32 v57, v57
  v_cvt_pk_bf16_f32 v39, v54, v55
  v_exp_f32 v58, v58
  v_exp_f32 v59, v59
  v_mfma_f32_32x32x16_bf16 v[80:95], v[240:243], v[36:39], v[80:95]
  v_cvt_pk_bf16_f32 v40, v56, v57
  v_exp_f32 v60, v60
  v_exp_f32 v61, v61
  v_cvt_pk_bf16_f32 v41, v58, v59
  v_exp_f32 v62, v62
  v_exp_f32 v63, v63
  v_cvt_pk_bf16_f32 v42, v60, v61
  v_cvt_pk_bf16_f32 v43, v62, v63
  s_waitcnt lgkmcnt(0)
  v_mfma_f32_32x32x16_bf16 v[48:63], v[24:27], v[16:19], 0
  v_exp_f32 v64, v64
  v_exp_f32 v65, v65
  v_exp_f32 v66, v66
  v_exp_f32 v67, v67
  v_mfma_f32_32x32x16_bf16 v[80:95], v[32:35], v[40:43], v[80:95]
  v_cvt_pk_bf16_f32 v36, v64, v65
  v_exp_f32 v68, v68
  v_exp_f32 v69, v69
  v_cvt_pk_bf16_f32 v37, v66, v67
  v_exp_f32 v70, v70
  v_exp_f32 v71, v71
  v_cvt_pk_bf16_f32 v38, v68, v69
  s_load_dwordx2 s[60:61], s[0:1], 64
  s_mov_b32 s62, 4096
  s_mov_b32 s63, 0x20000
  s_load_dwordx2 s[16:17], s[0:1], 80
  s_mov_b32 s18, 2097152
  s_mov_b32 s19, 0x20000
  v_exp_f32 v72, v72
  v_exp_f32 v73, v73
  v_cvt_pk_bf16_f32 v39, v70, v71
  v_exp_f32 v74, v74
  v_exp_f32 v75, v75
  v_mfma_f32_32x32x16_bf16 v[96:111], v[240:243], v[36:39], v[96:111]
  v_cvt_pk_bf16_f32 v40, v72, v73
  v_exp_f32 v76, v76
  v_exp_f32 v77, v77
  v_cvt_pk_bf16_f32 v41, v74, v75
  v_exp_f32 v78, v78
  v_exp_f32 v79, v79
  v_cvt_pk_bf16_f32 v42, v76, v77
  v_cvt_pk_bf16_f32 v43, v78, v79
  s_setprio 1
  v_mfma_f32_32x32x16_bf16 v[64:79], v[24:27], v[20:23], 0
  v_exp_f32 v48, v48
  v_exp_f32 v49, v49
  v_exp_f32 v50, v50
  v_exp_f32 v51, v51
  v_mfma_f32_32x32x16_bf16 v[96:111], v[32:35], v[40:43], v[96:111]
  ds_read_b128 v[24:27], v4 offset:31744
  s_mov_b64 exec, s[44:45]
  ds_read_b128 v[32:35], v5 offset:31232
  ds_read_b128 v[240:243], v5 offset:31744
  s_mov_b64 exec, -1
  v_cvt_pk_bf16_f32 v36, v48, v49
  v_exp_f32 v52, v52
  v_exp_f32 v53, v53
  v_cvt_pk_bf16_f32 v37, v50, v51
  v_exp_f32 v54, v54
  v_exp_f32 v55, v55
  v_cvt_pk_bf16_f32 v38, v52, v53
  v_lshlrev_b32 v13, 1, v10
  s_lshl_b32 s39, s5, 7
  s_lshl_b32 s49, s32, 5
  s_add_u32 s39, s39, s49
  s_waitcnt lgkmcnt(0)
  buffer_load_ushort v253, v13, s[60:63], s39 offen
  v_exp_f32 v56, v56
  v_exp_f32 v57, v57
  v_cvt_pk_bf16_f32 v39, v54, v55
  v_exp_f32 v58, v58
  v_exp_f32 v59, v59
  v_mfma_f32_32x32x16_bf16 v[80:95], v[28:31], v[36:39], v[80:95]
  v_cvt_pk_bf16_f32 v40, v56, v57
  v_exp_f32 v60, v60
  v_exp_f32 v61, v61
  v_cvt_pk_bf16_f32 v41, v58, v59
  v_exp_f32 v62, v62
  v_exp_f32 v63, v63
  v_cvt_pk_bf16_f32 v42, v60, v61
  v_cvt_pk_bf16_f32 v43, v62, v63
  s_waitcnt lgkmcnt(0)
  v_mfma_f32_32x32x16_bf16 v[48:63], v[24:27], v[16:19], 0
  v_exp_f32 v64, v64
  v_exp_f32 v65, v65
  v_exp_f32 v66, v66
  v_exp_f32 v67, v67
  v_mfma_f32_32x32x16_bf16 v[80:95], v[32:35], v[40:43], v[80:95]
  v_cvt_pk_bf16_f32 v36, v64, v65
  v_exp_f32 v68, v68
  v_exp_f32 v69, v69
  v_cvt_pk_bf16_f32 v37, v66, v67
  v_exp_f32 v70, v70
  v_exp_f32 v71, v71
  v_cvt_pk_bf16_f32 v38, v68, v69
  v_exp_f32 v72, v72
  v_exp_f32 v73, v73
  v_cvt_pk_bf16_f32 v39, v70, v71
  v_exp_f32 v74, v74
  v_exp_f32 v75, v75
  v_mfma_f32_32x32x16_bf16 v[96:111], v[28:31], v[36:39], v[96:111]
  v_cvt_pk_bf16_f32 v40, v72, v73
  v_exp_f32 v76, v76
  v_exp_f32 v77, v77
  v_cvt_pk_bf16_f32 v41, v74, v75
  v_exp_f32 v78, v78
  v_exp_f32 v79, v79
  v_cvt_pk_bf16_f32 v42, v76, v77
  v_cvt_pk_bf16_f32 v43, v78, v79
  s_setprio 0
  v_mfma_f32_32x32x16_bf16 v[64:79], v[24:27], v[20:23], 0
  v_exp_f32 v48, v48
  v_exp_f32 v49, v49
  v_exp_f32 v50, v50
  v_exp_f32 v51, v51
  v_mfma_f32_32x32x16_bf16 v[96:111], v[32:35], v[40:43], v[96:111]
  ds_read_b128 v[24:27], v4 offset:32768
  s_mov_b64 exec, s[44:45]
  ds_read_b128 v[32:35], v5 offset:32256
  ds_read_b128 v[28:31], v5 offset:32768
  s_mov_b64 exec, -1
  v_cvt_pk_bf16_f32 v36, v48, v49
  v_exp_f32 v52, v52
  v_exp_f32 v53, v53
  v_cvt_pk_bf16_f32 v37, v50, v51
  v_exp_f32 v54, v54
  v_exp_f32 v55, v55
  v_cvt_pk_bf16_f32 v38, v52, v53
  v_exp_f32 v56, v56
  v_exp_f32 v57, v57
  v_cvt_pk_bf16_f32 v39, v54, v55
  v_exp_f32 v58, v58
  v_exp_f32 v59, v59
  v_mfma_f32_32x32x16_bf16 v[80:95], v[240:243], v[36:39], v[80:95]
  v_cvt_pk_bf16_f32 v40, v56, v57
  v_exp_f32 v60, v60
  v_exp_f32 v61, v61
  v_cvt_pk_bf16_f32 v41, v58, v59
  v_exp_f32 v62, v62
  v_exp_f32 v63, v63
  v_cvt_pk_bf16_f32 v42, v60, v61
  v_cvt_pk_bf16_f32 v43, v62, v63
  s_waitcnt lgkmcnt(0)
  v_mfma_f32_32x32x16_bf16 v[48:63], v[24:27], v[16:19], 0
  v_exp_f32 v64, v64
  v_exp_f32 v65, v65
  v_exp_f32 v66, v66
  v_exp_f32 v67, v67
  v_mfma_f32_32x32x16_bf16 v[80:95], v[32:35], v[40:43], v[80:95]
  v_cvt_pk_bf16_f32 v36, v64, v65
  v_exp_f32 v68, v68
  v_exp_f32 v69, v69
  v_cvt_pk_bf16_f32 v37, v66, v67
  v_exp_f32 v70, v70
  v_exp_f32 v71, v71
  v_cvt_pk_bf16_f32 v38, v68, v69
  v_exp_f32 v72, v72
  v_exp_f32 v73, v73
  v_cvt_pk_bf16_f32 v39, v70, v71
  v_exp_f32 v74, v74
  v_exp_f32 v75, v75
  v_mfma_f32_32x32x16_bf16 v[96:111], v[240:243], v[36:39], v[96:111]
  v_cvt_pk_bf16_f32 v40, v72, v73
  v_exp_f32 v76, v76
  v_exp_f32 v77, v77
  v_cvt_pk_bf16_f32 v41, v74, v75
  v_exp_f32 v78, v78
  v_exp_f32 v79, v79
  v_cvt_pk_bf16_f32 v42, v76, v77
  v_cvt_pk_bf16_f32 v43, v78, v79
  s_setprio 0
  s_nop 0
  v_mfma_f32_32x32x16_bf16 v[96:111], v[32:35], v[40:43], v[96:111]
sequential_preLN__grouped_kv_mqa__mixer_gmlp__prompt_kernel_join32:
  s_mul_i32 s36, s4, 2304
  s_add_u32 s36, s36, 66560
  v_add_u32 v13, s36, v2
  v_lshlrev_b32 v6, 2, v1
  v_add_u32 v14, s36, v6
  s_xor_b32 s37, s4, 4
  s_mul_i32 s36, s37, 2304
  s_add_u32 s36, s36, 66560
  v_add_u32 v11, s36, v2
  v_add_u32 v12, s36, v6
  s_lshl_b32 s34, s5, 16
  s_lshl_b32 s49, s30, 15
  s_add_u32 s34, s34, s49
  s_lshl_b32 s49, s6, 12
  s_add_u32 s34, s34, s49
  s_lshl_b32 s49, s29, 11
  s_add_u32 s34, s34, s49
  s_lshl_b32 s49, s31, 10
  s_add_u32 s34, s34, s49
  s_add_u32 s34, s34, 1048576
  s_lshl_b32 s33, s5, 16
  s_lshl_b32 s49, s4, 12
  s_add_u32 s33, s33, s49
  s_add_u32 s33, s33, 1048576
  s_lshl_b32 s35, s4, 12
  s_cmp_eq_u32 s31, 0
  s_cbranch_scc1 sequential_preLN__grouped_kv_mqa__mixer_gmlp__prompt_kernel_L47
  ds_write_b128 v13, v[80:83]
  ds_write_b128 v13, v[84:87] offset:1024
  ds_write_b32 v14, v88 offset:2048
  v_mov_b32 v80, v96
  v_mov_b32 v81, v97
  v_mov_b32 v82, v98
  v_mov_b32 v83, v99
  v_mov_b32 v84, v100
  v_mov_b32 v85, v101
  v_mov_b32 v86, v102
  v_mov_b32 v87, v103
  v_mov_b32 v88, v104
  s_branch sequential_preLN__grouped_kv_mqa__mixer_gmlp__prompt_kernel_L48
sequential_preLN__grouped_kv_mqa__mixer_gmlp__prompt_kernel_L47:
  ds_write_b128 v13, v[96:99]
  ds_write_b128 v13, v[100:103] offset:1024
  ds_write_b32 v14, v104 offset:2048
sequential_preLN__grouped_kv_mqa__mixer_gmlp__prompt_kernel_L48:
  s_waitcnt lgkmcnt(0)
  s_barrier
  ds_read_b32 v32, v12 offset:2048
  ds_read_b128 v[24:27], v11
  ds_read_b128 v[28:31], v11 offset:1024
  s_waitcnt lgkmcnt(2)
  v_add_f32 v88, v88, v32
  v_rcp_f32 v89, v88
  v_rcp_f32 v88, v88
  s_waitcnt lgkmcnt(0)
  v_pk_add_f32 v[80:81], v[80:81], v[24:25]
  v_pk_add_f32 v[82:83], v[82:83], v[26:27]
  v_pk_add_f32 v[84:85], v[84:85], v[28:29]
  v_pk_add_f32 v[86:87], v[86:87], v[30:31]
  v_pk_mul_f32 v[80:81], v[80:81], v[88:89]
  v_pk_mul_f32 v[82:83], v[82:83], v[88:89]
  v_pk_mul_f32 v[84:85], v[84:85], v[88:89]
  v_pk_mul_f32 v[86:87], v[86:87], v[88:89]
  v_cvt_pk_bf16_f32 v24, v80, v81
  v_cvt_pk_bf16_f32 v25, v82, v83
  v_cvt_pk_bf16_f32 v26, v84, v85
  v_cvt_pk_bf16_f32 v27, v86, v87
  s_cmp_eq_u32 s68, 0
  s_cbranch_scc1 sequential_preLN__grouped_kv_mqa__mixer_gmlp__prompt_kernel_L49
  buffer_store_dwordx4 v[24:27], v2, s[8:11], s34 offen
  s_branch sequential_preLN__grouped_kv_mqa__mixer_gmlp__prompt_kernel_L50
sequential_preLN__grouped_kv_mqa__mixer_gmlp__prompt_kernel_L49:
  buffer_store_dwordx4 v[24:27], v2, s[8:11], s34 offen sc1
sequential_preLN__grouped_kv_mqa__mixer_gmlp__prompt_kernel_L50:
  s_and_b32 s36, s34, 0xffff
  v_add_u32 v13, s36, v2
  ds_write_b128 v13, v[24:27]
  s_mov_b32 s48, 100000
  v_lshrrev_b32 v6, 4, v1
  v_lshlrev_b32 v6, 10, v6
  v_lshl_add_u32 v6, v10, 4, v6
  s_lshr_b32 s40, s6, 1
  s_and_b32 s41, s6, 1
  s_lshl_b32 s76, s5, 12
  s_lshl_b32 s49, s40, 8
  s_add_u32 s76, s76, s49
  s_lshl_b32 s49, s41, 3
  s_add_u32 s76, s76, s49
  s_lshl_b32 s37, s30, 15
  s_lshl_b32 s49, s31, 10
  s_add_u32 s37, s37, s49
  v_add_u32 v3, s37, v2
  s_lshl_b32 s39, s4, 11
  s_add_u32 s39, s39, 131072
  v_add_u32 v4, s39, v2
  v_xor_b32 v5, 0x2000, v4
  v_lshlrev_b32 v12, 4, v10
  v_lshl_add_u32 v12, v9, 8, v12
  v_bfe_u32 v11, v1, 4, 1
  v_lshl_add_u32 v12, v11, 14, v12
  s_lshl_b32 s43, s5, 16
  s_lshl_b32 s49, s30, 15
  s_add_u32 s43, s43, s49
  s_lshl_b32 s49, s6, 11
  s_add_u32 s43, s43, s49
  s_lshl_b32 s49, s29, 10
  s_add_u32 s43, s43, s49
  s_lshl_b32 s49, s31, 9
  s_add_u32 s43, s43, s49
  s_add_u32 s43, s43, 3145728
  s_lshl_b32 s55, s5, 16
  s_lshl_b32 s49, s4, 11
  s_add_u32 s55, s55, s49
  s_add_u32 s55, s55, 3145728
  s_lshl_b32 s56, s4, 11
  s_lshl_b32 s40, s31, 10
  s_lshl_b32 s49, s29, 9
  s_add_u32 s40, s40, s49
  s_lshl_b32 s49, s30, 8
  s_add_u32 s40, s40, s49
  s_add_u32 s40, s40, 157696
  v_lshlrev_b32 v11, 3, v8
  v_add_u32 v11, s40, v11
  v_lshlrev_b32 v32, 16, v44
  v_and_b32 v33, 0xffff0000, v44
  v_lshlrev_b32 v34, 16, v45
  v_and_b32 v35, 0xffff0000, v45
  v_lshlrev_b32 v36, 16, v46
  v_and_b32 v37, 0xffff0000, v46
  v_lshlrev_b32 v38, 16, v47
  v_and_b32 v39, 0xffff0000, v47
  v_add_u32 v14, s35, v2
  s_cmp_eq_u32 s4, s6
  s_cbranch_scc1 sequential_preLN__grouped_kv_mqa__mixer_gmlp__prompt_kernel_landx52
sequential_preLN__grouped_kv_mqa__mixer_gmlp__prompt_kernel_land51:
  s_add_u32 m0, s35, 0
  s_add_u32 s36, s33, 0
  buffer_load_dwordx4 v2, s[8:11], s36 offen offset:0 sc1 lds
  buffer_load_dwordx4 v2, s[8:11], s36 offen offset:1024 sc1 lds
  buffer_load_dwordx4 v2, s[8:11], s36 offen offset:2048 sc1 lds
  buffer_load_dwordx4 v2, s[8:11], s36 offen offset:3072 sc1 lds
  s_add_u32 m0, s35, 32768
  s_add_u32 s36, s33, 32768
  buffer_load_dwordx4 v2, s[8:11], s36 offen offset:0 sc1 lds
  buffer_load_dwordx4 v2, s[8:11], s36 offen offset:1024 sc1 lds
  buffer_load_dwordx4 v2, s[8:11], s36 offen offset:2048 sc1 lds
  buffer_load_dwordx4 v2, s[8:11], s36 offen offset:3072 sc1 lds
sequential_preLN__grouped_kv_mqa__mixer_gmlp__prompt_kernel_landc53:
  s_waitcnt vmcnt(0)
  ds_read_b128 v[80:83], v14 offset:0
  ds_read_b128 v[84:87], v14 offset:1024
  ds_read_b128 v[88:91], v14 offset:2048
  ds_read_b128 v[92:95], v14 offset:3072
  ds_read_b128 v[96:99], v14 offset:32768
  ds_read_b128 v[100:103], v14 offset:33792
  ds_read_b128 v[104:107], v14 offset:34816
  ds_read_b128 v[108:111], v14 offset:35840
  s_waitcnt lgkmcnt(7)
  v_max3_u32 v13, v80, v81, v82
  v_max_u32 v13, v13, v83
  s_waitcnt lgkmcnt(6)
  v_max3_u32 v13, v13, v84, v85
  v_max3_u32 v13, v13, v86, v87
  s_waitcnt lgkmcnt(5)
  v_max3_u32 v13, v13, v88, v89
  v_max3_u32 v13, v13, v90, v91
  s_waitcnt lgkmcnt(4)
  v_max3_u32 v13, v13, v92, v93
  v_max3_u32 v13, v13, v94, v95
  s_waitcnt lgkmcnt(3)
  v_max3_u32 v13, v13, v96, v97
  v_max3_u32 v13, v13, v98, v99
  s_waitcnt lgkmcnt(2)
  v_max3_u32 v13, v13, v100, v101
  v_max3_u32 v13, v13, v102, v103
  s_waitcnt lgkmcnt(1)
  v_max3_u32 v13, v13, v104, v105
  v_max3_u32 v13, v13, v106, v107
  s_waitcnt lgkmcnt(0)
  v_max3_u32 v13, v13, v108, v109
  v_max3_u32 v13, v13, v110, v111
  v_cmp_eq_u32 vcc, -1, v13
  s_cbranch_vccz sequential_preLN__grouped_kv_mqa__mixer_gmlp__prompt_kernel_landx52
  s_sub_u32 s48, s48, 1
  s_cmp_lg_u32 s48, 0
  s_cbranch_scc1 sequential_preLN__grouped_kv_mqa__mixer_gmlp__prompt_kernel_land51
sequential_preLN__grouped_kv_mqa__mixer_gmlp__prompt_kernel_landx52:
  s_waitcnt vmcnt(0) lgkmcnt(0)
  s_barrier
  ds_read_b128 v[96:99], v3 offset:0
  ds_read_b128 v[100:103], v3 offset:2048
  ds_read_b128 v[104:107], v3 offset:4096
  ds_read_b128 v[108:111], v3 offset:6144
  s_waitcnt lgkmcnt(3)
  v_mfma_f32_32x32x16_bf16 v[80:95], v[112:115], v[96:99], 0
  ds_read_b128 v[96:99], v3 offset:8192
  s_mov_b32 s46, s93
  s_add_u32 s46, s46, s95
  s_lshl_b32 s46, s46, 14
  s_lshl_b32 s47, s31, 10
  s_add_u32 s46, s46, s47
  s_add_u32 s46, s46, 12058624
  s_add_u32 s46, s46, s92
  buffer_load_dwordx4 v[48:51], v2, s[8:11], s46 offen offset:0 sc1
  s_waitcnt lgkmcnt(3)
  v_mfma_f32_32x32x16_bf16 v[80:95], v[116:119], v[100:103], v[80:95]
  ds_read_b128 v[100:103], v3 offset:10240
  buffer_load_dwordx4 v[52:55], v2, s[8:11], s46 offen offset:2048 sc1
  s_waitcnt lgkmcnt(3)
  v_mfma_f32_32x32x16_bf16 v[80:95], v[120:123], v[104:107], v[80:95]
  ds_read_b128 v[104:107], v3 offset:12288
  s_add_u32 s46, s46, 4096
  buffer_load_dwordx4 v[56:59], v2, s[8:11], s46 offen offset:0 sc1
  s_waitcnt lgkmcnt(3)
  v_mfma_f32_32x32x16_bf16 v[80:95], v[124:127], v[108:111], v[80:95]
  ds_read_b128 v[108:111], v3 offset:14336
  buffer_load_dwordx4 v[60:63], v2, s[8:11], s46 offen offset:2048 sc1
  s_waitcnt lgkmcnt(3)
  v_mfma_f32_32x32x16_bf16 v[80:95], v[128:131], v[96:99], v[80:95]
  ds_read_b128 v[96:99], v3 offset:16384
  s_add_u32 s46, s46, 4096
  buffer_load_dwordx4 v[64:67], v2, s[8:11], s46 offen offset:0 sc1
  s_waitcnt lgkmcnt(3)
  v_mfma_f32_32x32x16_bf16 v[80:95], v[132:135], v[100:103], v[80:95]
  ds_read_b128 v[100:103], v3 offset:18432
  buffer_load_dwordx4 v[68:71], v2, s[8:11], s46 offen offset:2048 sc1
  s_waitcnt lgkmcnt(3)
  v_mfma_f32_32x32x16_bf16 v[80:95], v[136:139], v[104:107], v[80:95]
  ds_read_b128 v[104:107], v3 offset:20480
  s_add_u32 s46, s46, 4096
  buffer_load_dwordx4 v[72:75], v2, s[8:11], s46 offen offset:0 sc1
  s_waitcnt lgkmcnt(3)
  v_mfma_f32_32x32x16_bf16 v[80:95], v[140:143], v[108:111], v[80:95]
  ds_read_b128 v[108:111], v3 offset:22528
  buffer_load_dwordx4 v[76:79], v2, s[8:11], s46 offen offset:2048 sc1
  s_waitcnt lgkmcnt(3)
  v_mfma_f32_32x32x16_bf16 v[80:95], v[144:147], v[96:99], v[80:95]
  ds_read_b128 v[96:99], v3 offset:24576
  s_waitcnt lgkmcnt(3)
  v_mfma_f32_32x32x16_bf16 v[80:95], v[148:151], v[100:103], v[80:95]
  ds_read_b128 v[100:103], v3 offset:26624
  s_waitcnt lgkmcnt(3)
  v_mfma_f32_32x32x16_bf16 v[80:95], v[152:155], v[104:107], v[80:95]
  ds_read_b128 v[104:107], v3 offset:28672
  s_waitcnt lgkmcnt(3)
  v_mfma_f32_32x32x16_bf16 v[80:95], v[156:159], v[108:111], v[80:95]
  ds_read_b128 v[108:111], v3 offset:30720
  s_waitcnt lgkmcnt(3)
  v_mfma_f32_32x32x16_bf16 v[80:95], v[160:163], v[96:99], v[80:95]
  s_waitcnt lgkmcnt(2)
  v_mfma_f32_32x32x16_bf16 v[80:95], v[164:167], v[100:103], v[80:95]
  s_waitcnt lgkmcnt(1)
  v_mfma_f32_32x32x16_bf16 v[80:95], v[168:171], v[104:107], v[80:95]
  s_waitcnt lgkmcnt(0)
  v_mfma_f32_32x32x16_bf16 v[80:95], v[172:175], v[108:111], v[80:95]
  s_cmp_eq_u32 s31, 0
  s_cbranch_scc1 sequential_preLN__grouped_kv_mqa__mixer_gmlp__prompt_kernel_L54
  s_nop 9
  ds_write_b128 v4, v[80:83]
  ds_write_b128 v4, v[84:87] offset:1024
  v_pk_add_f32 v[80:81], v[88:89], v[32:33]
  v_pk_add_f32 v[82:83], v[90:91], v[34:35]
  v_pk_add_f32 v[84:85], v[92:93], v[36:37]
  v_pk_add_f32 v[86:87], v[94:95], v[38:39]
  s_branch sequential_preLN__grouped_kv_mqa__mixer_gmlp__prompt_kernel_L55
sequential_preLN__grouped_kv_mqa__mixer_gmlp__prompt_kernel_L54:
  s_nop 9
  ds_write_b128 v4, v[88:91]
  ds_write_b128 v4, v[92:95] offset:1024
  v_pk_add_f32 v[80:81], v[80:81], v[32:33]
  v_pk_add_f32 v[82:83], v[82:83], v[34:35]
  v_pk_add_f32 v[84:85], v[84:85], v[36:37]
  v_pk_add_f32 v[86:87], v[86:87], v[38:39]
sequential_preLN__grouped_kv_mqa__mixer_gmlp__prompt_kernel_L55:
  s_waitcnt lgkmcnt(0)
  s_barrier
  ds_read_b128 v[96:99], v5
  ds_read_b128 v[100:103], v5 offset:1024
  s_waitcnt lgkmcnt(0)
  v_pk_add_f32 v[80:81], v[80:81], v[96:97]
  v_pk_add_f32 v[82:83], v[82:83], v[98:99]
  v_pk_add_f32 v[84:85], v[84:85], v[100:101]
  v_pk_add_f32 v[86:87], v[86:87], v[102:103]
  v_cvt_pk_bf16_f32 v44, v80, v81
  v_cvt_pk_bf16_f32 v45, v82, v83
  v_cvt_pk_bf16_f32 v46, v84, v85
  v_cvt_pk_bf16_f32 v47, v86, v87
  s_cmp_eq_u32 s68, 0
  s_cbranch_scc1 sequential_preLN__grouped_kv_mqa__mixer_gmlp__prompt_kernel_L56
  buffer_store_dwordx4 v[44:47], v12, s[8:11], s43 offen
  s_branch sequential_preLN__grouped_kv_mqa__mixer_gmlp__prompt_kernel_L57
sequential_preLN__grouped_kv_mqa__mixer_gmlp__prompt_kernel_L56:
  buffer_store_dwordx4 v[44:47], v12, s[8:11], s43 offen sc1
sequential_preLN__grouped_kv_mqa__mixer_gmlp__prompt_kernel_L57:
  s_and_b32 s36, s43, 0xffff
  v_add_u32 v13, s36, v12
  ds_write_b128 v13, v[44:47]
  s_mov_b32 s48, 100000
  v_dot2_f32_bf16 v24, v44, s28, 0
  v_dot2_f32_bf16 v25, v44, v44, 0
  v_dot2_f32_bf16 v26, v45, s28, 0
  v_dot2_f32_bf16 v27, v45, v45, 0
  v_dot2_f32_bf16 v28, v46, s28, 0
  v_dot2_f32_bf16 v29, v46, v46, 0
  v_dot2_f32_bf16 v30, v47, s28, 0
  v_dot2_f32_bf16 v31, v47, v47, 0
  v_pk_add_f32 v[24:25], v[24:25], v[26:27]
  s_nop 1
  v_pk_add_f32 v[28:29], v[28:29], v[30:31]
  v_pk_add_f32 v[24:25], v[24:25], v[28:29]
  v_mov_b32 v26, v24
  v_mov_b32 v27, v25
  s_nop 0
  v_permlane32_swap_b32 v24, v26
  v_permlane32_swap_b32 v25, v27
  v_pk_add_f32 v[24:25], v[24:25], v[26:27]
  ds_write_b64 v11, v[24:25]
  s_lshl_b32 s98, s5, 18
  s_lshl_b32 s49, s29, 17
  s_add_u32 s98, s98, s49
  s_lshl_b32 s49, s32, 10
  s_add_u32 s98, s98, s49
  v_lshrrev_b32 v13, 3, v1
  v_and_b32 v8, 7, v1
  v_xor_b32 v8, v8, v13
  v_lshlrev_b32 v8, 4, v8
  v_lshl_add_u32 v8, v13, 12, v8
  s_lshl_b32 s99, s32, 14
  s_lshl_b32 s49, s29, 12
  s_add_u32 s99, s99, s49
  s_lshl_b32 s38, s31, 10
  v_add_u32 v3, s38, v2
  s_lshl_b32 s74, s5, 12
  s_lshl_b32 s49, s31, 11
  s_add_u32 s74, s74, s49
  s_add_u32 s75, s74, 524288
  s_add_u32 s74, s74, 393216
  s_lshr_b32 s39, s90, 1
  s_lshl_b32 s38, s31, 1
  s_add_u32 s38, s38, s39
  s_mul_i32 s39, s38, 6144
  s_lshl_b32 s49, s91, 12
  s_add_u32 s39, s39, s49
  s_add_u32 s39, s39, 131072
  v_add_u32 v4, s39, v2
  s_xor_b32 s38, s38, 2
  s_mul_i32 s39, s38, 6144
  s_lshl_b32 s49, s91, 12
  s_add_u32 s39, s39, s49
  s_add_u32 s39, s39, 131072
  v_add_u32 v5, s39, v2
  v_lshrrev_b32 v13, 4, v1
  v_lshlrev_b32 v40, 5, v10
  v_lshl_add_u32 v40, v13, 3, v40
  v_add_u32 v40, s39, v40
  v_bfe_u32 v41, v1, 2, 2
  v_lshl_add_u32 v41, v13, 3, v41
  v_lshlrev_b32 v41, 5, v41
  v_and_b32 v13, 3, v1
  v_lshl_add_u32 v41, v13, 3, v41
  v_add_u32 v41, s39, v41
  s_lshl_b32 s38, s91, 13
  s_sub_u32 s38, 4096, s38
  v_add_u32 v42, s38, v4
  v_add_u32 v43, s38, v5
  s_add_u32 s87, s39, s38
  s_xor_b32 s38, s31, 1
  s_mul_i32 s39, s38, 12288
  s_mul_i32 s49, s29, 6144
  s_add_u32 s39, s39, s49
  s_lshl_b32 s49, s30, 9
  s_add_u32 s39, s39, s49
  s_add_u32 s39, s39, 131072
  v_lshlrev_b32 v12, 3, v1
  v_add_u32 v12, s39, v12
  s_lshl_b32 s39, s90, 9
  s_lshl_b32 s49, s31, 8
  s_add_u32 s39, s39, s49
  s_add_u32 s39, s39, 155648
  v_lshlrev_b32 v11, 3, v10
  v_add_u32 v11, s39, v11
  s_mov_b32 s39, s93
  s_add_u32 s39, s39, s95
  s_lshl_b32 s80, s39, 16
  s_lshl_b32 s49, s5, 11
  s_add_u32 s80, s80, s49
  s_lshl_b32 s49, s31, 10
  s_add_u32 s80, s80, s49
  s_add_u32 s80, s80, s92
  s_add_u32 s80, s80, 5242880
  s_mov_b32 s39, s94
  s_add_u32 s39, s39, s95
  s_lshl_b32 s81, s39, 16
  s_lshl_b32 s49, s5, 11
  s_add_u32 s81, s81, s49
  s_lshl_b32 s49, s31, 10
  s_add_u32 s81, s81, s49
  s_add_u32 s81, s81, 5242880
  v_add_u32 v14, s56, v2
  s_cmp_eq_u32 s4, s6
  s_cbranch_scc1 sequential_preLN__grouped_kv_mqa__mixer_gmlp__prompt_kernel_landx59
sequential_preLN__grouped_kv_mqa__mixer_gmlp__prompt_kernel_land58:
  s_add_u32 m0, s56, 0
  s_add_u32 s36, s55, 0
  buffer_load_dwordx4 v2, s[8:11], s36 offen offset:0 sc1 lds
  buffer_load_dwordx4 v2, s[8:11], s36 offen offset:1024 sc1 lds
  s_add_u32 m0, s56, 16384
  s_add_u32 s36, s55, 16384
  buffer_load_dwordx4 v2, s[8:11], s36 offen offset:0 sc1 lds
  buffer_load_dwordx4 v2, s[8:11], s36 offen offset:1024 sc1 lds
  s_add_u32 m0, s56, 32768
  s_add_u32 s36, s55, 32768
  buffer_load_dwordx4 v2, s[8:11], s36 offen offset:0 sc1 lds
  buffer_load_dwordx4 v2, s[8:11], s36 offen offset:1024 sc1 lds
  s_add_u32 m0, s56, 49152
  s_add_u32 s36, s55, 49152
  buffer_load_dwordx4 v2, s[8:11], s36 offen offset:0 sc1 lds
  buffer_load_dwordx4 v2, s[8:11], s36 offen offset:1024 sc1 lds
sequential_preLN__grouped_kv_mqa__mixer_gmlp__prompt_kernel_landc60:
  s_waitcnt vmcnt(0)
  ds_read_b128 v[80:83], v14 offset:0
  ds_read_b128 v[84:87], v14 offset:1024
  ds_read_b128 v[88:91], v14 offset:16384
  ds_read_b128 v[92:95], v14 offset:17408
  ds_read_b128 v[96:99], v14 offset:32768
  ds_read_b128 v[100:103], v14 offset:33792
  ds_read_b128 v[104:107], v14 offset:49152
  ds_read_b128 v[108:111], v14 offset:50176
  s_waitcnt lgkmcnt(7)
  v_max3_u32 v13, v80, v81, v82
  v_max_u32 v13, v13, v83
  s_waitcnt lgkmcnt(6)
  v_max3_u32 v13, v13, v84, v85
  v_max3_u32 v13, v13, v86, v87
  s_waitcnt lgkmcnt(5)
  v_max3_u32 v13, v13, v88, v89
  v_max3_u32 v13, v13, v90, v91
  s_waitcnt lgkmcnt(4)
  v_max3_u32 v13, v13, v92, v93
  v_max3_u32 v13, v13, v94, v95
  s_waitcnt lgkmcnt(3)
  v_max3_u32 v13, v13, v96, v97
  v_max3_u32 v13, v13, v98, v99
  s_waitcnt lgkmcnt(2)
  v_max3_u32 v13, v13, v100, v101
  v_max3_u32 v13, v13, v102, v103
  s_waitcnt lgkmcnt(1)
  v_max3_u32 v13, v13, v104, v105
  v_max3_u32 v13, v13, v106, v107
  s_waitcnt lgkmcnt(0)
  v_max3_u32 v13, v13, v108, v109
  v_max3_u32 v13, v13, v110, v111
  v_cmp_eq_u32 vcc, -1, v13
  s_cbranch_vccz sequential_preLN__grouped_kv_mqa__mixer_gmlp__prompt_kernel_landx59
  s_sub_u32 s48, s48, 1
  s_cmp_lg_u32 s48, 0
  s_cbranch_scc1 sequential_preLN__grouped_kv_mqa__mixer_gmlp__prompt_kernel_land58
sequential_preLN__grouped_kv_mqa__mixer_gmlp__prompt_kernel_landx59:
  s_waitcnt vmcnt(0) lgkmcnt(0)
  s_barrier
  s_cmp_lg_u32 s4, 0
  s_cbranch_scc1 sequential_preLN__grouped_kv_mqa__mixer_gmlp__prompt_kernel_L61
  v_lshlrev_b32 v13, 3, v1
  v_add_u32 v13, 157696, v13
  ds_read_b64 v[24:25], v13 offset:0
  ds_read_b64 v[26:27], v13 offset:512
  ds_read_b64 v[28:29], v13 offset:1024
  ds_read_b64 v[30:31], v13 offset:1536
  s_add_u32 s47, s76, 393216
  s_waitcnt lgkmcnt(0)
  v_pk_add_f32 v[24:25], v[24:25], v[26:27]
  v_pk_add_f32 v[28:29], v[28:29], v[30:31]
  v_pk_add_f32 v[24:25], v[24:25], v[28:29]
  s_cmp_eq_u32 s68, 0
  s_cbranch_scc1 sequential_preLN__grouped_kv_mqa__mixer_gmlp__prompt_kernel_L62
  buffer_store_dwordx2 v[24:25], v6, s[8:11], s47 offen
  s_branch sequential_preLN__grouped_kv_mqa__mixer_gmlp__prompt_kernel_L63
sequential_preLN__grouped_kv_mqa__mixer_gmlp__prompt_kernel_L62:
  buffer_store_dwordx2 v[24:25], v6, s[8:11], s47 offen sc1
sequential_preLN__grouped_kv_mqa__mixer_gmlp__prompt_kernel_L63:
sequential_preLN__grouped_kv_mqa__mixer_gmlp__prompt_kernel_L61:
  s_mov_b32 s72, 1.0
  s_mov_b32 s73, 1.0
  s_mov_b32 s82, 0x3b000000
  s_mov_b32 s83, 0x3b000000
  s_mov_b32 s84, 0x3abe82fa
  s_mov_b32 s85, 0x3abe82fa
  s_cmp_lg_u32 s91, 0
  s_cbranch_scc1 sequential_preLN__grouped_kv_mqa__mixer_gmlp__prompt_kernel_d164
  ds_read_b128 v[80:83], v3 offset:0
  ds_read_b128 v[84:87], v3 offset:16384
  ds_read_b128 v[88:91], v3 offset:32768
  ds_read_b128 v[92:95], v3 offset:49152
  ds_read_b128 v[96:99], v3 offset:2048
  ds_read_b128 v[100:103], v3 offset:18432
  ds_read_b128 v[104:107], v3 offset:34816
  ds_read_b128 v[108:111], v3 offset:51200
  ds_read_b128 v[160:163], v3 offset:4096
  ds_read_b128 v[164:167], v3 offset:20480
  ds_read_b128 v[168:171], v3 offset:36864
  ds_read_b128 v[172:175], v3 offset:53248
  s_waitcnt lgkmcnt(8)
  v_mfma_f32_16x16x32_bf16 v[112:115], v[176:179], v[80:83], 0
  ds_read_b128 v[24:27], v3 offset:6144
  ds_read_b128 v[28:31], v3 offset:22528
  ds_read_b128 v[32:35], v3 offset:38912
  v_mfma_f32_16x16x32_bf16 v[128:131], v[208:211], v[80:83], 0
  ds_read_b128 v[36:39], v3 offset:55296
  v_and_b32 v13, 48, v1
  s_lshl_b32 s36, s93, 6
  v_mfma_f32_16x16x32_bf16 v[116:119], v[176:179], v[84:87], 0
  s_lshl_b32 s49, s95, 6
  s_add_u32 s36, s36, s49
  s_add_u32 s36, s36, 658112
  v_mfma_f32_16x16x32_bf16 v[132:135], v[208:211], v[84:87], 0
  s_add_u32 s36, s36, s92
  buffer_load_dwordx4 v[240:243], v13, s[8:11], s36 offen sc1
  v_mfma_f32_16x16x32_bf16 v[120:123], v[176:179], v[88:91], 0
  s_lshl_b32 s36, s94, 6
  s_lshl_b32 s49, s95, 6
  v_mfma_f32_16x16x32_bf16 v[136:139], v[208:211], v[88:91], 0
  s_add_u32 s36, s36, s49
  s_add_u32 s36, s36, 658112
  v_mfma_f32_16x16x32_bf16 v[124:127], v[176:179], v[92:95], 0
  buffer_load_dwordx4 v[244:247], v13, s[8:11], s36 offen sc1
  s_add_u32 m0, s99, 65536
  v_mfma_f32_16x16x32_bf16 v[140:143], v[208:211], v[92:95], 0
  s_add_u32 s36, s98, 0
  buffer_load_dwordx4 v8, s[24:27], s36 offen lds
  s_waitcnt lgkmcnt(8)
  v_mfma_f32_16x16x32_bf16 v[112:115], v[180:183], v[96:99], v[112:115]
  ds_read_b128 v[80:83], v3 offset:8192
  ds_read_b128 v[84:87], v3 offset:24576
  v_mfma_f32_16x16x32_bf16 v[128:131], v[212:215], v[96:99], v[128:131]
  ds_read_b128 v[88:91], v3 offset:40960
  v_mfma_f32_16x16x32_bf16 v[116:119], v[180:183], v[100:103], v[116:119]
  ds_read_b128 v[92:95], v3 offset:57344
  v_mfma_f32_16x16x32_bf16 v[132:135], v[212:215], v[100:103], v[132:135]
  buffer_load_dwordx4 v[16:19], v2, s[8:11], s74 offen sc1
  v_mfma_f32_16x16x32_bf16 v[120:123], v[180:183], v[104:107], v[120:123]
  buffer_load_dwordx4 v[20:23], v2, s[8:11], s74 offen offset:1024 sc1
  v_mfma_f32_16x16x32_bf16 v[136:139], v[212:215], v[104:107], v[136:139]
  s_add_u32 m0, s99, 66560
  v_mfma_f32_16x16x32_bf16 v[124:127], v[180:183], v[108:111], v[124:127]
  s_add_u32 s36, s98, 32768
  v_mfma_f32_16x16x32_bf16 v[140:143], v[212:215], v[108:111], v[140:143]
  buffer_load_dwordx4 v8, s[24:27], s36 offen lds
  s_waitcnt lgkmcnt(8)
  v_mfma_f32_16x16x32_bf16 v[112:115], v[184:187], v[160:163], v[112:115]
  ds_read_b128 v[96:99], v3 offset:10240
  v_mfma_f32_16x16x32_bf16 v[128:131], v[216:219], v[160:163], v[128:131]
  ds_read_b128 v[100:103], v3 offset:26624
  v_mfma_f32_16x16x32_bf16 v[116:119], v[184:187], v[164:167], v[116:119]
  ds_read_b128 v[104:107], v3 offset:43008
  v_mfma_f32_16x16x32_bf16 v[132:135], v[216:219], v[164:167], v[132:135]
  ds_read_b128 v[108:111], v3 offset:59392
  v_mfma_f32_16x16x32_bf16 v[120:123], v[184:187], v[168:171], v[120:123]
  s_add_u32 m0, s99, 67584
  v_mfma_f32_16x16x32_bf16 v[136:139], v[216:219], v[168:171], v[136:139]
  s_add_u32 s36, s98, 65536
  v_mfma_f32_16x16x32_bf16 v[124:127], v[184:187], v[172:175], v[124:127]
  buffer_load_dwordx4 v8, s[24:27], s36 offen lds
  v_mfma_f32_16x16x32_bf16 v[140:143], v[216:219], v[172:175], v[140:143]
  s_waitcnt lgkmcnt(8)
  v_mfma_f32_16x16x32_bf16 v[112:115], v[188:191], v[24:27], v[112:115]
  ds_read_b128 v[160:163], v3 offset:12288
  v_mfma_f32_16x16x32_bf16 v[128:131], v[220:223], v[24:27], v[128:131]
  ds_read_b128 v[164:167], v3 offset:28672
  v_mfma_f32_16x16x32_bf16 v[116:119], v[188:191], v[28:31], v[116:119]
  ds_read_b128 v[168:171], v3 offset:45056
  v_mfma_f32_16x16x32_bf16 v[132:135], v[220:223], v[28:31], v[132:135]
  ds_read_b128 v[172:175], v3 offset:61440
  v_mfma_f32_16x16x32_bf16 v[120:123], v[188:191], v[32:35], v[120:123]
  s_add_u32 m0, s99, 68608
  v_mfma_f32_16x16x32_bf16 v[136:139], v[220:223], v[32:35], v[136:139]
  s_add_u32 s36, s98, 98304
  v_mfma_f32_16x16x32_bf16 v[124:127], v[188:191], v[36:39], v[124:127]
  buffer_load_dwordx4 v8, s[24:27], s36 offen lds
  v_mfma_f32_16x16x32_bf16 v[140:143], v[220:223], v[36:39], v[140:143]
  s_waitcnt lgkmcnt(8)
  v_mfma_f32_16x16x32_bf16 v[112:115], v[192:195], v[80:83], v[112:115]
  ds_read_b128 v[24:27], v3 offset:14336
  v_mfma_f32_16x16x32_bf16 v[128:131], v[224:227], v[80:83], v[128:131]
  ds_read_b128 v[28:31], v3 offset:30720
  v_mfma_f32_16x16x32_bf16 v[116:119], v[192:195], v[84:87], v[116:119]
  ds_read_b128 v[32:35], v3 offset:47104
  v_mfma_f32_16x16x32_bf16 v[132:135], v[224:227], v[84:87], v[132:135]
  ds_read_b128 v[36:39], v3 offset:63488
  v_mfma_f32_16x16x32_bf16 v[120:123], v[192:195], v[88:91], v[120:123]
  s_add_u32 m0, s99, 73728
  v_mfma_f32_16x16x32_bf16 v[136:139], v[224:227], v[88:91], v[136:139]
  s_add_u32 s36, s98, 128
  v_mfma_f32_16x16x32_bf16 v[124:127], v[192:195], v[92:95], v[124:127]
  buffer_load_dwordx4 v8, s[24:27], s36 offen lds
  v_mfma_f32_16x16x32_bf16 v[140:143], v[224:227], v[92:95], v[140:143]
  s_waitcnt lgkmcnt(8)
  v_mfma_f32_16x16x32_bf16 v[112:115], v[196:199], v[96:99], v[112:115]
  s_add_u32 m0, s99, 74752
  v_mfma_f32_16x16x32_bf16 v[128:131], v[228:231], v[96:99], v[128:131]
  s_add_u32 s36, s98, 32896
  v_mfma_f32_16x16x32_bf16 v[116:119], v[196:199], v[100:103], v[116:119]
  buffer_load_dwordx4 v8, s[24:27], s36 offen lds
  v_mfma_f32_16x16x32_bf16 v[132:135], v[228:231], v[100:103], v[132:135]
  v_mfma_f32_16x16x32_bf16 v[120:123], v[196:199], v[104:107], v[120:123]
  v_mfma_f32_16x16x32_bf16 v[136:139], v[228:231], v[104:107], v[136:139]
  v_mfma_f32_16x16x32_bf16 v[124:127], v[196:199], v[108:111], v[124:127]
  v_mfma_f32_16x16x32_bf16 v[140:143], v[228:231], v[108:111], v[140:143]
  s_waitcnt vmcnt(5)
  s_mov_b32 s48, 100000
sequential_preLN__grouped_kv_mqa__mixer_gmlp__prompt_kernel_zp66:
  v_max3_u32 v13, v16, v17, v18
  v_max3_u32 v13, v13, v19, v20
  v_max3_u32 v13, v13, v21, v22
  v_max_u32 v13, v13, v23
  v_cmp_eq_u32 vcc, -1, v13
  s_cbranch_vccz sequential_preLN__grouped_kv_mqa__mixer_gmlp__prompt_kernel_zpx67
  s_sub_u32 s48, s48, 1
  s_cmp_eq_u32 s48, 0
  s_cbranch_scc1 sequential_preLN__grouped_kv_mqa__mixer_gmlp__prompt_kernel_zpx67
  buffer_load_dwordx4 v[16:19], v2, s[8:11], s74 offen sc1
  buffer_load_dwordx4 v[20:23], v2, s[8:11], s74 offen offset:1024 sc1
  s_waitcnt vmcnt(0)
  s_branch sequential_preLN__grouped_kv_mqa__mixer_gmlp__prompt_kernel_zp66
sequential_preLN__grouped_kv_mqa__mixer_gmlp__prompt_kernel_zpx67:
  s_waitcnt lgkmcnt(4)
  v_mfma_f32_16x16x32_bf16 v[112:115], v[200:203], v[160:163], v[112:115]
  s_add_u32 m0, s99, 75776
  s_add_u32 s36, s98, 65664
  buffer_load_dwordx4 v8, s[24:27], s36 offen lds
  v_pk_add_f32 v[16:17], v[16:17], v[18:19]
  v_mfma_f32_16x16x32_bf16 v[128:131], v[232:235], v[160:163], v[128:131]
  v_pk_add_f32 v[20:21], v[20:21], v[22:23]
  v_mov_b32 v18, v16
  v_mov_b32 v19, v17
  v_mov_b32 v22, v20
  v_mfma_f32_16x16x32_bf16 v[116:119], v[200:203], v[164:167], v[116:119]
  v_mov_b32 v23, v21
  v_permlane16_swap_b32 v16, v18
  v_permlane16_swap_b32 v17, v19
  v_permlane16_swap_b32 v20, v22
  v_mfma_f32_16x16x32_bf16 v[132:135], v[232:235], v[164:167], v[132:135]
  v_permlane16_swap_b32 v21, v23
  v_pk_add_f32 v[16:17], v[16:17], v[18:19]
  v_pk_add_f32 v[20:21], v[20:21], v[22:23]
  v_mov_b32 v18, v16
  v_mfma_f32_16x16x32_bf16 v[120:123], v[200:203], v[168:171], v[120:123]
  v_mov_b32 v19, v17
  v_mov_b32 v22, v20
  v_mov_b32 v23, v21
  v_mfma_f32_16x16x32_bf16 v[136:139], v[232:235], v[168:171], v[136:139]
  v_permlane32_swap_b32 v16, v18
  v_permlane32_swap_b32 v17, v19
  v_permlane32_swap_b32 v20, v22
  v_mfma_f32_16x16x32_bf16 v[124:127], v[200:203], v[172:175], v[124:127]
  v_permlane32_swap_b32 v21, v23
  v_pk_add_f32 v[16:17], v[16:17], v[18:19]
  v_pk_add_f32 v[20:21], v[20:21], v[22:23]
  v_mfma_f32_16x16x32_bf16 v[140:143], v[232:235], v[172:175], v[140:143]
  v_pk_mul_f32 v[16:17], v[16:17], s[82:83]
  v_pk_mul_f32 v[20:21], v[20:21], s[82:83]
  v_mov_b32 v14, v16
  s_waitcnt lgkmcnt(0)
  v_mfma_f32_16x16x32_bf16 v[112:115], v[204:207], v[24:27], v[112:115]
  s_add_u32 m0, s99, 76800
  s_add_u32 s36, s98, 98432
  buffer_load_dwordx4 v8, s[24:27], s36 offen lds
  v_mov_b32 v255, v20
  v_mfma_f32_16x16x32_bf16 v[128:131], v[236:239], v[24:27], v[128:131]
  v_fma_f32 v252, -v16, v16, v17
  v_fma_f32 v254, -v20, v20, v21
  v_max_f32 v252, 0, v252
  v_max_f32 v254, 0, v254
  v_mfma_f32_16x16x32_bf16 v[116:119], v[204:207], v[28:31], v[116:119]
  v_add_f32 v252, 0x3727c5ac, v252
  v_add_f32 v254, 0x3727c5ac, v254
  v_rsq_f32 v248, v252
  v_rsq_f32 v250, v254
  v_mfma_f32_16x16x32_bf16 v[132:135], v[236:239], v[28:31], v[132:135]
  v_mul_f32 v252, 0x3727c5ac, v252
  v_mul_f32 v254, 0x3727c5ac, v254
  v_mov_b32 v249, v248
  v_mov_b32 v251, v250
  v_mfma_f32_16x16x32_bf16 v[120:123], v[204:207], v[32:35], v[120:123]
  v_mul_f32 v18, 0xc0135761, v248
  v_mul_f32 v22, 0xc0135761, v250
  v_mul_f32 v16, v248, v248
  v_mfma_f32_16x16x32_bf16 v[136:139], v[236:239], v[32:35], v[136:139]
  v_mul_f32 v20, v250, v250
  v_mov_b32 v19, v18
  v_mov_b32 v23, v22
  v_mfma_f32_16x16x32_bf16 v[124:127], v[204:207], v[36:39], v[124:127]
  v_mul_f32 v16, v16, v248
  v_mul_f32 v20, v20, v250
  v_mul_f32 v16, 0xbdd2d3e8, v16
  v_mfma_f32_16x16x32_bf16 v[140:143], v[236:239], v[36:39], v[140:143]
  v_mul_f32 v20, 0xbdd2d3e8, v20
  v_mov_b32 v17, v16
  v_mov_b32 v21, v20
  s_cmp_eq_u32 s31, 0
  s_cbranch_scc1 sequential_preLN__grouped_kv_mqa__mixer_gmlp__prompt_kernel_L68
  ds_write_b128 v4, v[112:115] offset:0
  ds_write_b128 v4, v[116:119] offset:1024
  ds_write_b128 v4, v[128:131] offset:2048
  ds_write_b128 v4, v[132:135] offset:3072
  v_mov_b32 v112, v120
  v_mov_b32 v113, v121
  v_mov_b32 v114, v122
  v_mov_b32 v115, v123
  v_mov_b32 v116, v124
  v_mov_b32 v117, v125
  v_mov_b32 v118, v126
  v_mov_b32 v119, v127
  v_mov_b32 v128, v136
  v_mov_b32 v129, v137
  v_mov_b32 v130, v138
  v_mov_b32 v131, v139
  v_mov_b32 v132, v140
  v_mov_b32 v133, v141
  v_mov_b32 v134, v142
  v_mov_b32 v135, v143
  s_branch sequential_preLN__grouped_kv_mqa__mixer_gmlp__prompt_kernel_L69
sequential_preLN__grouped_kv_mqa__mixer_gmlp__prompt_kernel_L68:
  ds_write_b128 v4, v[120:123] offset:0
  ds_write_b128 v4, v[124:127] offset:1024
  ds_write_b128 v4, v[136:139] offset:2048
  ds_write_b128 v4, v[140:143] offset:3072
sequential_preLN__grouped_kv_mqa__mixer_gmlp__prompt_kernel_L69:
  s_waitcnt lgkmcnt(0)
  s_barrier
  ds_read_b128 v[120:123], v5 offset:0
  ds_read_b128 v[124:127], v5 offset:1024
  ds_read_b128 v[136:139], v5 offset:2048
  ds_read_b128 v[140:143], v5 offset:3072
  s_waitcnt lgkmcnt(0)
  v_pk_add_f32 v[112:113], v[112:113], v[120:121]
  s_add_u32 s36, s98, 512
  v_pk_add_f32 v[114:115], v[114:115], v[122:123]
  v_pk_add_f32 v[116:117], v[116:117], v[124:125]
  v_pk_add_f32 v[118:119], v[118:119], v[126:127]
  v_pk_add_f32 v[128:129], v[128:129], v[136:137]
  v_pk_add_f32 v[130:131], v[130:131], v[138:139]
  v_pk_add_f32 v[132:133], v[132:133], v[140:141]
  buffer_load_dwordx4 v[176:179], v8, s[24:27], s36 offen
  v_pk_add_f32 v[134:135], v[134:135], v[142:143]
  v_fma_f32 v112, -v14, v240, v112
  v_fma_f32 v113, -v14, v241, v113
  v_fma_f32 v114, -v14, v242, v114
  v_fma_f32 v115, -v14, v243, v115
  v_fma_f32 v116, -v255, v240, v116
  s_add_u32 s36, s98, 33280
  v_fma_f32 v117, -v255, v241, v117
  v_fma_f32 v118, -v255, v242, v118
  v_fma_f32 v119, -v255, v243, v119
  v_fma_f32 v128, -v14, v244, v128
  v_fma_f32 v129, -v14, v245, v129
  v_fma_f32 v130, -v14, v246, v130
  buffer_load_dwordx4 v[180:183], v8, s[24:27], s36 offen
  v_fma_f32 v131, -v14, v247, v131
  v_fma_f32 v132, -v255, v244, v132
  v_fma_f32 v133, -v255, v245, v133
  v_fma_f32 v134, -v255, v246, v134
  v_fma_f32 v135, -v255, v247, v135
  v_pk_mul_f32 v[120:121], v[112:113], v[112:113]
  s_add_u32 s36, s98, 66048
  v_pk_mul_f32 v[122:123], v[114:115], v[114:115]
  v_pk_mul_f32 v[124:125], v[116:117], v[116:117]
  v_pk_mul_f32 v[126:127], v[118:119], v[118:119]
  v_pk_mul_f32 v[136:137], v[128:129], v[128:129]
  v_pk_mul_f32 v[138:139], v[130:131], v[130:131]
  v_pk_mul_f32 v[140:141], v[132:133], v[132:133]
  buffer_load_dwordx4 v[184:187], v8, s[24:27], s36 offen
  v_pk_mul_f32 v[142:143], v[134:135], v[134:135]
  v_pk_fma_f32 v[120:121], v[120:121], v[16:17], v[18:19]
  v_pk_fma_f32 v[122:123], v[122:123], v[16:17], v[18:19]
  v_pk_fma_f32 v[124:125], v[124:125], v[20:21], v[22:23]
  v_pk_fma_f32 v[126:127], v[126:127], v[20:21], v[22:23]
  v_pk_fma_f32 v[136:137], v[136:137], v[16:17], v[18:19]
  s_add_u32 s36, s98, 98816
  v_pk_fma_f32 v[138:139], v[138:139], v[16:17], v[18:19]
  v_pk_fma_f32 v[140:141], v[140:141], v[20:21], v[22:23]
  v_pk_fma_f32 v[142:143], v[142:143], v[20:21], v[22:23]
  v_pk_mul_f32 v[120:121], v[120:121], v[112:113]
  v_pk_mul_f32 v[122:123], v[122:123], v[114:115]
  v_pk_mul_f32 v[124:125], v[124:125], v[116:117]
  buffer_load_dwordx4 v[188:191], v8, s[24:27], s36 offen
  v_pk_mul_f32 v[126:127], v[126:127], v[118:119]
  v_pk_mul_f32 v[136:137], v[136:137], v[128:129]
  v_pk_mul_f32 v[138:139], v[138:139], v[130:131]
  v_pk_mul_f32 v[140:141], v[140:141], v[132:133]
  v_pk_mul_f32 v[142:143], v[142:143], v[134:135]
  v_exp_f32 v120, v120
  s_add_u32 s36, s98, 640
  v_exp_f32 v121, v121
  v_exp_f32 v122, v122
  v_exp_f32 v123, v123
  v_exp_f32 v124, v124
  v_exp_f32 v125, v125
  v_exp_f32 v126, v126
  buffer_load_dwordx4 v[192:195], v8, s[24:27], s36 offen
  v_exp_f32 v127, v127
  v_exp_f32 v136, v136
  v_exp_f32 v137, v137
  v_exp_f32 v138, v138
  v_exp_f32 v139, v139
  v_exp_f32 v140, v140
  s_add_u32 s36, s98, 33408
  v_exp_f32 v141, v141
  v_exp_f32 v142, v142
  v_exp_f32 v143, v143
  v_pk_add_f32 v[120:121], v[120:121], s[72:73]
  v_pk_add_f32 v[122:123], v[122:123], s[72:73]
  v_pk_add_f32 v[124:125], v[124:125], s[72:73]
  buffer_load_dwordx4 v[196:199], v8, s[24:27], s36 offen
  v_pk_add_f32 v[126:127], v[126:127], s[72:73]
  v_pk_add_f32 v[136:137], v[136:137], s[72:73]
  v_pk_add_f32 v[138:139], v[138:139], s[72:73]
  v_pk_add_f32 v[140:141], v[140:141], s[72:73]
  v_pk_add_f32 v[142:143], v[142:143], s[72:73]
  v_rcp_f32 v120, v120
  s_add_u32 s36, s98, 66176
  v_rcp_f32 v121, v121
  v_rcp_f32 v122, v122
  v_rcp_f32 v123, v123
  v_rcp_f32 v124, v124
  v_rcp_f32 v125, v125
  v_rcp_f32 v126, v126
  buffer_load_dwordx4 v[200:203], v8, s[24:27], s36 offen
  v_rcp_f32 v127, v127
  v_rcp_f32 v136, v136
  v_rcp_f32 v137, v137
  v_rcp_f32 v138, v138
  v_rcp_f32 v139, v139
  v_rcp_f32 v140, v140
  s_add_u32 s36, s98, 98944
  v_rcp_f32 v141, v141
  v_rcp_f32 v142, v142
  v_rcp_f32 v143, v143
  v_pk_mul_f32 v[112:113], v[112:113], v[120:121]
  v_pk_mul_f32 v[114:115], v[114:115], v[122:123]
  v_pk_mul_f32 v[116:117], v[116:117], v[124:125]
  buffer_load_dwordx4 v[204:207], v8, s[24:27], s36 offen
  v_pk_mul_f32 v[118:119], v[118:119], v[126:127]
  v_pk_mul_f32 v[128:129], v[128:129], v[136:137]
  v_pk_mul_f32 v[130:131], v[130:131], v[138:139]
  v_pk_mul_f32 v[132:133], v[132:133], v[140:141]
  v_pk_mul_f32 v[134:135], v[134:135], v[142:143]
  v_pk_add_f32 v[24:25], v[112:113], v[114:115]
  v_pk_mul_f32 v[26:27], v[112:113], v[112:113]
  v_pk_add_f32 v[28:29], v[116:117], v[118:119]
  v_pk_mul_f32 v[30:31], v[116:117], v[116:117]
  v_pk_fma_f32 v[26:27], v[114:115], v[114:115], v[26:27]
  v_pk_fma_f32 v[30:31], v[118:119], v[118:119], v[30:31]
  v_pk_add_f32 v[24:25], v[24:25], v[128:129]
  v_pk_fma_f32 v[26:27], v[128:129], v[128:129], v[26:27]
  v_pk_add_f32 v[28:29], v[28:29], v[132:133]
  v_pk_fma_f32 v[30:31], v[132:133], v[132:133], v[30:31]
  v_pk_add_f32 v[24:25], v[24:25], v[130:131]
  v_pk_fma_f32 v[26:27], v[130:131], v[130:131], v[26:27]
  v_pk_add_f32 v[28:29], v[28:29], v[134:135]
  v_pk_fma_f32 v[30:31], v[134:135], v[134:135], v[30:31]
  v_add_f32 v24, v24, v25
  v_add_f32 v25, v26, v27
  v_add_f32 v28, v28, v29
  v_add_f32 v29, v30, v31
  v_mov_b32 v26, v24
  v_mov_b32 v27, v25
  v_mov_b32 v30, v28
  v_mov_b32 v31, v29
  v_permlane16_swap_b32 v24, v26
  v_permlane16_swap_b32 v25, v27
  v_permlane16_swap_b32 v28, v30
  v_permlane16_swap_b32 v29, v31
  v_pk_add_f32 v[24:25], v[24:25], v[26:27]
  v_pk_add_f32 v[28:29], v[28:29], v[30:31]
  v_mov_b32 v26, v24
  v_mov_b32 v27, v25
  v_mov_b32 v30, v28
  v_mov_b32 v31, v29
  v_permlane32_swap_b32 v24, v26
  v_permlane32_swap_b32 v25, v27
  v_permlane32_swap_b32 v28, v30
  v_permlane32_swap_b32 v29, v31
  v_pk_add_f32 v[24:25], v[24:25], v[26:27]
  v_pk_add_f32 v[28:29], v[28:29], v[30:31]
  ds_write_b64 v11, v[24:25]
  ds_write_b64 v11, v[28:29] offset:128
  s_waitcnt vmcnt(8)
  s_waitcnt lgkmcnt(0)
  s_barrier
  s_cmp_lg_u32 s4, 0
  s_cbranch_scc1 sequential_preLN__grouped_kv_mqa__mixer_gmlp__prompt_kernel_L70
  v_lshlrev_b32 v13, 3, v1
  v_add_u32 v13, 155648, v13
  ds_read_b64 v[24:25], v13 offset:0
  ds_read_b64 v[26:27], v13 offset:512
  ds_read_b64 v[28:29], v13 offset:1024
  ds_read_b64 v[30:31], v13 offset:1536
  s_add_u32 s47, s76, 524288
  s_waitcnt lgkmcnt(0)
  v_pk_add_f32 v[24:25], v[24:25], v[26:27]
  v_pk_add_f32 v[28:29], v[28:29], v[30:31]
  v_pk_add_f32 v[24:25], v[24:25], v[28:29]
  s_cmp_eq_u32 s68, 0
  s_cbranch_scc1 sequential_preLN__grouped_kv_mqa__mixer_gmlp__prompt_kernel_L71
  buffer_store_dwordx2 v[24:25], v6, s[8:11], s47 offen
  s_branch sequential_preLN__grouped_kv_mqa__mixer_gmlp__prompt_kernel_L72
sequential_preLN__grouped_kv_mqa__mixer_gmlp__prompt_kernel_L71:
  buffer_store_dwordx2 v[24:25], v6, s[8:11], s47 offen sc1
sequential_preLN__grouped_kv_mqa__mixer_gmlp__prompt_kernel_L72:
sequential_preLN__grouped_kv_mqa__mixer_gmlp__prompt_kernel_L70:
  ds_read_b128 v[80:83], v3 offset:0
  ds_read_b128 v[84:87], v3 offset:16384
  ds_read_b128 v[88:91], v3 offset:32768
  ds_read_b128 v[92:95], v3 offset:49152
  ds_read_b128 v[96:99], v3 offset:2048
  ds_read_b128 v[100:103], v3 offset:18432
  ds_read_b128 v[104:107], v3 offset:34816
  ds_read_b128 v[108:111], v3 offset:51200
  ds_read_b128 v[160:163], v3 offset:4096
  ds_read_b128 v[164:167], v3 offset:20480
  ds_read_b128 v[168:171], v3 offset:36864
  ds_read_b128 v[172:175], v3 offset:53248
  s_waitcnt lgkmcnt(8)
  v_mfma_f32_16x16x32_bf16 v[144:147], v[48:51], v[80:83], 0
  ds_read_b128 v[24:27], v3 offset:6144
  ds_read_b128 v[28:31], v3 offset:22528
  v_mfma_f32_16x16x32_bf16 v[148:151], v[48:51], v[84:87], 0
  ds_read_b128 v[32:35], v3 offset:38912
  ds_read_b128 v[36:39], v3 offset:55296
  v_mfma_f32_16x16x32_bf16 v[152:155], v[48:51], v[88:91], 0
  s_add_u32 s36, s98, 768
  buffer_load_dwordx4 v[208:211], v8, s[24:27], s36 offen
  v_mfma_f32_16x16x32_bf16 v[156:159], v[48:51], v[92:95], 0
  s_add_u32 s36, s98, 33536
  buffer_load_dwordx4 v[212:215], v8, s[24:27], s36 offen
  s_waitcnt lgkmcnt(8)
  v_mfma_f32_16x16x32_bf16 v[144:147], v[52:55], v[96:99], v[144:147]
  ds_read_b128 v[80:83], v3 offset:8192
  ds_read_b128 v[84:87], v3 offset:24576
  v_mfma_f32_16x16x32_bf16 v[148:151], v[52:55], v[100:103], v[148:151]
  ds_read_b128 v[88:91], v3 offset:40960
  ds_read_b128 v[92:95], v3 offset:57344
  v_mfma_f32_16x16x32_bf16 v[152:155], v[52:55], v[104:107], v[152:155]
  s_add_u32 s36, s98, 66304
  buffer_load_dwordx4 v[216:219], v8, s[24:27], s36 offen
  v_mfma_f32_16x16x32_bf16 v[156:159], v[52:55], v[108:111], v[156:159]
  s_add_u32 s36, s98, 99072
  buffer_load_dwordx4 v[220:223], v8, s[24:27], s36 offen
  s_waitcnt lgkmcnt(8)
  v_mfma_f32_16x16x32_bf16 v[144:147], v[56:59], v[160:163], v[144:147]
  ds_read_b128 v[96:99], v3 offset:10240
  ds_read_b128 v[100:103], v3 offset:26624
  v_mfma_f32_16x16x32_bf16 v[148:151], v[56:59], v[164:167], v[148:151]
  ds_read_b128 v[104:107], v3 offset:43008
  ds_read_b128 v[108:111], v3 offset:59392
  v_mfma_f32_16x16x32_bf16 v[152:155], v[56:59], v[168:171], v[152:155]
  s_add_u32 s36, s98, 896
  buffer_load_dwordx4 v[224:227], v8, s[24:27], s36 offen
  v_mfma_f32_16x16x32_bf16 v[156:159], v[56:59], v[172:175], v[156:159]
  s_add_u32 s36, s98, 33664
  buffer_load_dwordx4 v[228:231], v8, s[24:27], s36 offen
  s_waitcnt lgkmcnt(8)
  v_mfma_f32_16x16x32_bf16 v[144:147], v[60:63], v[24:27], v[144:147]
  ds_read_b128 v[160:163], v3 offset:12288
  ds_read_b128 v[164:167], v3 offset:28672
  v_mfma_f32_16x16x32_bf16 v[148:151], v[60:63], v[28:31], v[148:151]
  ds_read_b128 v[168:171], v3 offset:45056
  ds_read_b128 v[172:175], v3 offset:61440
  v_mfma_f32_16x16x32_bf16 v[152:155], v[60:63], v[32:35], v[152:155]
  s_add_u32 s36, s98, 66432
  buffer_load_dwordx4 v[232:235], v8, s[24:27], s36 offen
  v_mfma_f32_16x16x32_bf16 v[156:159], v[60:63], v[36:39], v[156:159]
  s_add_u32 s36, s98, 99200
  buffer_load_dwordx4 v[236:239], v8, s[24:27], s36 offen
  s_waitcnt lgkmcnt(8)
  v_mfma_f32_16x16x32_bf16 v[144:147], v[64:67], v[80:83], v[144:147]
  ds_read_b128 v[24:27], v3 offset:14336
  v_mfma_f32_16x16x32_bf16 v[148:151], v[64:67], v[84:87], v[148:151]
  ds_read_b128 v[28:31], v3 offset:30720
  v_mfma_f32_16x16x32_bf16 v[152:155], v[64:67], v[88:91], v[152:155]
  ds_read_b128 v[32:35], v3 offset:47104
  v_mfma_f32_16x16x32_bf16 v[156:159], v[64:67], v[92:95], v[156:159]
  ds_read_b128 v[36:39], v3 offset:63488
  s_waitcnt lgkmcnt(8)
  v_mfma_f32_16x16x32_bf16 v[144:147], v[68:71], v[96:99], v[144:147]
  v_mfma_f32_16x16x32_bf16 v[148:151], v[68:71], v[100:103], v[148:151]
  v_mfma_f32_16x16x32_bf16 v[152:155], v[68:71], v[104:107], v[152:155]
  v_mfma_f32_16x16x32_bf16 v[156:159], v[68:71], v[108:111], v[156:159]
  s_waitcnt lgkmcnt(4)
  v_mfma_f32_16x16x32_bf16 v[144:147], v[72:75], v[160:163], v[144:147]
  buffer_load_dwordx4 v[240:243], v2, s[8:11], s75 offen sc1
  v_mfma_f32_16x16x32_bf16 v[148:151], v[72:75], v[164:167], v[148:151]
  buffer_load_dwordx4 v[244:247], v2, s[8:11], s75 offen offset:1024 sc1
  v_mfma_f32_16x16x32_bf16 v[152:155], v[72:75], v[168:171], v[152:155]
  v_mfma_f32_16x16x32_bf16 v[156:159], v[72:75], v[172:175], v[156:159]
  s_waitcnt lgkmcnt(0)
  v_mfma_f32_16x16x32_bf16 v[144:147], v[76:79], v[24:27], v[144:147]
  v_mfma_f32_16x16x32_bf16 v[148:151], v[76:79], v[28:31], v[148:151]
  v_mfma_f32_16x16x32_bf16 v[152:155], v[76:79], v[32:35], v[152:155]
  v_mfma_f32_16x16x32_bf16 v[156:159], v[76:79], v[36:39], v[156:159]
  s_waitcnt vmcnt(0)
  s_mov_b32 s48, 100000
sequential_preLN__grouped_kv_mqa__mixer_gmlp__prompt_kernel_zp73:
  v_max3_u32 v13, v240, v241, v242
  v_max3_u32 v13, v13, v243, v244
  v_max3_u32 v13, v13, v245, v246
  v_max_u32 v13, v13, v247
  v_cmp_eq_u32 vcc, -1, v13
  s_cbranch_vccz sequential_preLN__grouped_kv_mqa__mixer_gmlp__prompt_kernel_zpx74
  s_sub_u32 s48, s48, 1
  s_cmp_eq_u32 s48, 0
  s_cbranch_scc1 sequential_preLN__grouped_kv_mqa__mixer_gmlp__prompt_kernel_zpx74
  buffer_load_dwordx4 v[240:243], v2, s[8:11], s75 offen sc1
  buffer_load_dwordx4 v[244:247], v2, s[8:11], s75 offen offset:1024 sc1
  s_waitcnt vmcnt(0)
  s_branch sequential_preLN__grouped_kv_mqa__mixer_gmlp__prompt_kernel_zp73
sequential_preLN__grouped_kv_mqa__mixer_gmlp__prompt_kernel_zpx74:
  v_pk_add_f32 v[240:241], v[240:241], v[242:243]
  v_pk_add_f32 v[244:245], v[244:245], v[246:247]
  v_mov_b32 v242, v240
  v_mov_b32 v243, v241
  v_mov_b32 v246, v244
  v_mov_b32 v247, v245
  v_permlane16_swap_b32 v240, v242
  v_permlane16_swap_b32 v241, v243
  v_permlane16_swap_b32 v244, v246
  v_permlane16_swap_b32 v245, v247
  v_pk_add_f32 v[240:241], v[240:241], v[242:243]
  v_pk_add_f32 v[244:245], v[244:245], v[246:247]
  v_mov_b32 v242, v240
  v_mov_b32 v243, v241
  v_mov_b32 v246, v244
  v_mov_b32 v247, v245
  v_permlane32_swap_b32 v240, v242
  v_permlane32_swap_b32 v241, v243
  v_permlane32_swap_b32 v244, v246
  v_permlane32_swap_b32 v245, v247
  v_pk_add_f32 v[240:241], v[240:241], v[242:243]
  v_pk_add_f32 v[244:245], v[244:245], v[246:247]
  v_pk_mul_f32 v[240:241], v[240:241], s[84:85]
  v_pk_mul_f32 v[244:245], v[244:245], s[84:85]
  v_fma_f32 v241, -v240, v240, v241
  v_fma_f32 v245, -v244, v244, v245
  v_max_f32 v241, 0, v241
  v_max_f32 v245, 0, v245
  v_add_f32 v241, v241, v252
  v_add_f32 v245, v245, v254
  v_rsq_f32 v242, v241
  v_rsq_f32 v246, v245
  v_rsq_f32 v243, v241
  v_rsq_f32 v247, v245
  v_mul_f32 v241, -v240, v242
  v_mul_f32 v245, -v244, v246
  v_mul_f32 v240, -v240, v242
  v_mul_f32 v244, -v244, v246
  v_pk_fma_f32 v[112:113], v[112:113], v[242:243], v[240:241]
  v_pk_fma_f32 v[114:115], v[114:115], v[242:243], v[240:241]
  v_cvt_pk_bf16_f32 v120, v112, v113
  v_cvt_pk_bf16_f32 v121, v114, v115
  ds_write_b64 v40, v[120:121] offset:0
  v_pk_fma_f32 v[116:117], v[116:117], v[246:247], v[244:245]
  v_pk_fma_f32 v[118:119], v[118:119], v[246:247], v[244:245]
  v_cvt_pk_bf16_f32 v122, v116, v117
  v_cvt_pk_bf16_f32 v123, v118, v119
  ds_write_b64 v40, v[122:123] offset:512
  v_pk_fma_f32 v[128:129], v[128:129], v[242:243], v[240:241]
  v_pk_fma_f32 v[130:131], v[130:131], v[242:243], v[240:241]
  v_cvt_pk_bf16_f32 v136, v128, v129
  v_cvt_pk_bf16_f32 v137, v130, v131
  ds_write_b64 v40, v[136:137] offset:1024
  v_pk_fma_f32 v[132:133], v[132:133], v[246:247], v[244:245]
  v_pk_fma_f32 v[134:135], v[134:135], v[246:247], v[244:245]
  v_cvt_pk_bf16_f32 v138, v132, v133
  v_cvt_pk_bf16_f32 v139, v134, v135
  ds_write_b64 v40, v[138:139] offset:1536
  s_waitcnt lgkmcnt(0)
  ds_read_b64_tr_b16 v[112:113], v41 offset:0
  ds_read_b64_tr_b16 v[114:115], v41 offset:128
  ds_read_b64_tr_b16 v[128:129], v41 offset:1024
  ds_read_b64_tr_b16 v[130:131], v41 offset:1152
  s_waitcnt lgkmcnt(2)
  buffer_store_dwordx4 v[112:115], v2, s[8:11], s80 offen sc1
  s_waitcnt lgkmcnt(0)
  buffer_store_dwordx4 v[128:131], v2, s[8:11], s81 offen sc1
  v_and_b32 v13, 48, v1
  s_lshl_b32 s36, s93, 6
  s_lshl_b32 s49, s95, 6
  s_add_u32 s36, s36, s49
  s_add_u32 s36, s36, 655360
  s_add_u32 s36, s36, s92
  buffer_load_dwordx4 v[240:243], v13, s[8:11], s36 offen sc1
  s_branch sequential_preLN__grouped_kv_mqa__mixer_gmlp__prompt_kernel_dj65
sequential_preLN__grouped_kv_mqa__mixer_gmlp__prompt_kernel_d164:
  ds_read_b128 v[80:83], v3 offset:0
  ds_read_b128 v[84:87], v3 offset:16384
  ds_read_b128 v[88:91], v3 offset:32768
  ds_read_b128 v[92:95], v3 offset:49152
  ds_read_b128 v[96:99], v3 offset:2048
  ds_read_b128 v[100:103], v3 offset:18432
  ds_read_b128 v[104:107], v3 offset:34816
  ds_read_b128 v[108:111], v3 offset:51200
  ds_read_b128 v[160:163], v3 offset:4096
  ds_read_b128 v[164:167], v3 offset:20480
  ds_read_b128 v[168:171], v3 offset:36864
  ds_read_b128 v[172:175], v3 offset:53248
  s_waitcnt lgkmcnt(8)
  v_mfma_f32_16x16x32_bf16 v[112:115], v[176:179], v[80:83], 0
  ds_read_b128 v[24:27], v3 offset:6144
  ds_read_b128 v[28:31], v3 offset:22528
  ds_read_b128 v[32:35], v3 offset:38912
  ds_read_b128 v[36:39], v3 offset:55296
  v_mfma_f32_16x16x32_bf16 v[116:119], v[176:179], v[84:87], 0
  v_and_b32 v13, 48, v1
  s_lshl_b32 s36, s93, 6
  s_lshl_b32 s49, s95, 6
  s_add_u32 s36, s36, s49
  v_mfma_f32_16x16x32_bf16 v[120:123], v[176:179], v[88:91], 0
  s_add_u32 s36, s36, 658112
  s_add_u32 s36, s36, s92
  buffer_load_dwordx4 v[240:243], v13, s[8:11], s36 offen sc1
  v_mfma_f32_16x16x32_bf16 v[124:127], v[176:179], v[92:95], 0
  s_add_u32 m0, s99, 65536
  s_add_u32 s36, s98, 0
  buffer_load_dwordx4 v8, s[24:27], s36 offen lds
  s_waitcnt lgkmcnt(8)
  v_mfma_f32_16x16x32_bf16 v[112:115], v[180:183], v[96:99], v[112:115]
  ds_read_b128 v[80:83], v3 offset:8192
  ds_read_b128 v[84:87], v3 offset:24576
  ds_read_b128 v[88:91], v3 offset:40960
  v_mfma_f32_16x16x32_bf16 v[116:119], v[180:183], v[100:103], v[116:119]
  ds_read_b128 v[92:95], v3 offset:57344
  buffer_load_dwordx4 v[16:19], v2, s[8:11], s74 offen sc1
  v_mfma_f32_16x16x32_bf16 v[120:123], v[180:183], v[104:107], v[120:123]
  buffer_load_dwordx4 v[20:23], v2, s[8:11], s74 offen offset:1024 sc1
  s_add_u32 m0, s99, 66560
  v_mfma_f32_16x16x32_bf16 v[124:127], v[180:183], v[108:111], v[124:127]
  s_add_u32 s36, s98, 32768
  buffer_load_dwordx4 v8, s[24:27], s36 offen lds
  s_waitcnt lgkmcnt(8)
  v_mfma_f32_16x16x32_bf16 v[112:115], v[184:187], v[160:163], v[112:115]
  ds_read_b128 v[96:99], v3 offset:10240
  ds_read_b128 v[100:103], v3 offset:26624
  v_mfma_f32_16x16x32_bf16 v[116:119], v[184:187], v[164:167], v[116:119]
  ds_read_b128 v[104:107], v3 offset:43008
  ds_read_b128 v[108:111], v3 offset:59392
  v_mfma_f32_16x16x32_bf16 v[120:123], v[184:187], v[168:171], v[120:123]
  s_add_u32 m0, s99, 67584
  s_add_u32 s36, s98, 65536
  v_mfma_f32_16x16x32_bf16 v[124:127], v[184:187], v[172:175], v[124:127]
  buffer_load_dwordx4 v8, s[24:27], s36 offen lds
  s_waitcnt lgkmcnt(8)
  v_mfma_f32_16x16x32_bf16 v[112:115], v[188:191], v[24:27], v[112:115]
  ds_read_b128 v[160:163], v3 offset:12288
  ds_read_b128 v[164:167], v3 offset:28672
  v_mfma_f32_16x16x32_bf16 v[116:119], v[188:191], v[28:31], v[116:119]
  ds_read_b128 v[168:171], v3 offset:45056
  ds_read_b128 v[172:175], v3 offset:61440
  v_mfma_f32_16x16x32_bf16 v[120:123], v[188:191], v[32:35], v[120:123]
  s_add_u32 m0, s99, 68608
  s_add_u32 s36, s98, 98304
  v_mfma_f32_16x16x32_bf16 v[124:127], v[188:191], v[36:39], v[124:127]
  buffer_load_dwordx4 v8, s[24:27], s36 offen lds
  s_waitcnt lgkmcnt(8)
  v_mfma_f32_16x16x32_bf16 v[112:115], v[192:195], v[80:83], v[112:115]
  ds_read_b128 v[24:27], v3 offset:14336
  ds_read_b128 v[28:31], v3 offset:30720
  v_mfma_f32_16x16x32_bf16 v[116:119], v[192:195], v[84:87], v[116:119]
  ds_read_b128 v[32:35], v3 offset:47104
  ds_read_b128 v[36:39], v3 offset:63488
  v_mfma_f32_16x16x32_bf16 v[120:123], v[192:195], v[88:91], v[120:123]
  s_add_u32 m0, s99, 73728
  s_add_u32 s36, s98, 128
  v_mfma_f32_16x16x32_bf16 v[124:127], v[192:195], v[92:95], v[124:127]
  buffer_load_dwordx4 v8, s[24:27], s36 offen lds
  s_waitcnt lgkmcnt(8)
  v_mfma_f32_16x16x32_bf16 v[112:115], v[196:199], v[96:99], v[112:115]
  s_add_u32 m0, s99, 74752
  v_mfma_f32_16x16x32_bf16 v[116:119], v[196:199], v[100:103], v[116:119]
  s_add_u32 s36, s98, 32896
  v_mfma_f32_16x16x32_bf16 v[120:123], v[196:199], v[104:107], v[120:123]
  buffer_load_dwordx4 v8, s[24:27], s36 offen lds
  v_mfma_f32_16x16x32_bf16 v[124:127], v[196:199], v[108:111], v[124:127]
  s_waitcnt vmcnt(5)
  s_mov_b32 s48, 100000
sequential_preLN__grouped_kv_mqa__mixer_gmlp__prompt_kernel_zp75:
  v_max3_u32 v13, v16, v17, v18
  v_max3_u32 v13, v13, v19, v20
  v_max3_u32 v13, v13, v21, v22
  v_max_u32 v13, v13, v23
  v_cmp_eq_u32 vcc, -1, v13
  s_cbranch_vccz sequential_preLN__grouped_kv_mqa__mixer_gmlp__prompt_kernel_zpx76
  s_sub_u32 s48, s48, 1
  s_cmp_eq_u32 s48, 0
  s_cbranch_scc1 sequential_preLN__grouped_kv_mqa__mixer_gmlp__prompt_kernel_zpx76
  buffer_load_dwordx4 v[16:19], v2, s[8:11], s74 offen sc1
  buffer_load_dwordx4 v[20:23], v2, s[8:11], s74 offen offset:1024 sc1
  s_waitcnt vmcnt(0)
  s_branch sequential_preLN__grouped_kv_mqa__mixer_gmlp__prompt_kernel_zp75
sequential_preLN__grouped_kv_mqa__mixer_gmlp__prompt_kernel_zpx76:
  s_waitcnt lgkmcnt(4)
  v_mfma_f32_16x16x32_bf16 v[112:115], v[200:203], v[160:163], v[112:115]
  s_add_u32 m0, s99, 75776
  s_add_u32 s36, s98, 65664
  buffer_load_dwordx4 v8, s[24:27], s36 offen lds
  v_pk_add_f32 v[16:17], v[16:17], v[18:19]
  v_pk_add_f32 v[20:21], v[20:21], v[22:23]
  v_mov_b32 v18, v16
  v_mov_b32 v19, v17
  v_mfma_f32_16x16x32_bf16 v[116:119], v[200:203], v[164:167], v[116:119]
  v_mov_b32 v22, v20
  v_mov_b32 v23, v21
  v_permlane16_swap_b32 v16, v18
  v_permlane16_swap_b32 v17, v19
  v_permlane16_swap_b32 v20, v22
  v_permlane16_swap_b32 v21, v23
  v_pk_add_f32 v[16:17], v[16:17], v[18:19]
  v_mfma_f32_16x16x32_bf16 v[120:123], v[200:203], v[168:171], v[120:123]
  v_pk_add_f32 v[20:21], v[20:21], v[22:23]
  v_mov_b32 v18, v16
  v_mov_b32 v19, v17
  v_mov_b32 v22, v20
  v_mov_b32 v23, v21
  v_permlane32_swap_b32 v16, v18
  v_permlane32_swap_b32 v17, v19
  v_mfma_f32_16x16x32_bf16 v[124:127], v[200:203], v[172:175], v[124:127]
  v_permlane32_swap_b32 v20, v22
  v_permlane32_swap_b32 v21, v23
  v_pk_add_f32 v[16:17], v[16:17], v[18:19]
  v_pk_add_f32 v[20:21], v[20:21], v[22:23]
  v_pk_mul_f32 v[16:17], v[16:17], s[82:83]
  v_pk_mul_f32 v[20:21], v[20:21], s[82:83]
  v_mov_b32 v14, v16
  s_waitcnt lgkmcnt(0)
  v_mfma_f32_16x16x32_bf16 v[112:115], v[204:207], v[24:27], v[112:115]
  s_add_u32 m0, s99, 76800
  s_add_u32 s36, s98, 98432
  buffer_load_dwordx4 v8, s[24:27], s36 offen lds
  v_mov_b32 v255, v20
  v_fma_f32 v252, -v16, v16, v17
  v_fma_f32 v254, -v20, v20, v21
  v_max_f32 v252, 0, v252
  v_mfma_f32_16x16x32_bf16 v[116:119], v[204:207], v[28:31], v[116:119]
  v_max_f32 v254, 0, v254
  v_add_f32 v252, 0x3727c5ac, v252
  v_add_f32 v254, 0x3727c5ac, v254
  v_rsq_f32 v248, v252
  v_rsq_f32 v250, v254
  v_mul_f32 v252, 0x3727c5ac, v252
  v_mul_f32 v254, 0x3727c5ac, v254
  v_mfma_f32_16x16x32_bf16 v[120:123], v[204:207], v[32:35], v[120:123]
  v_mov_b32 v249, v248
  v_mov_b32 v251, v250
  v_mul_f32 v18, 0xc0135761, v248
  v_mul_f32 v22, 0xc0135761, v250
  v_mul_f32 v16, v248, v248
  v_mul_f32 v20, v250, v250
  v_mov_b32 v19, v18
  v_mfma_f32_16x16x32_bf16 v[124:127], v[204:207], v[36:39], v[124:127]
  v_mov_b32 v23, v22
  v_mul_f32 v16, v16, v248
  v_mul_f32 v20, v20, v250
  v_mul_f32 v16, 0xbdd2d3e8, v16
  v_mul_f32 v20, 0xbdd2d3e8, v20
  v_mov_b32 v17, v16
  v_mov_b32 v21, v20
  s_cmp_eq_u32 s31, 0
  s_cbranch_scc1 sequential_preLN__grouped_kv_mqa__mixer_gmlp__prompt_kernel_L77
  ds_write_b128 v4, v[112:115] offset:0
  ds_write_b128 v4, v[116:119] offset:1024
  v_mov_b32 v112, v120
  v_mov_b32 v113, v121
  v_mov_b32 v114, v122
  v_mov_b32 v115, v123
  v_mov_b32 v116, v124
  v_mov_b32 v117, v125
  v_mov_b32 v118, v126
  v_mov_b32 v119, v127
  s_branch sequential_preLN__grouped_kv_mqa__mixer_gmlp__prompt_kernel_L78
sequential_preLN__grouped_kv_mqa__mixer_gmlp__prompt_kernel_L77:
  ds_write_b128 v4, v[120:123] offset:0
  ds_write_b128 v4, v[124:127] offset:1024
sequential_preLN__grouped_kv_mqa__mixer_gmlp__prompt_kernel_L78:
  s_waitcnt lgkmcnt(0)
  s_barrier
  ds_read_b128 v[120:123], v5 offset:0
  ds_read_b128 v[124:127], v5 offset:1024
  s_waitcnt lgkmcnt(0)
  v_pk_add_f32 v[112:113], v[112:113], v[120:121]
  s_add_u32 s36, s98, 512
  v_pk_add_f32 v[114:115], v[114:115], v[122:123]
  v_pk_add_f32 v[116:117], v[116:117], v[124:125]
  v_pk_add_f32 v[118:119], v[118:119], v[126:127]
  buffer_load_dwordx4 v[176:179], v8, s[24:27], s36 offen
  v_fma_f32 v112, -v14, v240, v112
  v_fma_f32 v113, -v14, v241, v113
  v_fma_f32 v114, -v14, v242, v114
  s_add_u32 s36, s98, 33280
  v_fma_f32 v115, -v14, v243, v115
  v_fma_f32 v116, -v255, v240, v116
  v_fma_f32 v117, -v255, v241, v117
  buffer_load_dwordx4 v[180:183], v8, s[24:27], s36 offen
  v_fma_f32 v118, -v255, v242, v118
  v_fma_f32 v119, -v255, v243, v119
  v_pk_mul_f32 v[120:121], v[112:113], v[112:113]
  s_add_u32 s36, s98, 66048
  v_pk_mul_f32 v[122:123], v[114:115], v[114:115]
  v_pk_mul_f32 v[124:125], v[116:117], v[116:117]
  v_pk_mul_f32 v[126:127], v[118:119], v[118:119]
  buffer_load_dwordx4 v[184:187], v8, s[24:27], s36 offen
  v_pk_fma_f32 v[120:121], v[120:121], v[16:17], v[18:19]
  v_pk_fma_f32 v[122:123], v[122:123], v[16:17], v[18:19]
  v_pk_fma_f32 v[124:125], v[124:125], v[20:21], v[22:23]
  s_add_u32 s36, s98, 98816
  v_pk_fma_f32 v[126:127], v[126:127], v[20:21], v[22:23]
  v_pk_mul_f32 v[120:121], v[120:121], v[112:113]
  v_pk_mul_f32 v[122:123], v[122:123], v[114:115]
  buffer_load_dwordx4 v[188:191], v8, s[24:27], s36 offen
  v_pk_mul_f32 v[124:125], v[124:125], v[116:117]
  v_pk_mul_f32 v[126:127], v[126:127], v[118:119]
  v_exp_f32 v120, v120
  s_add_u32 s36, s98, 640
  v_exp_f32 v121, v121
  v_exp_f32 v122, v122
  v_exp_f32 v123, v123
  buffer_load_dwordx4 v[192:195], v8, s[24:27], s36 offen
  v_exp_f32 v124, v124
  v_exp_f32 v125, v125
  v_exp_f32 v126, v126
  s_add_u32 s36, s98, 33408
  v_exp_f32 v127, v127
  v_pk_add_f32 v[120:121], v[120:121], s[72:73]
  v_pk_add_f32 v[122:123], v[122:123], s[72:73]
  buffer_load_dwordx4 v[196:199], v8, s[24:27], s36 offen
  v_pk_add_f32 v[124:125], v[124:125], s[72:73]
  v_pk_add_f32 v[126:127], v[126:127], s[72:73]
  v_rcp_f32 v120, v120
  s_add_u32 s36, s98, 66176
  v_rcp_f32 v121, v121
  v_rcp_f32 v122, v122
  v_rcp_f32 v123, v123
  buffer_load_dwordx4 v[200:203], v8, s[24:27], s36 offen
  v_rcp_f32 v124, v124
  v_rcp_f32 v125, v125
  v_rcp_f32 v126, v126
  s_add_u32 s36, s98, 98944
  v_rcp_f32 v127, v127
  v_pk_mul_f32 v[112:113], v[112:113], v[120:121]
  v_pk_mul_f32 v[114:115], v[114:115], v[122:123]
  buffer_load_dwordx4 v[204:207], v8, s[24:27], s36 offen
  v_pk_mul_f32 v[116:117], v[116:117], v[124:125]
  v_pk_mul_f32 v[118:119], v[118:119], v[126:127]
  v_pk_add_f32 v[24:25], v[112:113], v[114:115]
  v_pk_mul_f32 v[26:27], v[112:113], v[112:113]
  v_pk_add_f32 v[28:29], v[116:117], v[118:119]
  v_pk_mul_f32 v[30:31], v[116:117], v[116:117]
  v_pk_fma_f32 v[26:27], v[114:115], v[114:115], v[26:27]
  v_pk_fma_f32 v[30:31], v[118:119], v[118:119], v[30:31]
  v_add_f32 v24, v24, v25
  v_add_f32 v25, v26, v27
  v_add_f32 v28, v28, v29
  v_add_f32 v29, v30, v31
  v_mov_b32 v26, v24
  v_mov_b32 v27, v25
  v_mov_b32 v30, v28
  v_mov_b32 v31, v29
  v_permlane16_swap_b32 v24, v26
  v_permlane16_swap_b32 v25, v27
  v_permlane16_swap_b32 v28, v30
  v_permlane16_swap_b32 v29, v31
  v_pk_add_f32 v[24:25], v[24:25], v[26:27]
  v_pk_add_f32 v[28:29], v[28:29], v[30:31]
  v_mov_b32 v26, v24
  v_mov_b32 v27, v25
  v_mov_b32 v30, v28
  v_mov_b32 v31, v29
  v_permlane32_swap_b32 v24, v26
  v_permlane32_swap_b32 v25, v27
  v_permlane32_swap_b32 v28, v30
  v_permlane32_swap_b32 v29, v31
  v_pk_add_f32 v[24:25], v[24:25], v[26:27]
  v_pk_add_f32 v[28:29], v[28:29], v[30:31]
  ds_write_b64 v11, v[24:25]
  ds_write_b64 v11, v[28:29] offset:128
  ds_read_b128 v[80:83], v3 offset:0
  ds_read_b128 v[84:87], v3 offset:16384
  ds_read_b128 v[88:91], v3 offset:32768
  ds_read_b128 v[92:95], v3 offset:49152
  ds_read_b128 v[96:99], v3 offset:2048
  ds_read_b128 v[100:103], v3 offset:18432
  ds_read_b128 v[104:107], v3 offset:34816
  ds_read_b128 v[108:111], v3 offset:51200
  ds_read_b128 v[160:163], v3 offset:4096
  ds_read_b128 v[164:167], v3 offset:20480
  ds_read_b128 v[168:171], v3 offset:36864
  ds_read_b128 v[172:175], v3 offset:53248
  s_waitcnt lgkmcnt(8)
  v_mfma_f32_16x16x32_bf16 v[128:131], v[208:211], v[80:83], 0
  ds_read_b128 v[24:27], v3 offset:6144
  v_mfma_f32_16x16x32_bf16 v[144:147], v[48:51], v[80:83], 0
  ds_read_b128 v[28:31], v3 offset:22528
  v_mfma_f32_16x16x32_bf16 v[132:135], v[208:211], v[84:87], 0
  ds_read_b128 v[32:35], v3 offset:38912
  v_mfma_f32_16x16x32_bf16 v[148:151], v[48:51], v[84:87], 0
  ds_read_b128 v[36:39], v3 offset:55296
  v_mfma_f32_16x16x32_bf16 v[136:139], v[208:211], v[88:91], 0
  v_mfma_f32_16x16x32_bf16 v[152:155], v[48:51], v[88:91], 0
  v_mfma_f32_16x16x32_bf16 v[140:143], v[208:211], v[92:95], 0
  v_mfma_f32_16x16x32_bf16 v[156:159], v[48:51], v[92:95], 0
  s_waitcnt lgkmcnt(8)
  v_mfma_f32_16x16x32_bf16 v[128:131], v[212:215], v[96:99], v[128:131]
  ds_read_b128 v[80:83], v3 offset:8192
  v_mfma_f32_16x16x32_bf16 v[144:147], v[52:55], v[96:99], v[144:147]
  ds_read_b128 v[84:87], v3 offset:24576
  v_mfma_f32_16x16x32_bf16 v[132:135], v[212:215], v[100:103], v[132:135]
  ds_read_b128 v[88:91], v3 offset:40960
  v_mfma_f32_16x16x32_bf16 v[148:151], v[52:55], v[100:103], v[148:151]
  ds_read_b128 v[92:95], v3 offset:57344
  v_mfma_f32_16x16x32_bf16 v[136:139], v[212:215], v[104:107], v[136:139]
  v_mfma_f32_16x16x32_bf16 v[152:155], v[52:55], v[104:107], v[152:155]
  v_mfma_f32_16x16x32_bf16 v[140:143], v[212:215], v[108:111], v[140:143]
  v_mfma_f32_16x16x32_bf16 v[156:159], v[52:55], v[108:111], v[156:159]
  s_waitcnt lgkmcnt(8)
  v_mfma_f32_16x16x32_bf16 v[128:131], v[216:219], v[160:163], v[128:131]
  ds_read_b128 v[96:99], v3 offset:10240
  v_mfma_f32_16x16x32_bf16 v[144:147], v[56:59], v[160:163], v[144:147]
  ds_read_b128 v[100:103], v3 offset:26624
  v_mfma_f32_16x16x32_bf16 v[132:135], v[216:219], v[164:167], v[132:135]
  ds_read_b128 v[104:107], v3 offset:43008
  v_mfma_f32_16x16x32_bf16 v[148:151], v[56:59], v[164:167], v[148:151]
  ds_read_b128 v[108:111], v3 offset:59392
  v_mfma_f32_16x16x32_bf16 v[136:139], v[216:219], v[168:171], v[136:139]
  v_mfma_f32_16x16x32_bf16 v[152:155], v[56:59], v[168:171], v[152:155]
  v_mfma_f32_16x16x32_bf16 v[140:143], v[216:219], v[172:175], v[140:143]
  v_mfma_f32_16x16x32_bf16 v[156:159], v[56:59], v[172:175], v[156:159]
  s_waitcnt vmcnt(8)
  s_waitcnt lgkmcnt(0)
  s_barrier
  s_waitcnt lgkmcnt(8)
  v_mfma_f32_16x16x32_bf16 v[128:131], v[220:223], v[24:27], v[128:131]
  ds_read_b128 v[160:163], v3 offset:12288
  v_mfma_f32_16x16x32_bf16 v[144:147], v[60:63], v[24:27], v[144:147]
  ds_read_b128 v[164:167], v3 offset:28672
  v_mfma_f32_16x16x32_bf16 v[132:135], v[220:223], v[28:31], v[132:135]
  ds_read_b128 v[168:171], v3 offset:45056
  v_mfma_f32_16x16x32_bf16 v[148:151], v[60:63], v[28:31], v[148:151]
  ds_read_b128 v[172:175], v3 offset:61440
  v_mfma_f32_16x16x32_bf16 v[136:139], v[220:223], v[32:35], v[136:139]
  v_mfma_f32_16x16x32_bf16 v[152:155], v[60:63], v[32:35], v[152:155]
  v_mfma_f32_16x16x32_bf16 v[140:143], v[220:223], v[36:39], v[140:143]
  v_mfma_f32_16x16x32_bf16 v[156:159], v[60:63], v[36:39], v[156:159]
  s_waitcnt lgkmcnt(8)
  v_mfma_f32_16x16x32_bf16 v[128:131], v[224:227], v[80:83], v[128:131]
  ds_read_b128 v[24:27], v3 offset:14336
  v_mfma_f32_16x16x32_bf16 v[144:147], v[64:67], v[80:83], v[144:147]
  ds_read_b128 v[28:31], v3 offset:30720
  v_mfma_f32_16x16x32_bf16 v[132:135], v[224:227], v[84:87], v[132:135]
  ds_read_b128 v[32:35], v3 offset:47104
  v_mfma_f32_16x16x32_bf16 v[148:151], v[64:67], v[84:87], v[148:151]
  ds_read_b128 v[36:39], v3 offset:63488
  v_mfma_f32_16x16x32_bf16 v[136:139], v[224:227], v[88:91], v[136:139]
  v_mfma_f32_16x16x32_bf16 v[152:155], v[64:67], v[88:91], v[152:155]
  v_mfma_f32_16x16x32_bf16 v[140:143], v[224:227], v[92:95], v[140:143]
  v_mfma_f32_16x16x32_bf16 v[156:159], v[64:67], v[92:95], v[156:159]
  s_waitcnt lgkmcnt(8)
  v_mfma_f32_16x16x32_bf16 v[128:131], v[228:231], v[96:99], v[128:131]
  v_mfma_f32_16x16x32_bf16 v[144:147], v[68:71], v[96:99], v[144:147]
  v_mfma_f32_16x16x32_bf16 v[132:135], v[228:231], v[100:103], v[132:135]
  v_mfma_f32_16x16x32_bf16 v[148:151], v[68:71], v[100:103], v[148:151]
  v_mfma_f32_16x16x32_bf16 v[136:139], v[228:231], v[104:107], v[136:139]
  v_mfma_f32_16x16x32_bf16 v[152:155], v[68:71], v[104:107], v[152:155]
  v_mfma_f32_16x16x32_bf16 v[140:143], v[228:231], v[108:111], v[140:143]
  v_mfma_f32_16x16x32_bf16 v[156:159], v[68:71], v[108:111], v[156:159]
  s_waitcnt lgkmcnt(4)
  v_mfma_f32_16x16x32_bf16 v[128:131], v[232:235], v[160:163], v[128:131]
  v_mfma_f32_16x16x32_bf16 v[144:147], v[72:75], v[160:163], v[144:147]
  v_mfma_f32_16x16x32_bf16 v[132:135], v[232:235], v[164:167], v[132:135]
  v_mfma_f32_16x16x32_bf16 v[148:151], v[72:75], v[164:167], v[148:151]
  v_mfma_f32_16x16x32_bf16 v[136:139], v[232:235], v[168:171], v[136:139]
  v_mfma_f32_16x16x32_bf16 v[152:155], v[72:75], v[168:171], v[152:155]
  v_mfma_f32_16x16x32_bf16 v[140:143], v[232:235], v[172:175], v[140:143]
  v_mfma_f32_16x16x32_bf16 v[156:159], v[72:75], v[172:175], v[156:159]
  s_waitcnt lgkmcnt(0)
  v_mfma_f32_16x16x32_bf16 v[128:131], v[236:239], v[24:27], v[128:131]
  buffer_load_dwordx4 v[240:243], v2, s[8:11], s75 offen sc1
  v_mfma_f32_16x16x32_bf16 v[144:147], v[76:79], v[24:27], v[144:147]
  buffer_load_dwordx4 v[244:247], v2, s[8:11], s75 offen offset:1024 sc1
  v_mfma_f32_16x16x32_bf16 v[132:135], v[236:239], v[28:31], v[132:135]
  v_mfma_f32_16x16x32_bf16 v[148:151], v[76:79], v[28:31], v[148:151]
  v_mfma_f32_16x16x32_bf16 v[136:139], v[236:239], v[32:35], v[136:139]
  v_mfma_f32_16x16x32_bf16 v[152:155], v[76:79], v[32:35], v[152:155]
  v_mfma_f32_16x16x32_bf16 v[140:143], v[236:239], v[36:39], v[140:143]
  v_mfma_f32_16x16x32_bf16 v[156:159], v[76:79], v[36:39], v[156:159]
  s_waitcnt vmcnt(0)
  s_mov_b32 s48, 100000
sequential_preLN__grouped_kv_mqa__mixer_gmlp__prompt_kernel_zp79:
  v_max3_u32 v13, v240, v241, v242
  v_max3_u32 v13, v13, v243, v244
  v_max3_u32 v13, v13, v245, v246
  v_max_u32 v13, v13, v247
  v_cmp_eq_u32 vcc, -1, v13
  s_cbranch_vccz sequential_preLN__grouped_kv_mqa__mixer_gmlp__prompt_kernel_zpx80
  s_sub_u32 s48, s48, 1
  s_cmp_eq_u32 s48, 0
  s_cbranch_scc1 sequential_preLN__grouped_kv_mqa__mixer_gmlp__prompt_kernel_zpx80
  buffer_load_dwordx4 v[240:243], v2, s[8:11], s75 offen sc1
  buffer_load_dwordx4 v[244:247], v2, s[8:11], s75 offen offset:1024 sc1
  s_waitcnt vmcnt(0)
  s_branch sequential_preLN__grouped_kv_mqa__mixer_gmlp__prompt_kernel_zp79
sequential_preLN__grouped_kv_mqa__mixer_gmlp__prompt_kernel_zpx80:
  v_pk_add_f32 v[240:241], v[240:241], v[242:243]
  v_pk_add_f32 v[244:245], v[244:245], v[246:247]
  v_mov_b32 v242, v240
  v_mov_b32 v243, v241
  v_mov_b32 v246, v244
  v_mov_b32 v247, v245
  v_permlane16_swap_b32 v240, v242
  v_permlane16_swap_b32 v241, v243
  v_permlane16_swap_b32 v244, v246
  v_permlane16_swap_b32 v245, v247
  v_pk_add_f32 v[240:241], v[240:241], v[242:243]
  v_pk_add_f32 v[244:245], v[244:245], v[246:247]
  v_mov_b32 v242, v240
  v_mov_b32 v243, v241
  v_mov_b32 v246, v244
  v_mov_b32 v247, v245
  v_permlane32_swap_b32 v240, v242
  v_permlane32_swap_b32 v241, v243
  v_permlane32_swap_b32 v244, v246
  v_permlane32_swap_b32 v245, v247
  v_pk_add_f32 v[240:241], v[240:241], v[242:243]
  v_pk_add_f32 v[244:245], v[244:245], v[246:247]
  v_pk_mul_f32 v[240:241], v[240:241], s[84:85]
  v_pk_mul_f32 v[244:245], v[244:245], s[84:85]
  v_fma_f32 v241, -v240, v240, v241
  v_fma_f32 v245, -v244, v244, v245
  v_max_f32 v241, 0, v241
  v_max_f32 v245, 0, v245
  v_add_f32 v241, v241, v252
  v_add_f32 v245, v245, v254
  v_rsq_f32 v242, v241
  v_rsq_f32 v246, v245
  v_rsq_f32 v243, v241
  v_rsq_f32 v247, v245
  v_mul_f32 v241, -v240, v242
  v_mul_f32 v245, -v244, v246
  v_mul_f32 v240, -v240, v242
  v_mul_f32 v244, -v244, v246
  v_pk_fma_f32 v[112:113], v[112:113], v[242:243], v[240:241]
  v_pk_fma_f32 v[114:115], v[114:115], v[242:243], v[240:241]
  v_cvt_pk_bf16_f32 v120, v112, v113
  v_cvt_pk_bf16_f32 v121, v114, v115
  ds_write_b64 v40, v[120:121] offset:0
  v_pk_fma_f32 v[116:117], v[116:117], v[246:247], v[244:245]
  v_pk_fma_f32 v[118:119], v[118:119], v[246:247], v[244:245]
  v_cvt_pk_bf16_f32 v122, v116, v117
  v_cvt_pk_bf16_f32 v123, v118, v119
  ds_write_b64 v40, v[122:123] offset:512
  s_waitcnt lgkmcnt(0)
  ds_read_b64_tr_b16 v[112:113], v41 offset:0
  ds_read_b64_tr_b16 v[114:115], v41 offset:128
  s_waitcnt lgkmcnt(0)
  buffer_store_dwordx4 v[112:115], v2, s[8:11], s80 offen sc1
  v_and_b32 v13, 48, v1
  s_lshl_b32 s36, s94, 6
  s_lshl_b32 s49, s95, 6
  s_add_u32 s36, s36, s49
  s_add_u32 s36, s36, 655360
  buffer_load_dwordx4 v[240:243], v13, s[8:11], s36 offen sc1
  s_lshl_b32 s36, s93, 6
  s_lshl_b32 s49, s95, 6
  s_add_u32 s36, s36, s49
  s_add_u32 s36, s36, 655360
  s_add_u32 s36, s36, s92
  buffer_load_dwordx4 v[244:247], v13, s[8:11], s36 offen sc1
sequential_preLN__grouped_kv_mqa__mixer_gmlp__prompt_kernel_dj65:
  s_mul_i32 s53, s29, 3
  s_add_u32 s53, s53, s95
  s_cmp_gt_u32 s29, s96
  s_cselect_b32 s54, 1073741824, 0
  s_lshl_b32 s33, s53, 16
  s_lshl_b32 s49, s32, 14
  s_add_u32 s33, s33, s49
  s_add_u32 s33, s33, 5242880
  s_add_u32 s34, s33, 65536
  s_add_u32 s35, s34, 65536
  s_add_u32 s35, s35, s54
  v_and_b32 v13, 7, v1
  v_lshrrev_b32 v3, 4, v1
  v_xor_b32 v3, v3, v13
  v_lshlrev_b32 v3, 4, v3
  v_lshl_add_u32 v3, v10, 7, v3
  s_lshl_b32 s39, s32, 14
  v_add_u32 v3, s39, v3
  v_add_u32 v4, 0x10000, v3
  v_xor_b32 v6, 64, v4
  v_add_u32 v5, s99, v2
  v_add_u32 v11, 0x10000, v5
  s_lshl_b32 s40, s6, 12
  s_add_u32 s40, s40, 270336
  s_mov_b32 s41, s40
  s_lshl_b32 s49, s5, 7
  s_add_u32 s41, s41, s49
  v_lshlrev_b32 v40, 3, v1
  v_add_u32 v40, s87, v40
  s_waitcnt vmcnt(1)
  s_barrier
  s_cmp_lg_u32 s4, 0
  s_cbranch_scc1 sequential_preLN__grouped_kv_mqa__mixer_gmlp__prompt_kernel_L81
  s_mov_b64 exec, 1
  v_mov_b32 v13, 1
  buffer_store_dword v13, v15, s[8:11], s41 offen sc1
  s_mov_b64 exec, -1
sequential_preLN__grouped_kv_mqa__mixer_gmlp__prompt_kernel_L81:
  s_cmp_eq_u32 s91, 0
  s_cbranch_scc1 sequential_preLN__grouped_kv_mqa__mixer_gmlp__prompt_kernel_L86
  s_cmp_eq_u32 s31, 0
  s_cbranch_scc1 sequential_preLN__grouped_kv_mqa__mixer_gmlp__prompt_kernel_L88
  ds_write_b128 v42, v[128:131] offset:0
  ds_write_b128 v42, v[132:135] offset:1024
  ds_write_b128 v42, v[144:147] offset:2048
  ds_write_b128 v42, v[148:151] offset:3072
  v_mov_b32 v128, v136
  v_mov_b32 v129, v137
  v_mov_b32 v130, v138
  v_mov_b32 v131, v139
  v_mov_b32 v132, v140
  v_mov_b32 v133, v141
  v_mov_b32 v134, v142
  v_mov_b32 v135, v143
  v_mov_b32 v144, v152
  v_mov_b32 v145, v153
  v_mov_b32 v146, v154
  v_mov_b32 v147, v155
  v_mov_b32 v148, v156
  v_mov_b32 v149, v157
  v_mov_b32 v150, v158
  v_mov_b32 v151, v159
  s_branch sequential_preLN__grouped_kv_mqa__mixer_gmlp__prompt_kernel_L89
sequential_preLN__grouped_kv_mqa__mixer_gmlp__prompt_kernel_L88:
  ds_write_b128 v42, v[136:139] offset:0
  ds_write_b128 v42, v[140:143] offset:1024
  ds_write_b128 v42, v[152:155] offset:2048
  ds_write_b128 v42, v[156:159] offset:3072
sequential_preLN__grouped_kv_mqa__mixer_gmlp__prompt_kernel_L89:
  s_add_u32 s36, s98, 768
  buffer_load_dwordx4 v[208:211], v8, s[24:27], s36 offen
  s_add_u32 s36, s98, 33536
  buffer_load_dwordx4 v[212:215], v8, s[24:27], s36 offen
  s_add_u32 s36, s98, 66304
  buffer_load_dwordx4 v[216:219], v8, s[24:27], s36 offen
  s_add_u32 s36, s98, 99072
  buffer_load_dwordx4 v[220:223], v8, s[24:27], s36 offen
  s_add_u32 s36, s98, 896
  buffer_load_dwordx4 v[224:227], v8, s[24:27], s36 offen
  s_add_u32 s36, s98, 33664
  buffer_load_dwordx4 v[228:231], v8, s[24:27], s36 offen
  s_add_u32 s36, s98, 66432
  buffer_load_dwordx4 v[232:235], v8, s[24:27], s36 offen
  s_add_u32 s36, s98, 99200
  buffer_load_dwordx4 v[236:239], v8, s[24:27], s36 offen
  s_branch sequential_preLN__grouped_kv_mqa__mixer_gmlp__prompt_kernel_L87
sequential_preLN__grouped_kv_mqa__mixer_gmlp__prompt_kernel_L86:
  s_cmp_eq_u32 s31, 0
  s_cbranch_scc1 sequential_preLN__grouped_kv_mqa__mixer_gmlp__prompt_kernel_L90
  ds_write_b128 v42, v[144:147] offset:0
  ds_write_b128 v42, v[148:151] offset:1024
  v_mov_b32 v144, v152
  v_mov_b32 v145, v153
  v_mov_b32 v146, v154
  v_mov_b32 v147, v155
  v_mov_b32 v148, v156
  v_mov_b32 v149, v157
  v_mov_b32 v150, v158
  v_mov_b32 v151, v159
  s_branch sequential_preLN__grouped_kv_mqa__mixer_gmlp__prompt_kernel_L91
sequential_preLN__grouped_kv_mqa__mixer_gmlp__prompt_kernel_L90:
  ds_write_b128 v42, v[152:155] offset:0
  ds_write_b128 v42, v[156:159] offset:1024
sequential_preLN__grouped_kv_mqa__mixer_gmlp__prompt_kernel_L91:
sequential_preLN__grouped_kv_mqa__mixer_gmlp__prompt_kernel_L87:
  s_add_u32 m0, s99, 0
  s_add_u32 s36, s98, 256
  buffer_load_dwordx4 v8, s[24:27], s36 offen lds
  s_add_u32 m0, s99, 1024
  s_add_u32 s36, s98, 33024
  buffer_load_dwordx4 v8, s[24:27], s36 offen lds
  s_add_u32 m0, s99, 2048
  s_add_u32 s36, s98, 65792
  buffer_load_dwordx4 v8, s[24:27], s36 offen lds
  s_add_u32 m0, s99, 3072
  s_add_u32 s36, s98, 98560
  buffer_load_dwordx4 v8, s[24:27], s36 offen lds
  s_add_u32 m0, s99, 8192
  s_add_u32 s36, s98, 384
  buffer_load_dwordx4 v8, s[24:27], s36 offen lds
  s_add_u32 m0, s99, 9216
  s_add_u32 s36, s98, 33152
  buffer_load_dwordx4 v8, s[24:27], s36 offen lds
  s_add_u32 m0, s99, 10240
  s_add_u32 s36, s98, 65920
  buffer_load_dwordx4 v8, s[24:27], s36 offen lds
  s_add_u32 m0, s99, 11264
  s_add_u32 s36, s98, 98688
  buffer_load_dwordx4 v8, s[24:27], s36 offen lds
  s_cmp_lg_u32 s4, 0
  s_cbranch_scc1 sequential_preLN__grouped_kv_mqa__mixer_gmlp__prompt_kernel_L85
  s_mov_b32 s48, 100000
sequential_preLN__grouped_kv_mqa__mixer_gmlp__prompt_kernel_p382:
  v_and_b32 v13, 31, v1
  v_lshlrev_b32 v13, 7, v13
  buffer_load_dword v161, v13, s[8:11], s40 offen sc1
  s_sub_u32 s48, s48, 1
  s_cmp_eq_u32 s48, 0
  s_cbranch_scc1 sequential_preLN__grouped_kv_mqa__mixer_gmlp__prompt_kernel_p3x83
  s_waitcnt vmcnt(0)
  v_cmp_eq_u32 vcc, 0, v161
  s_cbranch_vccnz sequential_preLN__grouped_kv_mqa__mixer_gmlp__prompt_kernel_p382
sequential_preLN__grouped_kv_mqa__mixer_gmlp__prompt_kernel_p3x83:
  s_waitcnt lgkmcnt(0)
sequential_preLN__grouped_kv_mqa__mixer_gmlp__prompt_kernel_L85:
  s_waitcnt lgkmcnt(0)
  s_barrier
  buffer_load_dwordx4 v[48:51], v2, s[8:11], s33 offen offset:0 sc1
  buffer_load_dwordx4 v[52:55], v2, s[8:11], s34 offen offset:0 sc1
  buffer_load_dwordx4 v[56:59], v2, s[8:11], s35 offen offset:0 sc1
  buffer_load_dwordx4 v[60:63], v2, s[8:11], s33 offen offset:1024 sc1
  buffer_load_dwordx4 v[64:67], v2, s[8:11], s34 offen offset:1024 sc1
  buffer_load_dwordx4 v[68:71], v2, s[8:11], s35 offen offset:1024 sc1
  buffer_load_dwordx4 v[72:75], v2, s[8:11], s33 offen offset:2048 sc1
  buffer_load_dwordx4 v[76:79], v2, s[8:11], s34 offen offset:2048 sc1
  buffer_load_dwordx4 v[80:83], v2, s[8:11], s35 offen offset:2048 sc1
  buffer_load_dwordx4 v[84:87], v2, s[8:11], s33 offen offset:3072 sc1
  buffer_load_dwordx4 v[88:91], v2, s[8:11], s34 offen offset:3072 sc1
  buffer_load_dwordx4 v[92:95], v2, s[8:11], s35 offen offset:3072 sc1
  s_cmp_eq_u32 s91, 0
  s_cbranch_scc1 sequential_preLN__grouped_kv_mqa__mixer_gmlp__prompt_kernel_L92
  ds_read_b128 v[136:139], v43 offset:0
  ds_read_b128 v[140:143], v43 offset:1024
  ds_read_b128 v[152:155], v43 offset:2048
  ds_read_b128 v[156:159], v43 offset:3072
  s_waitcnt vmcnt(12) lgkmcnt(0)
  v_pk_add_f32 v[128:129], v[128:129], v[136:137]
  v_pk_add_f32 v[130:131], v[130:131], v[138:139]
  v_pk_add_f32 v[132:133], v[132:133], v[140:141]
  v_pk_add_f32 v[134:135], v[134:135], v[142:143]
  v_pk_add_f32 v[144:145], v[144:145], v[152:153]
  v_pk_add_f32 v[146:147], v[146:147], v[154:155]
  v_pk_add_f32 v[148:149], v[148:149], v[156:157]
  v_pk_add_f32 v[150:151], v[150:151], v[158:159]
  v_fma_f32 v128, -v14, v240, v128
  v_fma_f32 v129, -v14, v241, v129
  v_fma_f32 v130, -v14, v242, v130
  v_fma_f32 v131, -v14, v243, v131
  v_fma_f32 v132, -v255, v240, v132
  v_fma_f32 v133, -v255, v241, v133
  v_fma_f32 v134, -v255, v242, v134
  v_fma_f32 v135, -v255, v243, v135
  v_fma_f32 v144, -v14, v244, v144
  v_fma_f32 v145, -v14, v245, v145
  v_fma_f32 v146, -v14, v246, v146
  v_fma_f32 v147, -v14, v247, v147
  v_fma_f32 v148, -v255, v244, v148
  v_fma_f32 v149, -v255, v245, v149
  v_fma_f32 v150, -v255, v246, v150
  v_fma_f32 v151, -v255, v247, v151
  v_pk_mul_f32 v[136:137], v[128:129], v[128:129]
  v_pk_mul_f32 v[138:139], v[130:131], v[130:131]
  v_pk_mul_f32 v[140:141], v[132:133], v[132:133]
  v_pk_mul_f32 v[142:143], v[134:135], v[134:135]
  v_pk_mul_f32 v[152:153], v[144:145], v[144:145]
  v_pk_mul_f32 v[154:155], v[146:147], v[146:147]
  v_pk_mul_f32 v[156:157], v[148:149], v[148:149]
  v_pk_mul_f32 v[158:159], v[150:151], v[150:151]
  v_pk_fma_f32 v[136:137], v[136:137], v[16:17], v[18:19]
  v_pk_fma_f32 v[138:139], v[138:139], v[16:17], v[18:19]
  v_pk_fma_f32 v[140:141], v[140:141], v[20:21], v[22:23]
  v_pk_fma_f32 v[142:143], v[142:143], v[20:21], v[22:23]
  v_pk_fma_f32 v[152:153], v[152:153], v[16:17], v[18:19]
  v_pk_fma_f32 v[154:155], v[154:155], v[16:17], v[18:19]
  v_pk_fma_f32 v[156:157], v[156:157], v[20:21], v[22:23]
  v_pk_fma_f32 v[158:159], v[158:159], v[20:21], v[22:23]
  v_pk_mul_f32 v[136:137], v[136:137], v[128:129]
  v_pk_mul_f32 v[138:139], v[138:139], v[130:131]
  v_pk_mul_f32 v[140:141], v[140:141], v[132:133]
  v_pk_mul_f32 v[142:143], v[142:143], v[134:135]
  v_pk_mul_f32 v[152:153], v[152:153], v[144:145]
  v_pk_mul_f32 v[154:155], v[154:155], v[146:147]
  v_pk_mul_f32 v[156:157], v[156:157], v[148:149]
  v_pk_mul_f32 v[158:159], v[158:159], v[150:151]
  v_exp_f32 v136, v136
  v_exp_f32 v137, v137
  v_exp_f32 v138, v138
  v_exp_f32 v139, v139
  v_exp_f32 v140, v140
  v_exp_f32 v141, v141
  v_exp_f32 v142, v142
  v_exp_f32 v143, v143
  v_exp_f32 v152, v152
  v_exp_f32 v153, v153
  v_exp_f32 v154, v154
  v_exp_f32 v155, v155
  v_exp_f32 v156, v156
  v_exp_f32 v157, v157
  v_exp_f32 v158, v158
  v_exp_f32 v159, v159
  v_pk_add_f32 v[136:137], v[136:137], s[72:73]
  v_pk_add_f32 v[138:139], v[138:139], s[72:73]
  v_pk_add_f32 v[140:141], v[140:141], s[72:73]
  v_pk_add_f32 v[142:143], v[142:143], s[72:73]
  v_pk_add_f32 v[152:153], v[152:153], s[72:73]
  v_pk_add_f32 v[154:155], v[154:155], s[72:73]
  v_pk_add_f32 v[156:157], v[156:157], s[72:73]
  v_pk_add_f32 v[158:159], v[158:159], s[72:73]
  v_pk_mul_f32 v[128:129], v[128:129], v[248:249]
  v_pk_mul_f32 v[130:131], v[130:131], v[248:249]
  v_pk_mul_f32 v[132:133], v[132:133], v[250:251]
  v_pk_mul_f32 v[134:135], v[134:135], v[250:251]
  v_pk_mul_f32 v[144:145], v[144:145], v[248:249]
  v_pk_mul_f32 v[146:147], v[146:147], v[248:249]
  v_pk_mul_f32 v[148:149], v[148:149], v[250:251]
  v_pk_mul_f32 v[150:151], v[150:151], v[250:251]
  v_rcp_f32 v136, v136
  v_rcp_f32 v137, v137
  v_rcp_f32 v138, v138
  v_rcp_f32 v139, v139
  v_rcp_f32 v140, v140
  v_rcp_f32 v141, v141
  v_rcp_f32 v142, v142
  v_rcp_f32 v143, v143
  v_rcp_f32 v152, v152
  v_rcp_f32 v153, v153
  v_rcp_f32 v154, v154
  v_rcp_f32 v155, v155
  v_rcp_f32 v156, v156
  v_rcp_f32 v157, v157
  v_rcp_f32 v158, v158
  v_rcp_f32 v159, v159
  v_pk_mul_f32 v[128:129], v[128:129], v[136:137]
  v_pk_mul_f32 v[130:131], v[130:131], v[138:139]
  v_pk_mul_f32 v[132:133], v[132:133], v[140:141]
  v_pk_mul_f32 v[134:135], v[134:135], v[142:143]
  v_pk_mul_f32 v[144:145], v[144:145], v[152:153]
  v_pk_mul_f32 v[146:147], v[146:147], v[154:155]
  v_pk_mul_f32 v[148:149], v[148:149], v[156:157]
  v_pk_mul_f32 v[150:151], v[150:151], v[158:159]
  v_cvt_pk_bf16_f32 v136, v128, v129
  v_cvt_pk_bf16_f32 v137, v130, v131
  v_cvt_pk_bf16_f32 v138, v132, v133
  v_cvt_pk_bf16_f32 v139, v134, v135
  ds_write_b64 v40, v[136:137] offset:0
  ds_write_b64 v40, v[138:139] offset:512
  v_cvt_pk_bf16_f32 v152, v144, v145
  v_cvt_pk_bf16_f32 v153, v146, v147
  v_cvt_pk_bf16_f32 v154, v148, v149
  v_cvt_pk_bf16_f32 v155, v150, v151
  ds_write_b64 v40, v[152:153] offset:1024
  ds_write_b64 v40, v[154:155] offset:1536
  s_branch sequential_preLN__grouped_kv_mqa__mixer_gmlp__prompt_kernel_L93
sequential_preLN__grouped_kv_mqa__mixer_gmlp__prompt_kernel_L92:
  ds_read_b128 v[152:155], v43 offset:0
  ds_read_b128 v[156:159], v43 offset:1024
  s_waitcnt vmcnt(12) lgkmcnt(0)
  v_pk_add_f32 v[144:145], v[144:145], v[152:153]
  v_pk_add_f32 v[146:147], v[146:147], v[154:155]
  v_pk_add_f32 v[148:149], v[148:149], v[156:157]
  v_pk_add_f32 v[150:151], v[150:151], v[158:159]
  v_fma_f32 v144, -v14, v240, v144
  v_fma_f32 v145, -v14, v241, v145
  v_fma_f32 v146, -v14, v242, v146
  v_fma_f32 v147, -v14, v243, v147
  v_fma_f32 v148, -v255, v240, v148
  v_fma_f32 v149, -v255, v241, v149
  v_fma_f32 v150, -v255, v242, v150
  v_fma_f32 v151, -v255, v243, v151
  v_pk_mul_f32 v[152:153], v[144:145], v[144:145]
  v_pk_mul_f32 v[154:155], v[146:147], v[146:147]
  v_pk_mul_f32 v[156:157], v[148:149], v[148:149]
  v_pk_mul_f32 v[158:159], v[150:151], v[150:151]
  v_pk_fma_f32 v[152:153], v[152:153], v[16:17], v[18:19]
  v_pk_fma_f32 v[154:155], v[154:155], v[16:17], v[18:19]
  v_pk_fma_f32 v[156:157], v[156:157], v[20:21], v[22:23]
  v_pk_fma_f32 v[158:159], v[158:159], v[20:21], v[22:23]
  v_pk_mul_f32 v[152:153], v[152:153], v[144:145]
  v_pk_mul_f32 v[154:155], v[154:155], v[146:147]
  v_pk_mul_f32 v[156:157], v[156:157], v[148:149]
  v_pk_mul_f32 v[158:159], v[158:159], v[150:151]
  v_exp_f32 v152, v152
  v_exp_f32 v153, v153
  v_exp_f32 v154, v154
  v_exp_f32 v155, v155
  v_exp_f32 v156, v156
  v_exp_f32 v157, v157
  v_exp_f32 v158, v158
  v_exp_f32 v159, v159
  v_pk_add_f32 v[152:153], v[152:153], s[72:73]
  v_pk_add_f32 v[154:155], v[154:155], s[72:73]
  v_pk_add_f32 v[156:157], v[156:157], s[72:73]
  v_pk_add_f32 v[158:159], v[158:159], s[72:73]
  v_pk_mul_f32 v[144:145], v[144:145], v[248:249]
  v_pk_mul_f32 v[146:147], v[146:147], v[248:249]
  v_pk_mul_f32 v[148:149], v[148:149], v[250:251]
  v_pk_mul_f32 v[150:151], v[150:151], v[250:251]
  v_rcp_f32 v152, v152
  v_rcp_f32 v153, v153
  v_rcp_f32 v154, v154
  v_rcp_f32 v155, v155
  v_rcp_f32 v156, v156
  v_rcp_f32 v157, v157
  v_rcp_f32 v158, v158
  v_rcp_f32 v159, v159
  v_pk_mul_f32 v[144:145], v[144:145], v[152:153]
  v_pk_mul_f32 v[146:147], v[146:147], v[154:155]
  v_pk_mul_f32 v[148:149], v[148:149], v[156:157]
  v_pk_mul_f32 v[150:151], v[150:151], v[158:159]
  v_cvt_pk_bf16_f32 v152, v144, v145
  v_cvt_pk_bf16_f32 v153, v146, v147
  v_cvt_pk_bf16_f32 v154, v148, v149
  v_cvt_pk_bf16_f32 v155, v150, v151
  ds_write_b64 v40, v[152:153] offset:0
  ds_write_b64 v40, v[154:155] offset:512
sequential_preLN__grouped_kv_mqa__mixer_gmlp__prompt_kernel_L93:
  v_xor_b32 v14, 64, v3
  ds_read_b128 v[16:19], v4 offset:0
  ds_read_b128 v[20:23], v4 offset:2048
  ds_read_b128 v[24:27], v4 offset:4096
  ds_read_b128 v[28:31], v4 offset:6144
  s_waitcnt vmcnt(9)
  s_waitcnt lgkmcnt(0)
  v_mfma_f32_16x16x32_bf16 v[112:115], v[48:51], v[16:19], 0
  ds_read_b128 v[32:35], v6 offset:0
  v_mfma_f32_16x16x32_bf16 v[116:119], v[52:55], v[16:19], 0
  ds_read_b128 v[36:39], v6 offset:2048
  v_mfma_f32_16x16x32_bf16 v[120:123], v[56:59], v[16:19], 0
  ds_read_b128 v[40:43], v6 offset:4096
  v_mfma_f32_16x16x32_bf16 v[124:127], v[48:51], v[20:23], 0
  ds_read_b128 v[108:111], v6 offset:6144
  v_mfma_f32_16x16x32_bf16 v[128:131], v[52:55], v[20:23], 0
  s_add_u32 s33, s33, 4096
  v_mfma_f32_16x16x32_bf16 v[132:135], v[56:59], v[20:23], 0
  s_add_u32 s34, s34, 4096
  v_mfma_f32_16x16x32_bf16 v[136:139], v[48:51], v[24:27], 0
  s_add_u32 s35, s35, 4096
  v_mfma_f32_16x16x32_bf16 v[140:143], v[52:55], v[24:27], 0
  buffer_load_dwordx4 v[96:99], v2, s[8:11], s33 offen offset:0 sc1
  v_mfma_f32_16x16x32_bf16 v[144:147], v[56:59], v[24:27], 0
  buffer_load_dwordx4 v[100:103], v2, s[8:11], s34 offen offset:0 sc1
  v_mfma_f32_16x16x32_bf16 v[148:151], v[48:51], v[28:31], 0
  buffer_load_dwordx4 v[104:107], v2, s[8:11], s35 offen offset:0 sc1
  v_mfma_f32_16x16x32_bf16 v[152:155], v[52:55], v[28:31], 0
  v_mfma_f32_16x16x32_bf16 v[156:159], v[56:59], v[28:31], 0
  s_waitcnt vmcnt(9)
  s_waitcnt lgkmcnt(0)
  v_mfma_f32_16x16x32_bf16 v[112:115], v[60:63], v[32:35], v[112:115]
  ds_read_b128 v[16:19], v4 offset:8192
  v_mfma_f32_16x16x32_bf16 v[116:119], v[64:67], v[32:35], v[116:119]
  ds_read_b128 v[20:23], v4 offset:10240
  v_mfma_f32_16x16x32_bf16 v[120:123], v[68:71], v[32:35], v[120:123]
  ds_read_b128 v[24:27], v4 offset:12288
  v_mfma_f32_16x16x32_bf16 v[124:127], v[60:63], v[36:39], v[124:127]
  ds_read_b128 v[28:31], v4 offset:14336
  v_mfma_f32_16x16x32_bf16 v[128:131], v[64:67], v[36:39], v[128:131]
  buffer_load_dwordx4 v[48:51], v2, s[8:11], s33 offen offset:1024 sc1
  v_mfma_f32_16x16x32_bf16 v[132:135], v[68:71], v[36:39], v[132:135]
  buffer_load_dwordx4 v[52:55], v2, s[8:11], s34 offen offset:1024 sc1
  v_mfma_f32_16x16x32_bf16 v[136:139], v[60:63], v[40:43], v[136:139]
  buffer_load_dwordx4 v[56:59], v2, s[8:11], s35 offen offset:1024 sc1
  v_mfma_f32_16x16x32_bf16 v[140:143], v[64:67], v[40:43], v[140:143]
  v_mfma_f32_16x16x32_bf16 v[144:147], v[68:71], v[40:43], v[144:147]
  v_mfma_f32_16x16x32_bf16 v[148:151], v[60:63], v[108:111], v[148:151]
  v_mfma_f32_16x16x32_bf16 v[152:155], v[64:67], v[108:111], v[152:155]
  v_mfma_f32_16x16x32_bf16 v[156:159], v[68:71], v[108:111], v[156:159]
  s_waitcnt vmcnt(9)
  s_waitcnt lgkmcnt(0)
  v_mfma_f32_16x16x32_bf16 v[112:115], v[72:75], v[16:19], v[112:115]
  ds_read_b128 v[32:35], v6 offset:8192
  v_mfma_f32_16x16x32_bf16 v[116:119], v[76:79], v[16:19], v[116:119]
  ds_read_b128 v[36:39], v6 offset:10240
  v_mfma_f32_16x16x32_bf16 v[120:123], v[80:83], v[16:19], v[120:123]
  ds_read_b128 v[40:43], v6 offset:12288
  v_mfma_f32_16x16x32_bf16 v[124:127], v[72:75], v[20:23], v[124:127]
  ds_read_b128 v[108:111], v6 offset:14336
  v_mfma_f32_16x16x32_bf16 v[128:131], v[76:79], v[20:23], v[128:131]
  buffer_load_dwordx4 v[60:63], v2, s[8:11], s33 offen offset:2048 sc1
  v_mfma_f32_16x16x32_bf16 v[132:135], v[80:83], v[20:23], v[132:135]
  buffer_load_dwordx4 v[64:67], v2, s[8:11], s34 offen offset:2048 sc1
  v_mfma_f32_16x16x32_bf16 v[136:139], v[72:75], v[24:27], v[136:139]
  buffer_load_dwordx4 v[68:71], v2, s[8:11], s35 offen offset:2048 sc1
  v_mfma_f32_16x16x32_bf16 v[140:143], v[76:79], v[24:27], v[140:143]
  v_mfma_f32_16x16x32_bf16 v[144:147], v[80:83], v[24:27], v[144:147]
  v_mfma_f32_16x16x32_bf16 v[148:151], v[72:75], v[28:31], v[148:151]
  v_mfma_f32_16x16x32_bf16 v[152:155], v[76:79], v[28:31], v[152:155]
  v_mfma_f32_16x16x32_bf16 v[156:159], v[80:83], v[28:31], v[156:159]
  s_waitcnt vmcnt(9)
  s_waitcnt lgkmcnt(0)
  s_barrier
  v_mfma_f32_16x16x32_bf16 v[112:115], v[84:87], v[32:35], v[112:115]
  ds_read_b128 v[16:19], v3 offset:0
  v_mfma_f32_16x16x32_bf16 v[116:119], v[88:91], v[32:35], v[116:119]
  ds_read_b128 v[20:23], v3 offset:2048
  v_mfma_f32_16x16x32_bf16 v[120:123], v[92:95], v[32:35], v[120:123]
  ds_read_b128 v[24:27], v3 offset:4096
  v_mfma_f32_16x16x32_bf16 v[124:127], v[84:87], v[36:39], v[124:127]
  ds_read_b128 v[28:31], v3 offset:6144
  v_mfma_f32_16x16x32_bf16 v[128:131], v[88:91], v[36:39], v[128:131]
  ds_write_b128 v11, v[176:179] offset:0
  v_mfma_f32_16x16x32_bf16 v[132:135], v[92:95], v[36:39], v[132:135]
  ds_write_b128 v11, v[180:183] offset:1024
  v_mfma_f32_16x16x32_bf16 v[136:139], v[84:87], v[40:43], v[136:139]
  buffer_load_dwordx4 v[72:75], v2, s[8:11], s33 offen offset:3072 sc1
  v_mfma_f32_16x16x32_bf16 v[140:143], v[88:91], v[40:43], v[140:143]
  buffer_load_dwordx4 v[76:79], v2, s[8:11], s34 offen offset:3072 sc1
  v_mfma_f32_16x16x32_bf16 v[144:147], v[92:95], v[40:43], v[144:147]
  buffer_load_dwordx4 v[80:83], v2, s[8:11], s35 offen offset:3072 sc1
  v_mfma_f32_16x16x32_bf16 v[148:151], v[84:87], v[108:111], v[148:151]
  v_mfma_f32_16x16x32_bf16 v[152:155], v[88:91], v[108:111], v[152:155]
  v_mfma_f32_16x16x32_bf16 v[156:159], v[92:95], v[108:111], v[156:159]
  s_waitcnt vmcnt(9)
  s_waitcnt lgkmcnt(2)
  v_mfma_f32_16x16x32_bf16 v[112:115], v[96:99], v[16:19], v[112:115]
  ds_read_b64 v[162:163], v12 offset:4096
  ds_read_b64 v[164:165], v12 offset:0
  v_mfma_f32_16x16x32_bf16 v[116:119], v[100:103], v[16:19], v[116:119]
  ds_read_b64 v[166:167], v12 offset:1024
  ds_read_b128 v[32:35], v14 offset:0
  v_mfma_f32_16x16x32_bf16 v[120:123], v[104:107], v[16:19], v[120:123]
  ds_read_b128 v[36:39], v14 offset:2048
  ds_read_b128 v[40:43], v14 offset:4096
  v_mfma_f32_16x16x32_bf16 v[124:127], v[96:99], v[20:23], v[124:127]
  ds_read_b128 v[108:111], v14 offset:6144
  v_mfma_f32_16x16x32_bf16 v[128:131], v[100:103], v[20:23], v[128:131]
  ds_write_b128 v11, v[184:187] offset:2048
  v_mfma_f32_16x16x32_bf16 v[132:135], v[104:107], v[20:23], v[132:135]
  ds_write_b128 v11, v[188:191] offset:3072
  v_mfma_f32_16x16x32_bf16 v[136:139], v[96:99], v[24:27], v[136:139]
  s_add_u32 s33, s33, 4096
  v_mfma_f32_16x16x32_bf16 v[140:143], v[100:103], v[24:27], v[140:143]
  s_add_u32 s34, s34, 4096
  v_mfma_f32_16x16x32_bf16 v[144:147], v[104:107], v[24:27], v[144:147]
  s_add_u32 s35, s35, 4096
  v_mfma_f32_16x16x32_bf16 v[148:151], v[96:99], v[28:31], v[148:151]
  buffer_load_dwordx4 v[84:87], v2, s[8:11], s33 offen offset:0 sc1
  v_mfma_f32_16x16x32_bf16 v[152:155], v[100:103], v[28:31], v[152:155]
  buffer_load_dwordx4 v[88:91], v2, s[8:11], s34 offen offset:0 sc1
  v_mfma_f32_16x16x32_bf16 v[156:159], v[104:107], v[28:31], v[156:159]
  buffer_load_dwordx4 v[92:95], v2, s[8:11], s35 offen offset:0 sc1
  s_waitcnt vmcnt(9)
  s_waitcnt lgkmcnt(2)
  v_mfma_f32_16x16x32_bf16 v[112:115], v[48:51], v[32:35], v[112:115]
  ds_read_b128 v[16:19], v3 offset:8192
  v_mfma_f32_16x16x32_bf16 v[116:119], v[52:55], v[32:35], v[116:119]
  ds_read_b128 v[20:23], v3 offset:10240
  v_mfma_f32_16x16x32_bf16 v[120:123], v[56:59], v[32:35], v[120:123]
  ds_read_b128 v[24:27], v3 offset:12288
  v_mfma_f32_16x16x32_bf16 v[124:127], v[48:51], v[36:39], v[124:127]
  ds_read_b128 v[28:31], v3 offset:14336
  v_mfma_f32_16x16x32_bf16 v[128:131], v[52:55], v[36:39], v[128:131]
  ds_write_b128 v11, v[192:195] offset:8192
  v_mfma_f32_16x16x32_bf16 v[132:135], v[56:59], v[36:39], v[132:135]
  ds_write_b128 v11, v[196:199] offset:9216
  v_mfma_f32_16x16x32_bf16 v[136:139], v[48:51], v[40:43], v[136:139]
  buffer_load_dwordx4 v[96:99], v2, s[8:11], s33 offen offset:1024 sc1
  v_mfma_f32_16x16x32_bf16 v[140:143], v[52:55], v[40:43], v[140:143]
  buffer_load_dwordx4 v[100:103], v2, s[8:11], s34 offen offset:1024 sc1
  v_mfma_f32_16x16x32_bf16 v[144:147], v[56:59], v[40:43], v[144:147]
  buffer_load_dwordx4 v[104:107], v2, s[8:11], s35 offen offset:1024 sc1
  v_mfma_f32_16x16x32_bf16 v[148:151], v[48:51], v[108:111], v[148:151]
  v_mfma_f32_16x16x32_bf16 v[152:155], v[52:55], v[108:111], v[152:155]
  v_mfma_f32_16x16x32_bf16 v[156:159], v[56:59], v[108:111], v[156:159]
  s_waitcnt vmcnt(9)
  s_waitcnt lgkmcnt(2)
  v_mfma_f32_16x16x32_bf16 v[112:115], v[60:63], v[16:19], v[112:115]
  ds_read_b128 v[32:35], v14 offset:8192
  v_mfma_f32_16x16x32_bf16 v[116:119], v[64:67], v[16:19], v[116:119]
  ds_read_b128 v[36:39], v14 offset:10240
  v_mfma_f32_16x16x32_bf16 v[120:123], v[68:71], v[16:19], v[120:123]
  ds_read_b128 v[40:43], v14 offset:12288
  v_mfma_f32_16x16x32_bf16 v[124:127], v[60:63], v[20:23], v[124:127]
  ds_read_b128 v[108:111], v14 offset:14336
  v_mfma_f32_16x16x32_bf16 v[128:131], v[64:67], v[20:23], v[128:131]
  ds_write_b128 v11, v[200:203] offset:10240
  v_mfma_f32_16x16x32_bf16 v[132:135], v[68:71], v[20:23], v[132:135]
  ds_write_b128 v11, v[204:207] offset:11264
  v_mfma_f32_16x16x32_bf16 v[136:139], v[60:63], v[24:27], v[136:139]
  buffer_load_dwordx4 v[48:51], v2, s[8:11], s33 offen offset:2048 sc1
  v_mfma_f32_16x16x32_bf16 v[140:143], v[64:67], v[24:27], v[140:143]
  buffer_load_dwordx4 v[52:55], v2, s[8:11], s34 offen offset:2048 sc1
  v_mfma_f32_16x16x32_bf16 v[144:147], v[68:71], v[24:27], v[144:147]
  buffer_load_dwordx4 v[56:59], v2, s[8:11], s35 offen offset:2048 sc1
  v_mfma_f32_16x16x32_bf16 v[148:151], v[60:63], v[28:31], v[148:151]
  v_mfma_f32_16x16x32_bf16 v[152:155], v[64:67], v[28:31], v[152:155]
  v_mfma_f32_16x16x32_bf16 v[156:159], v[68:71], v[28:31], v[156:159]
  s_waitcnt vmcnt(9)
  s_waitcnt lgkmcnt(0)
  s_barrier
  v_mfma_f32_16x16x32_bf16 v[112:115], v[72:75], v[32:35], v[112:115]
  ds_read_b128 v[16:19], v4 offset:0
  v_mfma_f32_16x16x32_bf16 v[116:119], v[76:79], v[32:35], v[116:119]
  ds_read_b128 v[20:23], v4 offset:2048
  v_mfma_f32_16x16x32_bf16 v[120:123], v[80:83], v[32:35], v[120:123]
  ds_read_b128 v[24:27], v4 offset:4096
  v_mfma_f32_16x16x32_bf16 v[124:127], v[72:75], v[36:39], v[124:127]
  ds_read_b128 v[28:31], v4 offset:6144
  v_mfma_f32_16x16x32_bf16 v[128:131], v[76:79], v[36:39], v[128:131]
  ds_write_b128 v5, v[208:211] offset:0
  v_mfma_f32_16x16x32_bf16 v[132:135], v[80:83], v[36:39], v[132:135]
  ds_write_b128 v5, v[212:215] offset:1024
  v_mfma_f32_16x16x32_bf16 v[136:139], v[72:75], v[40:43], v[136:139]
  buffer_load_dwordx4 v[60:63], v2, s[8:11], s33 offen offset:3072 sc1
  v_mfma_f32_16x16x32_bf16 v[140:143], v[76:79], v[40:43], v[140:143]
  buffer_load_dwordx4 v[64:67], v2, s[8:11], s34 offen offset:3072 sc1
  v_mfma_f32_16x16x32_bf16 v[144:147], v[80:83], v[40:43], v[144:147]
  buffer_load_dwordx4 v[68:71], v2, s[8:11], s35 offen offset:3072 sc1
  v_mfma_f32_16x16x32_bf16 v[148:151], v[72:75], v[108:111], v[148:151]
  v_mfma_f32_16x16x32_bf16 v[152:155], v[76:79], v[108:111], v[152:155]
  v_mfma_f32_16x16x32_bf16 v[156:159], v[80:83], v[108:111], v[156:159]
  s_waitcnt vmcnt(9)
  s_waitcnt lgkmcnt(2)
  v_mfma_f32_16x16x32_bf16 v[112:115], v[84:87], v[16:19], v[112:115]
  ds_read_b128 v[32:35], v6 offset:0
  v_mfma_f32_16x16x32_bf16 v[116:119], v[88:91], v[16:19], v[116:119]
  ds_read_b128 v[36:39], v6 offset:2048
  v_mfma_f32_16x16x32_bf16 v[120:123], v[92:95], v[16:19], v[120:123]
  ds_read_b128 v[40:43], v6 offset:4096
  v_mfma_f32_16x16x32_bf16 v[124:127], v[84:87], v[20:23], v[124:127]
  ds_read_b128 v[108:111], v6 offset:6144
  v_mfma_f32_16x16x32_bf16 v[128:131], v[88:91], v[20:23], v[128:131]
  ds_write_b128 v5, v[216:219] offset:2048
  v_mfma_f32_16x16x32_bf16 v[132:135], v[92:95], v[20:23], v[132:135]
  ds_write_b128 v5, v[220:223] offset:3072
  v_mfma_f32_16x16x32_bf16 v[136:139], v[84:87], v[24:27], v[136:139]
  s_add_u32 s33, s33, 4096
  v_mfma_f32_16x16x32_bf16 v[140:143], v[88:91], v[24:27], v[140:143]
  s_add_u32 s34, s34, 4096
  v_mfma_f32_16x16x32_bf16 v[144:147], v[92:95], v[24:27], v[144:147]
  s_add_u32 s35, s35, 4096
  v_mfma_f32_16x16x32_bf16 v[148:151], v[84:87], v[28:31], v[148:151]
  buffer_load_dwordx4 v[72:75], v2, s[8:11], s33 offen offset:0 sc1
  v_mfma_f32_16x16x32_bf16 v[152:155], v[88:91], v[28:31], v[152:155]
  buffer_load_dwordx4 v[76:79], v2, s[8:11], s34 offen offset:0 sc1
  v_mfma_f32_16x16x32_bf16 v[156:159], v[92:95], v[28:31], v[156:159]
  buffer_load_dwordx4 v[80:83], v2, s[8:11], s35 offen offset:0 sc1
  s_waitcnt vmcnt(9)
  s_waitcnt lgkmcnt(2)
  v_mfma_f32_16x16x32_bf16 v[112:115], v[96:99], v[32:35], v[112:115]
  ds_read_b128 v[16:19], v4 offset:8192
  v_mfma_f32_16x16x32_bf16 v[116:119], v[100:103], v[32:35], v[116:119]
  ds_read_b128 v[20:23], v4 offset:10240
  v_mfma_f32_16x16x32_bf16 v[120:123], v[104:107], v[32:35], v[120:123]
  ds_read_b128 v[24:27], v4 offset:12288
  v_mfma_f32_16x16x32_bf16 v[124:127], v[96:99], v[36:39], v[124:127]
  ds_read_b128 v[28:31], v4 offset:14336
  v_mfma_f32_16x16x32_bf16 v[128:131], v[100:103], v[36:39], v[128:131]
  ds_write_b128 v5, v[224:227] offset:8192
  v_mfma_f32_16x16x32_bf16 v[132:135], v[104:107], v[36:39], v[132:135]
  ds_write_b128 v5, v[228:231] offset:9216
  v_mfma_f32_16x16x32_bf16 v[136:139], v[96:99], v[40:43], v[136:139]
  buffer_load_dwordx4 v[84:87], v2, s[8:11], s33 offen offset:1024 sc1
  v_mfma_f32_16x16x32_bf16 v[140:143], v[100:103], v[40:43], v[140:143]
  buffer_load_dwordx4 v[88:91], v2, s[8:11], s34 offen offset:1024 sc1
  v_mfma_f32_16x16x32_bf16 v[144:147], v[104:107], v[40:43], v[144:147]
  buffer_load_dwordx4 v[92:95], v2, s[8:11], s35 offen offset:1024 sc1
  v_mfma_f32_16x16x32_bf16 v[148:151], v[96:99], v[108:111], v[148:151]
  v_mfma_f32_16x16x32_bf16 v[152:155], v[100:103], v[108:111], v[152:155]
  v_mfma_f32_16x16x32_bf16 v[156:159], v[104:107], v[108:111], v[156:159]
  s_waitcnt vmcnt(9)
  s_waitcnt lgkmcnt(2)
  v_mfma_f32_16x16x32_bf16 v[112:115], v[48:51], v[16:19], v[112:115]
  ds_read_b128 v[32:35], v6 offset:8192
  v_mfma_f32_16x16x32_bf16 v[116:119], v[52:55], v[16:19], v[116:119]
  ds_read_b128 v[36:39], v6 offset:10240
  v_mfma_f32_16x16x32_bf16 v[120:123], v[56:59], v[16:19], v[120:123]
  ds_read_b128 v[40:43], v6 offset:12288
  v_mfma_f32_16x16x32_bf16 v[124:127], v[48:51], v[20:23], v[124:127]
  ds_read_b128 v[108:111], v6 offset:14336
  v_mfma_f32_16x16x32_bf16 v[128:131], v[52:55], v[20:23], v[128:131]
  ds_write_b128 v5, v[232:235] offset:10240
  v_mfma_f32_16x16x32_bf16 v[132:135], v[56:59], v[20:23], v[132:135]
  ds_write_b128 v5, v[236:239] offset:11264
  v_mfma_f32_16x16x32_bf16 v[136:139], v[48:51], v[24:27], v[136:139]
  buffer_load_dwordx4 v[96:99], v2, s[8:11], s33 offen offset:2048 sc1
  v_mfma_f32_16x16x32_bf16 v[140:143], v[52:55], v[24:27], v[140:143]
  buffer_load_dwordx4 v[100:103], v2, s[8:11], s34 offen offset:2048 sc1
  v_mfma_f32_16x16x32_bf16 v[144:147], v[56:59], v[24:27], v[144:147]
  buffer_load_dwordx4 v[104:107], v2, s[8:11], s35 offen offset:2048 sc1
  v_mfma_f32_16x16x32_bf16 v[148:151], v[48:51], v[28:31], v[148:151]
  v_mfma_f32_16x16x32_bf16 v[152:155], v[52:55], v[28:31], v[152:155]
  v_mfma_f32_16x16x32_bf16 v[156:159], v[56:59], v[28:31], v[156:159]
  s_waitcnt vmcnt(9)
  s_waitcnt lgkmcnt(0)
  s_barrier
  v_mfma_f32_16x16x32_bf16 v[112:115], v[60:63], v[32:35], v[112:115]
  ds_read_b128 v[16:19], v3 offset:0
  v_mfma_f32_16x16x32_bf16 v[116:119], v[64:67], v[32:35], v[116:119]
  ds_read_b128 v[20:23], v3 offset:2048
  v_mfma_f32_16x16x32_bf16 v[120:123], v[68:71], v[32:35], v[120:123]
  ds_read_b128 v[24:27], v3 offset:4096
  v_mfma_f32_16x16x32_bf16 v[124:127], v[60:63], v[36:39], v[124:127]
  ds_read_b128 v[28:31], v3 offset:6144
  v_mfma_f32_16x16x32_bf16 v[128:131], v[64:67], v[36:39], v[128:131]
  buffer_load_dwordx4 v[48:51], v2, s[8:11], s33 offen offset:3072 sc1
  v_mfma_f32_16x16x32_bf16 v[132:135], v[68:71], v[36:39], v[132:135]
  buffer_load_dwordx4 v[52:55], v2, s[8:11], s34 offen offset:3072 sc1
  v_mfma_f32_16x16x32_bf16 v[136:139], v[60:63], v[40:43], v[136:139]
  buffer_load_dwordx4 v[56:59], v2, s[8:11], s35 offen offset:3072 sc1
  v_mfma_f32_16x16x32_bf16 v[140:143], v[64:67], v[40:43], v[140:143]
  v_mfma_f32_16x16x32_bf16 v[144:147], v[68:71], v[40:43], v[144:147]
  v_mfma_f32_16x16x32_bf16 v[148:151], v[60:63], v[108:111], v[148:151]
  v_mfma_f32_16x16x32_bf16 v[152:155], v[64:67], v[108:111], v[152:155]
  v_mfma_f32_16x16x32_bf16 v[156:159], v[68:71], v[108:111], v[156:159]
  s_waitcnt vmcnt(9)
  s_waitcnt lgkmcnt(0)
  v_mfma_f32_16x16x32_bf16 v[112:115], v[72:75], v[16:19], v[112:115]
  ds_read_b128 v[32:35], v14 offset:0
  ds_read_b128 v[36:39], v14 offset:2048
  v_mfma_f32_16x16x32_bf16 v[116:119], v[76:79], v[16:19], v[116:119]
  ds_read_b128 v[40:43], v14 offset:4096
  ds_read_b128 v[108:111], v14 offset:6144
  v_mfma_f32_16x16x32_bf16 v[120:123], v[80:83], v[16:19], v[120:123]
  s_mul_i32 s46, s6, 90112
  s_mul_i32 s49, s29, 45056
  v_mfma_f32_16x16x32_bf16 v[124:127], v[72:75], v[20:23], v[124:127]
  s_add_u32 s46, s46, s49
  v_mfma_f32_16x16x32_bf16 v[128:131], v[76:79], v[20:23], v[128:131]
  s_lshl_b32 s49, s32, 10
  v_mfma_f32_16x16x32_bf16 v[132:135], v[80:83], v[20:23], v[132:135]
  s_add_u32 s46, s46, s49
  v_mfma_f32_16x16x32_bf16 v[136:139], v[72:75], v[24:27], v[136:139]
  s_add_u32 s46, s46, 13631488
  v_mfma_f32_16x16x32_bf16 v[140:143], v[76:79], v[24:27], v[140:143]
  buffer_load_dwordx4 v[176:179], v2, s[8:11], s46 offen offset:0 sc1
  v_mfma_f32_16x16x32_bf16 v[144:147], v[80:83], v[24:27], v[144:147]
  s_add_u32 s46, s46, 4096
  v_mfma_f32_16x16x32_bf16 v[148:151], v[72:75], v[28:31], v[148:151]
  buffer_load_dwordx4 v[180:183], v2, s[8:11], s46 offen offset:0 sc1
  v_mfma_f32_16x16x32_bf16 v[152:155], v[76:79], v[28:31], v[152:155]
  s_add_u32 s46, s46, 4096
  v_mfma_f32_16x16x32_bf16 v[156:159], v[80:83], v[28:31], v[156:159]
  buffer_load_dwordx4 v[184:187], v2, s[8:11], s46 offen offset:0 sc1
  s_waitcnt vmcnt(9)
  s_waitcnt lgkmcnt(0)
  v_mfma_f32_16x16x32_bf16 v[112:115], v[84:87], v[32:35], v[112:115]
  ds_read_b128 v[16:19], v3 offset:8192
  v_mfma_f32_16x16x32_bf16 v[116:119], v[88:91], v[32:35], v[116:119]
  ds_read_b128 v[20:23], v3 offset:10240
  v_mfma_f32_16x16x32_bf16 v[120:123], v[92:95], v[32:35], v[120:123]
  ds_read_b128 v[24:27], v3 offset:12288
  v_mfma_f32_16x16x32_bf16 v[124:127], v[84:87], v[36:39], v[124:127]
  ds_read_b128 v[28:31], v3 offset:14336
  v_mfma_f32_16x16x32_bf16 v[128:131], v[88:91], v[36:39], v[128:131]
  s_add_u32 s46, s46, 4096
  v_mfma_f32_16x16x32_bf16 v[132:135], v[92:95], v[36:39], v[132:135]
  buffer_load_dwordx4 v[188:191], v2, s[8:11], s46 offen offset:0 sc1
  v_mfma_f32_16x16x32_bf16 v[136:139], v[84:87], v[40:43], v[136:139]
  s_add_u32 s46, s46, 4096
  v_mfma_f32_16x16x32_bf16 v[140:143], v[88:91], v[40:43], v[140:143]
  buffer_load_dwordx4 v[192:195], v2, s[8:11], s46 offen offset:0 sc1
  v_mfma_f32_16x16x32_bf16 v[144:147], v[92:95], v[40:43], v[144:147]
  s_add_u32 s46, s46, 4096
  v_mfma_f32_16x16x32_bf16 v[148:151], v[84:87], v[108:111], v[148:151]
  buffer_load_dwordx4 v[196:199], v2, s[8:11], s46 offen offset:0 sc1
  v_mfma_f32_16x16x32_bf16 v[152:155], v[88:91], v[108:111], v[152:155]
  v_mfma_f32_16x16x32_bf16 v[156:159], v[92:95], v[108:111], v[156:159]
  s_waitcnt vmcnt(9)
  s_waitcnt lgkmcnt(0)
  v_mfma_f32_16x16x32_bf16 v[112:115], v[96:99], v[16:19], v[112:115]
  ds_read_b128 v[32:35], v14 offset:8192
  v_mfma_f32_16x16x32_bf16 v[116:119], v[100:103], v[16:19], v[116:119]
  ds_read_b128 v[36:39], v14 offset:10240
  v_mfma_f32_16x16x32_bf16 v[120:123], v[104:107], v[16:19], v[120:123]
  ds_read_b128 v[40:43], v14 offset:12288
  v_mfma_f32_16x16x32_bf16 v[124:127], v[96:99], v[20:23], v[124:127]
  ds_read_b128 v[108:111], v14 offset:14336
  v_mfma_f32_16x16x32_bf16 v[128:131], v[100:103], v[20:23], v[128:131]
  s_add_u32 s46, s46, 4096
  v_mfma_f32_16x16x32_bf16 v[132:135], v[104:107], v[20:23], v[132:135]
  buffer_load_dwordx4 v[200:203], v2, s[8:11], s46 offen offset:0 sc1
  v_mfma_f32_16x16x32_bf16 v[136:139], v[96:99], v[24:27], v[136:139]
  s_add_u32 s46, s46, 4096
  v_mfma_f32_16x16x32_bf16 v[140:143], v[100:103], v[24:27], v[140:143]
  buffer_load_dwordx4 v[204:207], v2, s[8:11], s46 offen offset:0 sc1
  v_mfma_f32_16x16x32_bf16 v[144:147], v[104:107], v[24:27], v[144:147]
  s_add_u32 s46, s46, 4096
  v_mfma_f32_16x16x32_bf16 v[148:151], v[96:99], v[28:31], v[148:151]
  buffer_load_dwordx4 v[208:211], v2, s[8:11], s46 offen offset:0 sc1
  v_mfma_f32_16x16x32_bf16 v[152:155], v[100:103], v[28:31], v[152:155]
  v_mfma_f32_16x16x32_bf16 v[156:159], v[104:107], v[28:31], v[156:159]
  s_waitcnt vmcnt(9)
  s_waitcnt lgkmcnt(0)
  v_mfma_f32_16x16x32_bf16 v[112:115], v[48:51], v[32:35], v[112:115]
  s_add_u32 s46, s46, 4096
  v_mfma_f32_16x16x32_bf16 v[116:119], v[52:55], v[32:35], v[116:119]
  buffer_load_dwordx4 v[212:215], v2, s[8:11], s46 offen offset:0 sc1
  v_mfma_f32_16x16x32_bf16 v[120:123], v[56:59], v[32:35], v[120:123]
  s_add_u32 s46, s46, 4096
  v_mfma_f32_16x16x32_bf16 v[124:127], v[48:51], v[36:39], v[124:127]
  buffer_load_dwordx4 v[216:219], v2, s[8:11], s46 offen offset:0 sc1
  v_mfma_f32_16x16x32_bf16 v[128:131], v[52:55], v[36:39], v[128:131]
  v_mfma_f32_16x16x32_bf16 v[132:135], v[56:59], v[36:39], v[132:135]
  v_mfma_f32_16x16x32_bf16 v[136:139], v[48:51], v[40:43], v[136:139]
  v_mfma_f32_16x16x32_bf16 v[140:143], v[52:55], v[40:43], v[140:143]
  v_mfma_f32_16x16x32_bf16 v[144:147], v[56:59], v[40:43], v[144:147]
  v_mfma_f32_16x16x32_bf16 v[148:151], v[48:51], v[108:111], v[148:151]
  v_mfma_f32_16x16x32_bf16 v[152:155], v[52:55], v[108:111], v[152:155]
  v_mfma_f32_16x16x32_bf16 v[156:159], v[56:59], v[108:111], v[156:159]
  s_mul_i32 s39, s29, 36864
  s_add_u32 s39, s39, 90112
  v_add_u32 v5, s39, v2
  s_cmp_eq_u32 s32, 1
  s_cbranch_scc1 sequential_preLN__grouped_kv_mqa__mixer_gmlp__prompt_kernel_rk96
  s_cmp_eq_u32 s32, 2
  s_cbranch_scc1 sequential_preLN__grouped_kv_mqa__mixer_gmlp__prompt_kernel_rk97
  s_cmp_eq_u32 s32, 3
  s_cbranch_scc1 sequential_preLN__grouped_kv_mqa__mixer_gmlp__prompt_kernel_rk98
sequential_preLN__grouped_kv_mqa__mixer_gmlp__prompt_kernel_rk95:
  ds_write_b128 v5, v[124:127] offset:9216
  ds_write_b128 v5, v[128:131] offset:10240
  ds_write_b128 v5, v[132:135] offset:11264
  ds_write_b128 v5, v[136:139] offset:18432
  ds_write_b128 v5, v[140:143] offset:19456
  ds_write_b128 v5, v[144:147] offset:20480
  ds_write_b128 v5, v[148:151] offset:27648
  ds_write_b128 v5, v[152:155] offset:28672
  ds_write_b128 v5, v[156:159] offset:29696
  v_lshlrev_b32 v160, 16, v253
  v_lshlrev_b32 v161, 16, v253
  v_pk_add_f32 v[48:49], v[112:113], v[160:161]
  v_pk_add_f32 v[50:51], v[114:115], v[160:161]
  v_pk_add_f32 v[52:53], v[116:117], v[160:161]
  v_pk_add_f32 v[54:55], v[118:119], v[160:161]
  v_pk_add_f32 v[56:57], v[120:121], v[160:161]
  v_pk_add_f32 v[58:59], v[122:123], v[160:161]
  s_branch sequential_preLN__grouped_kv_mqa__mixer_gmlp__prompt_kernel_rj94
sequential_preLN__grouped_kv_mqa__mixer_gmlp__prompt_kernel_rk96:
  ds_write_b128 v5, v[112:115] offset:0
  ds_write_b128 v5, v[116:119] offset:1024
  ds_write_b128 v5, v[120:123] offset:2048
  ds_write_b128 v5, v[136:139] offset:21504
  ds_write_b128 v5, v[140:143] offset:22528
  ds_write_b128 v5, v[144:147] offset:23552
  ds_write_b128 v5, v[148:151] offset:30720
  ds_write_b128 v5, v[152:155] offset:31744
  ds_write_b128 v5, v[156:159] offset:32768
  v_lshlrev_b32 v160, 16, v253
  v_lshlrev_b32 v161, 16, v253
  v_pk_add_f32 v[48:49], v[124:125], v[160:161]
  v_pk_add_f32 v[50:51], v[126:127], v[160:161]
  v_pk_add_f32 v[52:53], v[128:129], v[160:161]
  v_pk_add_f32 v[54:55], v[130:131], v[160:161]
  v_pk_add_f32 v[56:57], v[132:133], v[160:161]
  v_pk_add_f32 v[58:59], v[134:135], v[160:161]
  s_branch sequential_preLN__grouped_kv_mqa__mixer_gmlp__prompt_kernel_rj94
sequential_preLN__grouped_kv_mqa__mixer_gmlp__prompt_kernel_rk97:
  ds_write_b128 v5, v[112:115] offset:3072
  ds_write_b128 v5, v[116:119] offset:4096
  ds_write_b128 v5, v[120:123] offset:5120
  ds_write_b128 v5, v[124:127] offset:12288
  ds_write_b128 v5, v[128:131] offset:13312
  ds_write_b128 v5, v[132:135] offset:14336
  ds_write_b128 v5, v[148:151] offset:33792
  ds_write_b128 v5, v[152:155] offset:34816
  ds_write_b128 v5, v[156:159] offset:35840
  v_lshlrev_b32 v160, 16, v253
  v_lshlrev_b32 v161, 16, v253
  v_pk_add_f32 v[48:49], v[136:137], v[160:161]
  v_pk_add_f32 v[50:51], v[138:139], v[160:161]
  v_pk_add_f32 v[52:53], v[140:141], v[160:161]
  v_pk_add_f32 v[54:55], v[142:143], v[160:161]
  v_pk_add_f32 v[56:57], v[144:145], v[160:161]
  v_pk_add_f32 v[58:59], v[146:147], v[160:161]
  s_branch sequential_preLN__grouped_kv_mqa__mixer_gmlp__prompt_kernel_rj94
sequential_preLN__grouped_kv_mqa__mixer_gmlp__prompt_kernel_rk98:
  ds_write_b128 v5, v[112:115] offset:6144
  ds_write_b128 v5, v[116:119] offset:7168
  ds_write_b128 v5, v[120:123] offset:8192
  ds_write_b128 v5, v[124:127] offset:15360
  ds_write_b128 v5, v[128:131] offset:16384
  ds_write_b128 v5, v[132:135] offset:17408
  ds_write_b128 v5, v[136:139] offset:24576
  ds_write_b128 v5, v[140:143] offset:25600
  ds_write_b128 v5, v[144:147] offset:26624
  v_lshlrev_b32 v160, 16, v253
  v_lshlrev_b32 v161, 16, v253
  v_pk_add_f32 v[48:49], v[148:149], v[160:161]
  v_pk_add_f32 v[50:51], v[150:151], v[160:161]
  v_pk_add_f32 v[52:53], v[152:153], v[160:161]
  v_pk_add_f32 v[54:55], v[154:155], v[160:161]
  v_pk_add_f32 v[56:57], v[156:157], v[160:161]
  v_pk_add_f32 v[58:59], v[158:159], v[160:161]
sequential_preLN__grouped_kv_mqa__mixer_gmlp__prompt_kernel_rj94:
  s_mul_i32 s39, s29, 36864
  s_mul_i32 s49, s32, 9216
  s_add_u32 s39, s39, s49
  s_add_u32 s39, s39, 90112
  v_add_u32 v5, s39, v2
  v_lshlrev_b32 v12, 9, v9
  v_lshl_add_u32 v12, v10, 4, v12
  v_bfe_u32 v13, v1, 4, 1
  v_lshl_add_u32 v12, v13, 3, v12
  s_mul_i32 s33, s5, 90112
  s_mul_i32 s49, s31, 45056
  s_add_u32 s33, s33, s49
  s_lshl_b32 s49, s53, 10
  s_add_u32 s33, s33, s49
  s_lshl_b32 s49, s30, 8
  s_add_u32 s33, s33, s49
  s_add_u32 s33, s33, 8388608
  s_add_u32 s34, s33, s54
  s_mov_b32 s39, 0x110b0600
  s_mov_b32 s40, 0x26211c16
  s_cmp_lt_u32 s4, 4
  s_cselect_b32 s39, s39, s40
  s_and_b32 s40, s4, 3
  s_lshl_b32 s40, s40, 3
  s_lshr_b32 s39, s39, s40
  s_and_b32 s84, s39, 0xff
  s_lshr_b32 s86, 21, s4
  s_and_b32 s86, s86, 1
  s_lshl_b32 s84, s84, 10
  s_mul_i32 s85, s5, 90112
  s_add_u32 s85, s85, s84
  s_add_u32 s85, s85, 8388608
  s_lshl_b32 s86, s86, 10
  s_add_u32 s86, s86, 4096
  s_waitcnt lgkmcnt(0)
  s_barrier
  ds_read_b128 v[64:67], v5 offset:0
  ds_read_b128 v[68:71], v5 offset:1024
  ds_read_b128 v[72:75], v5 offset:2048
  ds_read_b128 v[76:79], v5 offset:3072
  ds_read_b128 v[80:83], v5 offset:4096
  ds_read_b128 v[84:87], v5 offset:5120
  ds_read_b128 v[88:91], v5 offset:6144
  ds_read_b128 v[92:95], v5 offset:7168
  ds_read_b128 v[96:99], v5 offset:8192
  v_lshlrev_b32 v16, 16, v162
  v_and_b32 v17, 0xffff0000, v162
  v_lshlrev_b32 v18, 16, v163
  v_and_b32 v19, 0xffff0000, v163
  v_lshlrev_b32 v20, 16, v164
  v_and_b32 v21, 0xffff0000, v164
  v_lshlrev_b32 v22, 16, v165
  v_and_b32 v23, 0xffff0000, v165
  v_lshlrev_b32 v24, 16, v166
  v_and_b32 v25, 0xffff0000, v166
  v_lshlrev_b32 v26, 16, v167
  v_and_b32 v27, 0xffff0000, v167
  s_waitcnt lgkmcnt(6)
  v_pk_add_f32 v[48:49], v[48:49], v[64:65]
  v_pk_add_f32 v[50:51], v[50:51], v[66:67]
  v_pk_add_f32 v[52:53], v[52:53], v[68:69]
  v_pk_add_f32 v[54:55], v[54:55], v[70:71]
  v_pk_add_f32 v[56:57], v[56:57], v[72:73]
  v_pk_add_f32 v[58:59], v[58:59], v[74:75]
  s_waitcnt lgkmcnt(3)
  v_pk_add_f32 v[48:49], v[48:49], v[76:77]
  v_pk_add_f32 v[50:51], v[50:51], v[78:79]
  v_pk_add_f32 v[52:53], v[52:53], v[80:81]
  v_pk_add_f32 v[54:55], v[54:55], v[82:83]
  v_pk_add_f32 v[56:57], v[56:57], v[84:85]
  v_pk_add_f32 v[58:59], v[58:59], v[86:87]
  s_waitcnt lgkmcnt(0)
  v_pk_add_f32 v[48:49], v[48:49], v[88:89]
  v_pk_add_f32 v[50:51], v[50:51], v[90:91]
  v_pk_add_f32 v[52:53], v[52:53], v[92:93]
  v_pk_add_f32 v[54:55], v[54:55], v[94:95]
  v_pk_add_f32 v[56:57], v[56:57], v[96:97]
  v_pk_add_f32 v[58:59], v[58:59], v[98:99]
  v_pk_mul_f32 v[48:49], v[48:49], v[16:17]
  v_pk_mul_f32 v[50:51], v[50:51], v[18:19]
  v_pk_mul_f32 v[52:53], v[52:53], v[20:21]
  v_pk_mul_f32 v[54:55], v[54:55], v[22:23]
  v_pk_mul_f32 v[56:57], v[56:57], v[24:25]
  v_pk_mul_f32 v[58:59], v[58:59], v[26:27]
  v_cvt_pk_bf16_f32 v162, v48, v49
  v_cvt_pk_bf16_f32 v163, v50, v51
  v_cvt_pk_bf16_f32 v164, v52, v53
  v_cvt_pk_bf16_f32 v165, v54, v55
  v_cvt_pk_bf16_f32 v166, v56, v57
  v_cvt_pk_bf16_f32 v167, v58, v59
  s_cmp_eq_u32 s68, 0
  s_cbranch_scc1 sequential_preLN__grouped_kv_mqa__mixer_gmlp__prompt_kernel_L99
  buffer_store_dwordx2 v[162:163], v12, s[8:11], s33 offen offset:0
  buffer_store_dwordx2 v[164:165], v12, s[8:11], s33 offen offset:1024
  buffer_store_dwordx2 v[166:167], v12, s[8:11], s34 offen offset:2048
  s_branch sequential_preLN__grouped_kv_mqa__mixer_gmlp__prompt_kernel_L100
sequential_preLN__grouped_kv_mqa__mixer_gmlp__prompt_kernel_L99:
  buffer_store_dwordx2 v[162:163], v12, s[8:11], s33 offen offset:0 sc1
  buffer_store_dwordx2 v[164:165], v12, s[8:11], s33 offen offset:1024 sc1
  buffer_store_dwordx2 v[166:167], v12, s[8:11], s34 offen offset:2048 sc1
sequential_preLN__grouped_kv_mqa__mixer_gmlp__prompt_kernel_L100:
  s_mul_i32 s36, s31, 45056
  s_lshl_b32 s49, s53, 10
  s_add_u32 s36, s36, s49
  s_lshl_b32 s49, s30, 8
  s_add_u32 s36, s36, s49
  v_add_u32 v13, s36, v12
  ds_write_b64 v13, v[162:163] offset:0
  ds_write_b64 v13, v[164:165] offset:1024
  s_cmp_lg_u32 s54, 0
  s_cbranch_scc1 sequential_preLN__grouped_kv_mqa__mixer_gmlp__prompt_kernel_L101
  ds_write_b64 v13, v[166:167] offset:2048
sequential_preLN__grouped_kv_mqa__mixer_gmlp__prompt_kernel_L101:
  s_mov_b32 s48, 100000
  s_lshl_b32 s37, s32, 10
  v_add_u32 v3, s37, v2
  s_mul_i32 s39, s29, 24576
  s_add_u32 s39, s39, 98304
  v_add_u32 v4, s39, v2
  s_mul_i32 s39, s29, 24576
  s_mul_i32 s49, s32, 6144
  s_add_u32 s39, s39, s49
  s_add_u32 s39, s39, 98304
  v_add_u32 v5, s39, v2
  v_lshlrev_b32 v32, 16, v44
  v_and_b32 v33, 0xffff0000, v44
  v_lshlrev_b32 v34, 16, v45
  v_and_b32 v35, 0xffff0000, v45
  v_lshlrev_b32 v36, 16, v46
  v_and_b32 v37, 0xffff0000, v46
  v_lshlrev_b32 v38, 16, v47
  v_and_b32 v39, 0xffff0000, v47
  v_add_u32 v14, s84, v2
  v_add_u32 v11, 45056, v3
  v_add_u32 v12, s86, v14
  s_cmp_eq_u32 s4, s6
  s_cbranch_scc1 sequential_preLN__grouped_kv_mqa__mixer_gmlp__prompt_kernel_landx103
sequential_preLN__grouped_kv_mqa__mixer_gmlp__prompt_kernel_land102:
  s_add_u32 m0, s84, 0
  s_add_u32 s36, s85, 0
  buffer_load_dwordx4 v2, s[8:11], s36 offen offset:0 sc1 lds
  buffer_load_dwordx4 v2, s[8:11], s36 offen offset:1024 sc1 lds
  buffer_load_dwordx4 v2, s[8:11], s36 offen offset:2048 sc1 lds
  buffer_load_dwordx4 v2, s[8:11], s36 offen offset:3072 sc1 lds
  s_add_u32 m0, m0, 4096
  s_add_u32 s37, s36, 4096
  buffer_load_dwordx4 v2, s[8:11], s37 offen sc1 lds
  s_add_u32 s37, s84, s86
  s_add_u32 m0, s37, 0
  s_add_u32 s37, s36, s86
  buffer_load_dwordx4 v2, s[8:11], s37 offen sc1 lds
  s_add_u32 m0, s84, 45056
  s_add_u32 s36, s85, 45056
  buffer_load_dwordx4 v2, s[8:11], s36 offen offset:0 sc1 lds
  buffer_load_dwordx4 v2, s[8:11], s36 offen offset:1024 sc1 lds
  buffer_load_dwordx4 v2, s[8:11], s36 offen offset:2048 sc1 lds
  buffer_load_dwordx4 v2, s[8:11], s36 offen offset:3072 sc1 lds
  s_add_u32 m0, m0, 4096
  s_add_u32 s37, s36, 4096
  buffer_load_dwordx4 v2, s[8:11], s37 offen sc1 lds
  s_add_u32 s37, s84, s86
  s_add_u32 m0, s37, 45056
  s_add_u32 s37, s36, s86
  buffer_load_dwordx4 v2, s[8:11], s37 offen sc1 lds
sequential_preLN__grouped_kv_mqa__mixer_gmlp__prompt_kernel_landc104:
  s_waitcnt vmcnt(0)
  ds_read_b128 v[48:51], v14 offset:0
  ds_read_b128 v[52:55], v14 offset:1024
  ds_read_b128 v[56:59], v14 offset:2048
  ds_read_b128 v[60:63], v14 offset:3072
  ds_read_b128 v[64:67], v14 offset:4096
  ds_read_b128 v[68:71], v14 offset:45056
  ds_read_b128 v[72:75], v14 offset:46080
  ds_read_b128 v[76:79], v14 offset:47104
  ds_read_b128 v[80:83], v14 offset:48128
  ds_read_b128 v[84:87], v14 offset:49152
  ds_read_b128 v[88:91], v12 offset:0
  ds_read_b128 v[92:95], v12 offset:45056
  s_waitcnt lgkmcnt(11)
  v_max3_u32 v13, v48, v49, v50
  v_max_u32 v13, v13, v51
  s_waitcnt lgkmcnt(10)
  v_max3_u32 v13, v13, v52, v53
  v_max3_u32 v13, v13, v54, v55
  s_waitcnt lgkmcnt(9)
  v_max3_u32 v13, v13, v56, v57
  v_max3_u32 v13, v13, v58, v59
  s_waitcnt lgkmcnt(8)
  v_max3_u32 v13, v13, v60, v61
  v_max3_u32 v13, v13, v62, v63
  s_waitcnt lgkmcnt(7)
  v_max3_u32 v13, v13, v64, v65
  v_max3_u32 v13, v13, v66, v67
  s_waitcnt lgkmcnt(6)
  v_max3_u32 v13, v13, v68, v69
  v_max3_u32 v13, v13, v70, v71
  s_waitcnt lgkmcnt(5)
  v_max3_u32 v13, v13, v72, v73
  v_max3_u32 v13, v13, v74, v75
  s_waitcnt lgkmcnt(4)
  v_max3_u32 v13, v13, v76, v77
  v_max3_u32 v13, v13, v78, v79
  s_waitcnt lgkmcnt(3)
  v_max3_u32 v13, v13, v80, v81
  v_max3_u32 v13, v13, v82, v83
  s_waitcnt lgkmcnt(2)
  v_max3_u32 v13, v13, v84, v85
  v_max3_u32 v13, v13, v86, v87
  s_waitcnt lgkmcnt(1)
  v_max3_u32 v13, v13, v88, v89
  v_max3_u32 v13, v13, v90, v91
  s_waitcnt lgkmcnt(0)
  v_max3_u32 v13, v13, v92, v93
  v_max3_u32 v13, v13, v94, v95
  v_cmp_eq_u32 vcc, -1, v13
  s_cbranch_vccz sequential_preLN__grouped_kv_mqa__mixer_gmlp__prompt_kernel_landx103
  s_sub_u32 s48, s48, 1
  s_cmp_lg_u32 s48, 0
  s_cbranch_scc1 sequential_preLN__grouped_kv_mqa__mixer_gmlp__prompt_kernel_land102
sequential_preLN__grouped_kv_mqa__mixer_gmlp__prompt_kernel_landx103:
  s_waitcnt vmcnt(0) lgkmcnt(0)
  s_barrier
  ds_read_b128 v[80:83], v3 offset:0
  ds_read_b128 v[84:87], v11 offset:0
  ds_read_b128 v[88:91], v3 offset:4096
  ds_read_b128 v[92:95], v11 offset:4096
  ds_read_b128 v[96:99], v3 offset:8192
  ds_read_b128 v[100:103], v11 offset:8192
  ds_read_b128 v[104:107], v3 offset:12288
  ds_read_b128 v[108:111], v11 offset:12288
  s_waitcnt lgkmcnt(6)
  v_mfma_f32_32x32x16_bf16 v[48:63], v[176:179], v[80:83], 0
  v_mfma_f32_32x32x16_bf16 v[64:79], v[176:179], v[84:87], 0
  ds_read_b128 v[80:83], v3 offset:16384
  ds_read_b128 v[84:87], v11 offset:16384
  s_waitcnt lgkmcnt(6)
  v_mfma_f32_32x32x16_bf16 v[48:63], v[180:183], v[88:91], v[48:63]
  v_mfma_f32_32x32x16_bf16 v[64:79], v[180:183], v[92:95], v[64:79]
  ds_read_b128 v[88:91], v3 offset:20480
  ds_read_b128 v[92:95], v11 offset:20480
  s_waitcnt lgkmcnt(6)
  v_mfma_f32_32x32x16_bf16 v[48:63], v[184:187], v[96:99], v[48:63]
  v_mfma_f32_32x32x16_bf16 v[64:79], v[184:187], v[100:103], v[64:79]
  ds_read_b128 v[96:99], v3 offset:24576
  ds_read_b128 v[100:103], v11 offset:24576
  s_waitcnt lgkmcnt(6)
  v_mfma_f32_32x32x16_bf16 v[48:63], v[188:191], v[104:107], v[48:63]
  v_mfma_f32_32x32x16_bf16 v[64:79], v[188:191], v[108:111], v[64:79]
  ds_read_b128 v[104:107], v3 offset:28672
  ds_read_b128 v[108:111], v11 offset:28672
  s_waitcnt lgkmcnt(6)
  v_mfma_f32_32x32x16_bf16 v[48:63], v[192:195], v[80:83], v[48:63]
  v_mfma_f32_32x32x16_bf16 v[64:79], v[192:195], v[84:87], v[64:79]
  ds_read_b128 v[80:83], v3 offset:32768
  ds_read_b128 v[84:87], v11 offset:32768
  s_waitcnt lgkmcnt(6)
  v_mfma_f32_32x32x16_bf16 v[48:63], v[196:199], v[88:91], v[48:63]
  v_mfma_f32_32x32x16_bf16 v[64:79], v[196:199], v[92:95], v[64:79]
  ds_read_b128 v[88:91], v3 offset:36864
  ds_read_b128 v[92:95], v11 offset:36864
  s_waitcnt lgkmcnt(6)
  v_mfma_f32_32x32x16_bf16 v[48:63], v[200:203], v[96:99], v[48:63]
  v_mfma_f32_32x32x16_bf16 v[64:79], v[200:203], v[100:103], v[64:79]
  ds_read_b128 v[96:99], v3 offset:40960
  ds_read_b128 v[100:103], v11 offset:40960
  s_waitcnt lgkmcnt(6)
  v_mfma_f32_32x32x16_bf16 v[48:63], v[204:207], v[104:107], v[48:63]
  v_mfma_f32_32x32x16_bf16 v[64:79], v[204:207], v[108:111], v[64:79]
  s_waitcnt lgkmcnt(4)
  v_mfma_f32_32x32x16_bf16 v[48:63], v[208:211], v[80:83], v[48:63]
  v_mfma_f32_32x32x16_bf16 v[64:79], v[208:211], v[84:87], v[64:79]
  s_waitcnt lgkmcnt(2)
  v_mfma_f32_32x32x16_bf16 v[48:63], v[212:215], v[88:91], v[48:63]
  v_mfma_f32_32x32x16_bf16 v[64:79], v[212:215], v[92:95], v[64:79]
  s_waitcnt lgkmcnt(0)
  s_cmp_eq_u32 s32, 3
  s_cbranch_scc1 sequential_preLN__grouped_kv_mqa__mixer_gmlp__prompt_kernel_L105
  v_mfma_f32_32x32x16_bf16 v[48:63], v[216:219], v[96:99], v[48:63]
  v_mfma_f32_32x32x16_bf16 v[64:79], v[216:219], v[100:103], v[64:79]
sequential_preLN__grouped_kv_mqa__mixer_gmlp__prompt_kernel_L105:
  s_cmp_eq_u32 s32, 1
  s_cbranch_scc1 sequential_preLN__grouped_kv_mqa__mixer_gmlp__prompt_kernel_fk108
  s_cmp_eq_u32 s32, 2
  s_cbranch_scc1 sequential_preLN__grouped_kv_mqa__mixer_gmlp__prompt_kernel_fk109
  s_cmp_eq_u32 s32, 3
  s_cbranch_scc1 sequential_preLN__grouped_kv_mqa__mixer_gmlp__prompt_kernel_fk110
sequential_preLN__grouped_kv_mqa__mixer_gmlp__prompt_kernel_fk107:
  s_nop 5
  ds_write_b128 v4, v[64:67] offset:6144
  ds_write_b128 v4, v[68:71] offset:7168
  ds_write_b128 v4, v[56:59] offset:12288
  ds_write_b128 v4, v[60:63] offset:13312
  ds_write_b128 v4, v[72:75] offset:18432
  ds_write_b128 v4, v[76:79] offset:19456
  v_pk_add_f32 v[32:33], v[32:33], v[48:49]
  v_pk_add_f32 v[34:35], v[34:35], v[50:51]
  v_pk_add_f32 v[36:37], v[36:37], v[52:53]
  v_pk_add_f32 v[38:39], v[38:39], v[54:55]
  s_branch sequential_preLN__grouped_kv_mqa__mixer_gmlp__prompt_kernel_fj106
sequential_preLN__grouped_kv_mqa__mixer_gmlp__prompt_kernel_fk108:
  s_nop 8
  ds_write_b128 v4, v[48:51] offset:0
  ds_write_b128 v4, v[52:55] offset:1024
  ds_write_b128 v4, v[56:59] offset:14336
  ds_write_b128 v4, v[60:63] offset:15360
  ds_write_b128 v4, v[72:75] offset:20480
  ds_write_b128 v4, v[76:79] offset:21504
  v_pk_add_f32 v[32:33], v[32:33], v[64:65]
  v_pk_add_f32 v[34:35], v[34:35], v[66:67]
  v_pk_add_f32 v[36:37], v[36:37], v[68:69]
  v_pk_add_f32 v[38:39], v[38:39], v[70:71]
  s_branch sequential_preLN__grouped_kv_mqa__mixer_gmlp__prompt_kernel_fj106
sequential_preLN__grouped_kv_mqa__mixer_gmlp__prompt_kernel_fk109:
  s_nop 6
  ds_write_b128 v4, v[48:51] offset:2048
  ds_write_b128 v4, v[52:55] offset:3072
  ds_write_b128 v4, v[64:67] offset:8192
  ds_write_b128 v4, v[68:71] offset:9216
  ds_write_b128 v4, v[72:75] offset:22528
  ds_write_b128 v4, v[76:79] offset:23552
  v_pk_add_f32 v[32:33], v[32:33], v[56:57]
  v_pk_add_f32 v[34:35], v[34:35], v[58:59]
  v_pk_add_f32 v[36:37], v[36:37], v[60:61]
  v_pk_add_f32 v[38:39], v[38:39], v[62:63]
  s_branch sequential_preLN__grouped_kv_mqa__mixer_gmlp__prompt_kernel_fj106
sequential_preLN__grouped_kv_mqa__mixer_gmlp__prompt_kernel_fk110:
  s_nop 4
  ds_write_b128 v4, v[48:51] offset:4096
  ds_write_b128 v4, v[52:55] offset:5120
  ds_write_b128 v4, v[64:67] offset:10240
  ds_write_b128 v4, v[68:71] offset:11264
  ds_write_b128 v4, v[56:59] offset:16384
  ds_write_b128 v4, v[60:63] offset:17408
  v_pk_add_f32 v[32:33], v[32:33], v[72:73]
  v_pk_add_f32 v[34:35], v[34:35], v[74:75]
  v_pk_add_f32 v[36:37], v[36:37], v[76:77]
  v_pk_add_f32 v[38:39], v[38:39], v[78:79]
sequential_preLN__grouped_kv_mqa__mixer_gmlp__prompt_kernel_fj106:
  s_waitcnt lgkmcnt(0)
  s_barrier
  ds_read_b128 v[80:83], v5 offset:0
  ds_read_b128 v[84:87], v5 offset:1024
  ds_read_b128 v[88:91], v5 offset:2048
  ds_read_b128 v[92:95], v5 offset:3072
  ds_read_b128 v[96:99], v5 offset:4096
  ds_read_b128 v[100:103], v5 offset:5120
  s_waitcnt lgkmcnt(4)
  v_pk_add_f32 v[32:33], v[32:33], v[80:81]
  v_pk_add_f32 v[34:35], v[34:35], v[82:83]
  v_pk_add_f32 v[36:37], v[36:37], v[84:85]
  v_pk_add_f32 v[38:39], v[38:39], v[86:87]
  s_waitcnt lgkmcnt(2)
  v_pk_add_f32 v[32:33], v[32:33], v[88:89]
  v_pk_add_f32 v[34:35], v[34:35], v[90:91]
  v_pk_add_f32 v[36:37], v[36:37], v[92:93]
  v_pk_add_f32 v[38:39], v[38:39], v[94:95]
  s_waitcnt lgkmcnt(0)
  v_pk_add_f32 v[32:33], v[32:33], v[96:97]
  v_pk_add_f32 v[34:35], v[34:35], v[98:99]
  v_pk_add_f32 v[36:37], v[36:37], v[100:101]
  v_pk_add_f32 v[38:39], v[38:39], v[102:103]
  v_cvt_pk_bf16_f32 v44, v32, v33
  v_cvt_pk_bf16_f32 v45, v34, v35
  v_cvt_pk_bf16_f32 v46, v36, v37
  v_cvt_pk_bf16_f32 v47, v38, v39
  buffer_store_dwordx4 v[44:47], v7, s[16:19], s52 offen
L_end:
  s_endpgm
sequential_preLN__grouped_kv_mqa__mixer_gmlp__prompt_kernel_slow31:
  s_waitcnt lgkmcnt(0)
  s_and_b32 s90, s4, 3
  s_xor_b32 s90, s90, s31
  s_and_b32 s91, s90, 1
  s_mov_b32 s39, 0x110b0600
  s_mov_b32 s40, 0x26211c16
  s_cmp_lt_u32 s6, 4
  s_cselect_b32 s39, s39, s40
  s_and_b32 s40, s6, 3
  s_lshl_b32 s40, s40, 3
  s_lshr_b32 s39, s39, s40
  s_and_b32 s95, s39, 0xff
  s_lshr_b32 s96, 21, s6
  s_and_b32 s96, s96, 1
  s_and_b32 s97, s30, s96
  s_mul_i32 s39, s90, 3
  s_add_u32 s39, s39, 1
  s_lshr_b32 s93, s39, 1
  s_sub_u32 s39, s93, s96
  s_cmp_eq_u32 s39, 5
  s_cselect_b32 s92, 1073741824, 0
  s_lshr_b32 s40, s90, 1
  s_mul_i32 s40, s40, 3
  s_add_u32 s94, s40, 1
  s_add_u32 s36, s89, 8192
  s_add_u32 m0, s89, 8192
  s_nop 0
  buffer_load_dwordx4 v2, s[8:11], s36 offen sc1 lds
  s_add_u32 s36, s89, 73728
  s_add_u32 m0, s89, 106496
  s_nop 0
  buffer_load_dwordx4 v2, s[8:11], s36 offen sc1 lds
  s_add_u32 s36, s89, 12288
  s_add_u32 m0, s89, 12288
  s_nop 0
  buffer_load_dwordx4 v2, s[8:11], s36 offen sc1 lds
  s_add_u32 s36, s89, 77824
  s_add_u32 m0, s89, 110592
  s_nop 0
  buffer_load_dwordx4 v2, s[8:11], s36 offen sc1 lds
  s_add_u32 s36, s89, 16384
  s_add_u32 m0, s89, 16384
  s_nop 0
  buffer_load_dwordx4 v2, s[8:11], s36 offen sc1 lds
  s_add_u32 s36, s89, 81920
  s_add_u32 m0, s89, 114688
  s_nop 0
  buffer_load_dwordx4 v2, s[8:11], s36 offen sc1 lds
  s_add_u32 s36, s89, 20480
  s_add_u32 m0, s89, 20480
  s_nop 0
  buffer_load_dwordx4 v2, s[8:11], s36 offen sc1 lds
  s_add_u32 s36, s89, 86016
  s_add_u32 m0, s89, 118784
  s_nop 0
  buffer_load_dwordx4 v2, s[8:11], s36 offen sc1 lds
  s_add_u32 s36, s89, 24576
  s_add_u32 m0, s89, 24576
  s_nop 0
  buffer_load_dwordx4 v2, s[8:11], s36 offen sc1 lds
  s_add_u32 s36, s89, 90112
  s_add_u32 m0, s89, 122880
  s_nop 0
  buffer_load_dwordx4 v2, s[8:11], s36 offen sc1 lds
  s_add_u32 s36, s89, 28672
  s_add_u32 m0, s89, 28672
  s_nop 0
  buffer_load_dwordx4 v2, s[8:11], s36 offen sc1 lds
  s_add_u32 s36, s89, 94208
  s_add_u32 m0, s89, 126976
  s_nop 0
  buffer_load_dwordx4 v2, s[8:11], s36 offen sc1 lds
  s_waitcnt vmcnt(0)
  v_readfirstlane_b32 s39, v254
  s_nop 1
  v_cmp_ne_u32 vcc, s39, v254
  s_nop 0
  s_cmp_eq_u64 vcc, 0
  s_cselect_b32 s68, 1, 0
  ds_write_b128 v13, v[244:247] offset:0
  ds_write_b128 v13, v[248:251] offset:1024
  s_waitcnt lgkmcnt(0)
  ds_read_b64_tr_b16 v[128:129], v11 offset:0
  ds_read_b64_tr_b16 v[130:131], v12 offset:0
  ds_read_b64_tr_b16 v[132:133], v11 offset:1024
  ds_read_b64_tr_b16 v[134:135], v12 offset:1024
  s_waitcnt lgkmcnt(0)
  buffer_store_dwordx4 v[128:131], v2, s[8:11], s54 offen offset:0 sc1
  buffer_store_dwordx4 v[132:135], v2, s[8:11], s54 offen offset:1024 sc1
  s_cmp_lg_u32 s53, 2
  s_cbranch_scc1 sequential_preLN__grouped_kv_mqa__mixer_gmlp__prompt_kernel_L111
  v_dot2_f32_bf16 v140, v128, s28, 0
  v_dot2_f32_bf16 v141, v129, s28, 0
  v_dot2_f32_bf16 v142, v130, s28, 0
  v_dot2_f32_bf16 v143, v131, s28, 0
  v_dot2_f32_bf16 v140, v132, s28, v140
  v_dot2_f32_bf16 v141, v133, s28, v141
  v_dot2_f32_bf16 v142, v134, s28, v142
  v_dot2_f32_bf16 v143, v135, s28, v143
  v_lshlrev_b32 v137, 5, v10
  s_lshl_b32 s39, s4, 2
  s_add_u32 s39, s39, 82944
  v_add_u32 v137, s39, v137
  v_pk_add_f32 v[140:141], v[140:141], v[142:143]
  v_add_f32 v138, v140, v141
  v_mov_b32 v139, v138
  s_nop 1
  v_permlane32_swap_b32 v138, v139
  v_add_f32 v138, v138, v139
  v_mov_b32 v139, v138
  s_nop 1
  v_permlane16_swap_b32 v138, v139
  v_add_f32 v138, v138, v139
  ds_write_b32 v137, v138
sequential_preLN__grouped_kv_mqa__mixer_gmlp__prompt_kernel_L111:
  s_waitcnt lgkmcnt(0)
  s_barrier
  s_cmp_lg_u32 s53, 2
  s_cbranch_scc1 sequential_preLN__grouped_kv_mqa__mixer_gmlp__prompt_kernel_L112
  s_cmp_lg_u32 s4, 7
  s_cbranch_scc1 sequential_preLN__grouped_kv_mqa__mixer_gmlp__prompt_kernel_L112
  v_lshlrev_b32 v137, 5, v10
  v_add_u32 v137, 82944, v137
  ds_read_b128 v[140:143], v137
  ds_read_b128 v[144:147], v137 offset:16
  v_lshlrev_b32 v137, 2, v10
  s_lshl_b32 s39, s2, 6
  s_add_u32 s39, s39, 655360
  s_waitcnt lgkmcnt(0)
  v_pk_add_f32 v[140:141], v[140:141], v[142:143]
  v_pk_add_f32 v[144:145], v[144:145], v[146:147]
  v_pk_add_f32 v[140:141], v[140:141], v[144:145]
  v_add_f32 v140, v140, v141
  buffer_store_dword v140, v137, s[8:11], s39 offen sc1
sequential_preLN__grouped_kv_mqa__mixer_gmlp__prompt_kernel_L112:
  v_mov_b32 v248, -1
  v_mov_b32 v249, -1
  v_mov_b32 v250, -1
  v_mov_b32 v251, -1
  s_lshl_b32 s46, s5, 16
  s_lshl_b32 s49, s30, 15
  s_add_u32 s46, s46, s49
  s_lshl_b32 s49, s6, 12
  s_add_u32 s46, s46, s49
  s_lshl_b32 s49, s29, 11
  s_add_u32 s46, s46, s49
  s_lshl_b32 s49, s31, 10
  s_add_u32 s46, s46, s49
  s_add_u32 s46, s46, 1048576
  s_cmp_eq_u32 s68, 0
  s_cbranch_scc1 sequential_preLN__grouped_kv_mqa__mixer_gmlp__prompt_kernel_L113
  buffer_store_dwordx4 v[248:251], v2, s[8:11], s46 offen
  s_branch sequential_preLN__grouped_kv_mqa__mixer_gmlp__prompt_kernel_L114
sequential_preLN__grouped_kv_mqa__mixer_gmlp__prompt_kernel_L113:
  buffer_store_dwordx4 v[248:251], v2, s[8:11], s46 offen sc1
sequential_preLN__grouped_kv_mqa__mixer_gmlp__prompt_kernel_L114:
  s_lshl_b32 s46, s5, 16
  s_lshl_b32 s49, s32, 14
  s_add_u32 s46, s46, s49
  s_lshl_b32 s49, s6, 11
  s_add_u32 s46, s46, s49
  s_lshl_b32 s49, s29, 10
  s_add_u32 s46, s46, s49
  s_add_u32 s46, s46, 3145728
  s_cmp_eq_u32 s68, 0
  s_cbranch_scc1 sequential_preLN__grouped_kv_mqa__mixer_gmlp__prompt_kernel_L115
  buffer_store_dwordx4 v[248:251], v2, s[8:11], s46 offen
  s_branch sequential_preLN__grouped_kv_mqa__mixer_gmlp__prompt_kernel_L116
sequential_preLN__grouped_kv_mqa__mixer_gmlp__prompt_kernel_L115:
  buffer_store_dwordx4 v[248:251], v2, s[8:11], s46 offen sc1
sequential_preLN__grouped_kv_mqa__mixer_gmlp__prompt_kernel_L116:
  s_mul_i32 s46, s5, 90112
  s_mul_i32 s49, s29, 45056
  s_add_u32 s46, s46, s49
  s_lshl_b32 s49, s95, 10
  s_add_u32 s46, s46, s49
  s_lshl_b32 s49, s32, 10
  s_add_u32 s46, s46, s49
  s_add_u32 s46, s46, 8388608
  s_cmp_eq_u32 s68, 0
  s_cbranch_scc1 sequential_preLN__grouped_kv_mqa__mixer_gmlp__prompt_kernel_L117
  buffer_store_dwordx4 v[248:251], v2, s[8:11], s46 offen
  s_branch sequential_preLN__grouped_kv_mqa__mixer_gmlp__prompt_kernel_L118
sequential_preLN__grouped_kv_mqa__mixer_gmlp__prompt_kernel_L117:
  buffer_store_dwordx4 v[248:251], v2, s[8:11], s46 offen sc1
sequential_preLN__grouped_kv_mqa__mixer_gmlp__prompt_kernel_L118:
  s_mul_i32 s46, s5, 90112
  s_mul_i32 s49, s29, 45056
  s_add_u32 s46, s46, s49
  s_lshl_b32 s49, s95, 10
  s_add_u32 s46, s46, s49
  s_lshl_b32 s49, s97, 10
  s_add_u32 s46, s46, s49
  s_add_u32 s46, s46, 8392704
  s_cmp_eq_u32 s68, 0
  s_cbranch_scc1 sequential_preLN__grouped_kv_mqa__mixer_gmlp__prompt_kernel_L119
  buffer_store_dwordx4 v[248:251], v2, s[8:11], s46 offen
  s_branch sequential_preLN__grouped_kv_mqa__mixer_gmlp__prompt_kernel_L120
sequential_preLN__grouped_kv_mqa__mixer_gmlp__prompt_kernel_L119:
  buffer_store_dwordx4 v[248:251], v2, s[8:11], s46 offen sc1
sequential_preLN__grouped_kv_mqa__mixer_gmlp__prompt_kernel_L120:
  s_waitcnt vmcnt(0)
  s_barrier
  s_cmp_lg_u32 s4, 0
  s_cbranch_scc1 sequential_preLN__grouped_kv_mqa__mixer_gmlp__prompt_kernel_L121
  s_lshl_b32 s39, s2, 2
  s_add_u32 s39, s39, 263168
  v_mov_b32 v14, 1
  s_mov_b64 exec, 1
  buffer_store_dword v14, v15, s[8:11], s39 offen sc1
  s_mov_b64 exec, -1
sequential_preLN__grouped_kv_mqa__mixer_gmlp__prompt_kernel_L121:
  s_barrier
  s_cmp_lg_u32 s4, 0
  s_cbranch_scc1 sequential_preLN__grouped_kv_mqa__mixer_gmlp__prompt_kernel_L122
  s_mov_b32 s39, 263168
  buffer_load_dwordx4 v[244:247], v2, s[8:11], s39 offen sc1
sequential_preLN__grouped_kv_mqa__mixer_gmlp__prompt_kernel_L122:
  s_cmp_lg_u32 s4, 0
  s_cbranch_scc1 sequential_preLN__grouped_kv_mqa__mixer_gmlp__prompt_kernel_wpx124
  s_mov_b32 s48, 100000
sequential_preLN__grouped_kv_mqa__mixer_gmlp__prompt_kernel_wp123:
  s_waitcnt vmcnt(0)
  v_min_u32 v14, v244, v245
  v_min3_u32 v14, v14, v246, v247
  v_cmp_eq_u32 vcc, 0, v14
  s_cbranch_vccz sequential_preLN__grouped_kv_mqa__mixer_gmlp__prompt_kernel_wpx124
  s_sub_u32 s48, s48, 1
  s_cmp_eq_u32 s48, 0
  s_cbranch_scc1 sequential_preLN__grouped_kv_mqa__mixer_gmlp__prompt_kernel_wpx124
  s_sleep 16
  s_mov_b32 s39, 263168
  buffer_load_dwordx4 v[244:247], v2, s[8:11], s39 offen sc1
  s_branch sequential_preLN__grouped_kv_mqa__mixer_gmlp__prompt_kernel_wp123
sequential_preLN__grouped_kv_mqa__mixer_gmlp__prompt_kernel_wpx124:
  s_barrier
  s_lshl_b32 s46, s6, 16
  s_lshl_b32 s49, s29, 15
  s_add_u32 s46, s46, s49
  s_lshl_b32 s49, s31, 10
  s_add_u32 s46, s46, s49
  s_add_u32 s46, s46, 11534336
  buffer_load_dwordx4 v[112:115], v2, s[8:11], s46 offen offset:0 sc1
  buffer_load_dwordx4 v[116:119], v2, s[8:11], s46 offen offset:2048 sc1
  s_add_u32 s46, s46, 4096
  buffer_load_dwordx4 v[120:123], v2, s[8:11], s46 offen offset:0 sc1
  buffer_load_dwordx4 v[124:127], v2, s[8:11], s46 offen offset:2048 sc1
  s_add_u32 s46, s46, 4096
  buffer_load_dwordx4 v[128:131], v2, s[8:11], s46 offen offset:0 sc1
  buffer_load_dwordx4 v[132:135], v2, s[8:11], s46 offen offset:2048 sc1
  s_add_u32 s46, s46, 4096
  buffer_load_dwordx4 v[136:139], v2, s[8:11], s46 offen offset:0 sc1
  buffer_load_dwordx4 v[140:143], v2, s[8:11], s46 offen offset:2048 sc1
  s_add_u32 s46, s46, 4096
  buffer_load_dwordx4 v[144:147], v2, s[8:11], s46 offen offset:0 sc1
  buffer_load_dwordx4 v[148:151], v2, s[8:11], s46 offen offset:2048 sc1
  s_add_u32 s46, s46, 4096
  buffer_load_dwordx4 v[152:155], v2, s[8:11], s46 offen offset:0 sc1
  buffer_load_dwordx4 v[156:159], v2, s[8:11], s46 offen offset:2048 sc1
  s_add_u32 s46, s46, 4096
  buffer_load_dwordx4 v[160:163], v2, s[8:11], s46 offen offset:0 sc1
  buffer_load_dwordx4 v[164:167], v2, s[8:11], s46 offen offset:2048 sc1
  s_add_u32 s46, s46, 4096
  buffer_load_dwordx4 v[168:171], v2, s[8:11], s46 offen offset:0 sc1
  buffer_load_dwordx4 v[172:175], v2, s[8:11], s46 offen offset:2048 sc1
  s_mov_b32 s46, s93
  s_add_u32 s46, s46, s95
  s_add_u32 s46, s46, 43
  s_lshl_b32 s46, s46, 14
  s_lshl_b32 s47, s31, 10
  s_add_u32 s46, s46, s47
  s_add_u32 s46, s46, 12058624
  s_add_u32 s46, s46, s92
  buffer_load_dwordx4 v[176:179], v2, s[8:11], s46 offen offset:0 sc1
  buffer_load_dwordx4 v[180:183], v2, s[8:11], s46 offen offset:2048 sc1
  s_add_u32 s46, s46, 4096
  buffer_load_dwordx4 v[184:187], v2, s[8:11], s46 offen offset:0 sc1
  buffer_load_dwordx4 v[188:191], v2, s[8:11], s46 offen offset:2048 sc1
  s_add_u32 s46, s46, 4096
  buffer_load_dwordx4 v[192:195], v2, s[8:11], s46 offen offset:0 sc1
  buffer_load_dwordx4 v[196:199], v2, s[8:11], s46 offen offset:2048 sc1
  s_add_u32 s46, s46, 4096
  buffer_load_dwordx4 v[200:203], v2, s[8:11], s46 offen offset:0 sc1
  buffer_load_dwordx4 v[204:207], v2, s[8:11], s46 offen offset:2048 sc1
  s_xor_b32 s46, s91, 1
  s_mul_i32 s46, s46, 43
  s_add_u32 s46, s46, s94
  s_add_u32 s46, s46, s95
  s_lshl_b32 s46, s46, 14
  s_lshl_b32 s47, s31, 10
  s_add_u32 s46, s46, s47
  s_add_u32 s46, s46, 12058624
  buffer_load_dwordx4 v[208:211], v2, s[8:11], s46 offen offset:0 sc1
  buffer_load_dwordx4 v[212:215], v2, s[8:11], s46 offen offset:2048 sc1
  s_add_u32 s46, s46, 4096
  buffer_load_dwordx4 v[216:219], v2, s[8:11], s46 offen offset:0 sc1
  buffer_load_dwordx4 v[220:223], v2, s[8:11], s46 offen offset:2048 sc1
  s_add_u32 s46, s46, 4096
  buffer_load_dwordx4 v[224:227], v2, s[8:11], s46 offen offset:0 sc1
  buffer_load_dwordx4 v[228:231], v2, s[8:11], s46 offen offset:2048 sc1
  s_add_u32 s46, s46, 4096
  buffer_load_dwordx4 v[232:235], v2, s[8:11], s46 offen offset:0 sc1
  buffer_load_dwordx4 v[236:239], v2, s[8:11], s46 offen offset:2048 sc1
  s_load_dwordx2 s[60:61], s[0:1], 64
  s_mov_b32 s62, 4096
  s_mov_b32 s63, 0x20000
  s_load_dwordx2 s[16:17], s[0:1], 80
  s_mov_b32 s18, 2097152
  s_mov_b32 s19, 0x20000
  v_lshlrev_b32 v13, 1, v10
  s_lshl_b32 s39, s5, 7
  s_lshl_b32 s49, s32, 5
  s_add_u32 s39, s39, s49
  s_waitcnt lgkmcnt(0)
  buffer_load_ushort v253, v13, s[60:63], s39 offen
  s_lshl_b32 s39, s5, 18
  s_lshl_b32 s49, s6, 15
  s_add_u32 s39, s39, s49
  s_lshl_b32 s49, s4, 12
  s_add_u32 s39, s39, s49
  buffer_load_dwordx4 v[248:251], v2, s[24:27], s39 offen offset:0
  s_lshl_b32 s39, s5, 18
  s_lshl_b32 s49, s6, 15
  s_add_u32 s39, s39, s49
  s_lshl_b32 s49, s4, 12
  s_add_u32 s39, s39, s49
  buffer_load_dwordx4 v[248:251], v2, s[24:27], s39 offen offset:1024
  s_lshl_b32 s39, s5, 18
  s_lshl_b32 s49, s6, 15
  s_add_u32 s39, s39, s49
  s_lshl_b32 s49, s4, 12
  s_add_u32 s39, s39, s49
  buffer_load_dwordx4 v[248:251], v2, s[24:27], s39 offen offset:2048
  s_lshl_b32 s39, s5, 18
  s_lshl_b32 s49, s6, 15
  s_add_u32 s39, s39, s49
  s_lshl_b32 s49, s4, 12
  s_add_u32 s39, s39, s49
  buffer_load_dwordx4 v[248:251], v2, s[24:27], s39 offen offset:3072
  s_barrier
  s_barrier
  s_barrier
  s_barrier
  v_mov_b32 v12, v10
  v_mov_b32 v80, 0
  v_mov_b32 v96, 0
  v_mov_b32 v81, 0
  v_mov_b32 v97, 0
  v_mov_b32 v82, 0
  v_mov_b32 v98, 0
  v_mov_b32 v83, 0
  v_mov_b32 v99, 0
  v_mov_b32 v84, 0
  v_mov_b32 v100, 0
  v_mov_b32 v85, 0
  v_mov_b32 v101, 0
  v_mov_b32 v86, 0
  v_mov_b32 v102, 0
  v_mov_b32 v87, 0
  v_mov_b32 v103, 0
  v_mov_b32 v88, 0
  v_mov_b32 v104, 0
  v_mov_b32 v89, 0
  v_mov_b32 v105, 0
  v_mov_b32 v90, 0
  v_mov_b32 v106, 0
  v_mov_b32 v91, 0
  v_mov_b32 v107, 0
  v_mov_b32 v92, 0
  v_mov_b32 v108, 0
  v_mov_b32 v93, 0
  v_mov_b32 v109, 0
  v_mov_b32 v94, 0
  v_mov_b32 v110, 0
  v_mov_b32 v95, 0
  v_mov_b32 v111, 0
  v_mov_b32 v64, 0xff800000
  v_mov_b32 v10, v2
  s_mov_b32 s46, 64
sequential_preLN__grouped_kv_mqa__mixer_gmlp__prompt_kernel_sl125:
  ds_read_b128 v[24:27], v10
  s_waitcnt lgkmcnt(0)
  v_mfma_f32_32x32x16_bf16 v[48:63], v[24:27], v[16:19], 0
  v_add_u32 v10, 1024, v10
  s_nop 10
  v_max3_f32 v64, v48, v49, v64
  v_max3_f32 v64, v50, v51, v64
  v_max3_f32 v64, v52, v53, v64
  v_max3_f32 v64, v54, v55, v64
  v_max3_f32 v64, v56, v57, v64
  v_max3_f32 v64, v58, v59, v64
  v_max3_f32 v64, v60, v61, v64
  v_max3_f32 v64, v62, v63, v64
  s_sub_u32 s46, s46, 1
  s_cmp_lg_u32 s46, 0
  s_cbranch_scc1 sequential_preLN__grouped_kv_mqa__mixer_gmlp__prompt_kernel_sl125
  v_mov_b32 v10, v64
  s_nop 1
  v_permlane32_swap_b32 v64, v10
  v_max_f32 v64, v64, v10
  v_sub_f32 v64, 0, v64
  v_mov_b32 v65, v64
  v_mov_b32 v66, v64
  v_mov_b32 v67, v64
  v_mov_b32 v68, v64
  v_mov_b32 v69, v64
  v_mov_b32 v70, v64
  v_mov_b32 v71, v64
  v_mov_b32 v72, v64
  v_mov_b32 v73, v64
  v_mov_b32 v74, v64
  v_mov_b32 v75, v64
  v_mov_b32 v76, v64
  v_mov_b32 v77, v64
  v_mov_b32 v78, v64
  v_mov_b32 v79, v64
  s_lshl_b32 s47, s31, 15
  v_add_u32 v10, s47, v2
  v_add_u32 v11, s47, v3
  s_mov_b32 s46, 32
sequential_preLN__grouped_kv_mqa__mixer_gmlp__prompt_kernel_sl126:
  ds_read_b128 v[24:27], v10
  s_mov_b64 exec, s[44:45]
  ds_read_b128 v[28:31], v11
  ds_read_b128 v[32:35], v11 offset:512
  s_mov_b64 exec, -1
  s_waitcnt lgkmcnt(0)
  v_mfma_f32_32x32x16_bf16 v[48:63], v[24:27], v[16:19], v[64:79]
  v_add_u32 v10, 1024, v10
  v_add_u32 v11, 1024, v11
  s_nop 9
  v_exp_f32 v48, v48
  v_exp_f32 v49, v49
  v_exp_f32 v50, v50
  v_exp_f32 v51, v51
  v_exp_f32 v52, v52
  v_exp_f32 v53, v53
  v_exp_f32 v54, v54
  v_exp_f32 v55, v55
  v_exp_f32 v56, v56
  v_exp_f32 v57, v57
  v_exp_f32 v58, v58
  v_exp_f32 v59, v59
  v_exp_f32 v60, v60
  v_exp_f32 v61, v61
  v_exp_f32 v62, v62
  v_exp_f32 v63, v63
  v_cvt_pk_bf16_f32 v36, v48, v49
  v_cvt_pk_bf16_f32 v37, v50, v51
  v_cvt_pk_bf16_f32 v38, v52, v53
  v_cvt_pk_bf16_f32 v39, v54, v55
  v_cvt_pk_bf16_f32 v40, v56, v57
  v_cvt_pk_bf16_f32 v41, v58, v59
  v_cvt_pk_bf16_f32 v42, v60, v61
  v_cvt_pk_bf16_f32 v43, v62, v63
  v_mfma_f32_32x32x16_bf16 v[80:95], v[28:31], v[36:39], v[80:95]
  s_nop 0
  v_mfma_f32_32x32x16_bf16 v[80:95], v[32:35], v[40:43], v[80:95]
  s_sub_u32 s46, s46, 1
  s_cmp_lg_u32 s46, 0
  s_cbranch_scc1 sequential_preLN__grouped_kv_mqa__mixer_gmlp__prompt_kernel_sl126
  v_mov_b32 v64, 0xff800000
  v_mov_b32 v10, v2
  s_mov_b32 s46, 64
sequential_preLN__grouped_kv_mqa__mixer_gmlp__prompt_kernel_sl127:
  ds_read_b128 v[24:27], v10
  s_waitcnt lgkmcnt(0)
  v_mfma_f32_32x32x16_bf16 v[48:63], v[24:27], v[20:23], 0
  v_add_u32 v10, 1024, v10
  s_nop 10
  v_max3_f32 v64, v48, v49, v64
  v_max3_f32 v64, v50, v51, v64
  v_max3_f32 v64, v52, v53, v64
  v_max3_f32 v64, v54, v55, v64
  v_max3_f32 v64, v56, v57, v64
  v_max3_f32 v64, v58, v59, v64
  v_max3_f32 v64, v60, v61, v64
  v_max3_f32 v64, v62, v63, v64
  s_sub_u32 s46, s46, 1
  s_cmp_lg_u32 s46, 0
  s_cbranch_scc1 sequential_preLN__grouped_kv_mqa__mixer_gmlp__prompt_kernel_sl127
  v_mov_b32 v10, v64
  s_nop 1
  v_permlane32_swap_b32 v64, v10
  v_max_f32 v64, v64, v10
  v_sub_f32 v64, 0, v64
  v_mov_b32 v65, v64
  v_mov_b32 v66, v64
  v_mov_b32 v67, v64
  v_mov_b32 v68, v64
  v_mov_b32 v69, v64
  v_mov_b32 v70, v64
  v_mov_b32 v71, v64
  v_mov_b32 v72, v64
  v_mov_b32 v73, v64
  v_mov_b32 v74, v64
  v_mov_b32 v75, v64
  v_mov_b32 v76, v64
  v_mov_b32 v77, v64
  v_mov_b32 v78, v64
  v_mov_b32 v79, v64
  s_lshl_b32 s47, s31, 15
  v_add_u32 v10, s47, v2
  v_add_u32 v11, s47, v3
  s_mov_b32 s46, 32
sequential_preLN__grouped_kv_mqa__mixer_gmlp__prompt_kernel_sl128:
  ds_read_b128 v[24:27], v10
  s_mov_b64 exec, s[44:45]
  ds_read_b128 v[28:31], v11
  ds_read_b128 v[32:35], v11 offset:512
  s_mov_b64 exec, -1
  s_waitcnt lgkmcnt(0)
  v_mfma_f32_32x32x16_bf16 v[48:63], v[24:27], v[20:23], v[64:79]
  v_add_u32 v10, 1024, v10
  v_add_u32 v11, 1024, v11
  s_nop 9
  v_exp_f32 v48, v48
  v_exp_f32 v49, v49
  v_exp_f32 v50, v50
  v_exp_f32 v51, v51
  v_exp_f32 v52, v52
  v_exp_f32 v53, v53
  v_exp_f32 v54, v54
  v_exp_f32 v55, v55
  v_exp_f32 v56, v56
  v_exp_f32 v57, v57
  v_exp_f32 v58, v58
  v_exp_f32 v59, v59
  v_exp_f32 v60, v60
  v_exp_f32 v61, v61
  v_exp_f32 v62, v62
  v_exp_f32 v63, v63
  v_cvt_pk_bf16_f32 v36, v48, v49
  v_cvt_pk_bf16_f32 v37, v50, v51
  v_cvt_pk_bf16_f32 v38, v52, v53
  v_cvt_pk_bf16_f32 v39, v54, v55
  v_cvt_pk_bf16_f32 v40, v56, v57
  v_cvt_pk_bf16_f32 v41, v58, v59
  v_cvt_pk_bf16_f32 v42, v60, v61
  v_cvt_pk_bf16_f32 v43, v62, v63
  v_mfma_f32_32x32x16_bf16 v[96:111], v[28:31], v[36:39], v[96:111]
  s_nop 0
  v_mfma_f32_32x32x16_bf16 v[96:111], v[32:35], v[40:43], v[96:111]
  s_sub_u32 s46, s46, 1
  s_cmp_lg_u32 s46, 0
  s_cbranch_scc1 sequential_preLN__grouped_kv_mqa__mixer_gmlp__prompt_kernel_sl128
  v_mov_b32 v10, v12
  s_waitcnt vmcnt(0)
  s_branch sequential_preLN__grouped_kv_mqa__mixer_gmlp__prompt_kernel_join32
L_codeend:
.section .rodata,"a"
.p2align 6
.amdhsa_kernel sequential_preLN__grouped_kv_mqa__mixer_gmlp__prompt_kernel
  .amdhsa_next_free_vgpr 256
  .amdhsa_next_free_sgpr 100
  .amdhsa_accum_offset 256
  .amdhsa_group_segment_fixed_size 0
  .amdhsa_kernarg_size 104
  .amdhsa_user_sgpr_count 2
  .amdhsa_user_sgpr_kernarg_segment_ptr 1
  .amdhsa_system_sgpr_workgroup_id_x 1
.end_amdhsa_kernel
```
